```python
import torch

def _softmax(x, axis=-1):
    return torch.softmax(x, dim=axis)
def _gelu(x):
    return torch.nn.functional.gelu(x, approximate="tanh")
def _silu(x):
    return torch.nn.functional.silu(x)
def _sigmoid(x):
    return torch.sigmoid(x)
def _layernorm(x, axis=-1, eps=1e-5):
    m = x.mean(dim=axis, keepdim=True)
    v = x.var(dim=axis, keepdim=True, unbiased=False)
    return (x - m) / torch.sqrt(v + eps)
def _scatter_add(tgt, idx, src, axis=0):
    return tgt.clone().index_add_(axis, idx, src)
def _segment_sum(src, seg, n):
    out = torch.zeros((n,) + src.shape[1:], dtype=src.dtype)
    return out.index_add_(0, seg, src)
def _pad(x, pw):
    flat = tuple(v for pair in reversed(pw) for v in pair)
    return torch.nn.functional.pad(x, flat)

kernel_name = 'interleave_layers__gqa_block_cached__glu_gated_geglu__decode'

def setup_inputs():

    _w = (lambda a: (lambda t: t.to(torch.bfloat16) if t.is_floating_point() else t)(torch.as_tensor(a)))
    def _A_setup():
        B, Sq, D = 1, 1, 576
        Hq, Hkv, Sk, Dh = 32, 16, 65536, 128
        assert Hq % Hkv == 0, (Hq, Hkv)
        return {
            "x": _w((lambda *s: torch.randn(*s, dtype=torch.bfloat16) * 0.05)(B, Sq, D)),
            "k_cache": _w((lambda *s: torch.randn(*s, dtype=torch.bfloat16) * 0.8)(B, Hkv, Sk, Dh)),
            "v_cache": _w((lambda *s: torch.randn(*s, dtype=torch.bfloat16) * 1.6)(B, Hkv, Sk, Dh)),
            "wq": _w((lambda *s: torch.randn(*s, dtype=torch.bfloat16) * 0.8)(D, Hq * Dh) * (D ** -0.5)),
            "wo": _w((lambda *s: torch.randn(*s, dtype=torch.bfloat16) * 1.6)(Hq * Dh, D) * ((Hq * Dh) ** -0.5)),
        }
    _A_in = _A_setup()

    def _B_setup():
        B, S, Dm, Df = 1, 1, 576, 4608
        return {
            "x": _w((lambda *s: torch.randn(*s, dtype=torch.bfloat16) * 0.05)(B, S, Dm)),
            "w_gate": _w((lambda *s: torch.randn(*s, dtype=torch.bfloat16) * 0.4)(Dm, Df) * (Dm ** -0.5)),
            "w_up": _w((lambda *s: torch.randn(*s, dtype=torch.bfloat16) * 0.4)(Dm, Df) * (Dm ** -0.5)),
            "w_down": _w((lambda *s: torch.randn(*s, dtype=torch.bfloat16) * 0.4)(Df, Dm) * (Df ** -0.5)),
        }
    _B_in = _B_setup()

    return {
        "A_x": _A_in["x"],
        "A_k_cache": _A_in["k_cache"],
        "A_v_cache": _A_in["v_cache"],
        "A_wq": _A_in["wq"],
        "A_wo": _A_in["wo"],
        "B_x": _B_in["x"],
        "B_w_gate": _B_in["w_gate"],
        "B_w_up": _B_in["w_up"],
        "B_w_down": _B_in["w_down"],
    }

def reference(A_x, A_k_cache, A_v_cache, A_wq, A_wo, B_x, B_w_gate, B_w_up, B_w_down):
    def _A_ref(x, k_cache, v_cache, wq, wo):
        B, Sq, D = x.shape
        Hq, Dh = 32, 128
        Hkv = k_cache.shape[1]
        rep = Hq // Hkv
        q = (lambda x, *d: x.permute(*d))((x @ wq).reshape(B, Sq, Hq, Dh), 0, 2, 1, 3)
        k = (lambda x, n, axis: torch.repeat_interleave(x, n, dim=axis))(k_cache, rep, axis=1)
        v = (lambda x, n, axis: torch.repeat_interleave(x, n, dim=axis))(v_cache, rep, axis=1)
        scores = torch.einsum("bhqd,bhkd->bhqk", q, k) * (Dh ** -0.5)
        p = _softmax(scores, axis=-1)
        o = torch.einsum("bhqk,bhkd->bhqd", p, v)
        return (lambda x, *d: x.permute(*d))(o, 0, 2, 1, 3).reshape(B, Sq, Hq * Dh) @ wo

    def _B_ref(x, w_gate, w_up, w_down):
        g = torch.einsum("bsd,df->bsf", x, w_gate)
        u = torch.einsum("bsd,df->bsf", x, w_up)
        h = _gelu(g) * u
        return torch.einsum("bsf,fd->bsd", h, w_down)

    x = A_x
    x = x + _A_ref(_layernorm(x, axis=-1), A_k_cache, A_v_cache, A_wq, A_wo)
    x = x + _B_ref(_layernorm(x, axis=-1), B_w_gate, B_w_up, B_w_down)
    x = x + _A_ref(_layernorm(x, axis=-1), A_k_cache, A_v_cache, A_wq, A_wo)
    x = x + _B_ref(_layernorm(x, axis=-1), B_w_gate, B_w_up, B_w_down)
    return x
```

```asm
; @launch grid=(256,1,1) block=(256,1,1) lds=158720
.amdgcn_target "amdgcn-amd-amdhsa--gfx950"
.text
.globl interleave_layers__gqa_block_cached__glu_gated_geglu__decode_kernel
.p2align 8
.type interleave_layers__gqa_block_cached__glu_gated_geglu__decode_kernel,@function
interleave_layers__gqa_block_cached__glu_gated_geglu__decode_kernel:
    s_cmp_ge_u32 s2, 256
    s_cbranch_scc1 .Lend
    s_load_dwordx16 s[4:19], s[0:1], 0
    s_load_dwordx8 s[20:27], s[0:1], 64
    s_getpc_b64 s[98:99]
.Lpc:
    v_lshrrev_b32 v1, 6, v0
    v_subrev_u32 v2, 64, v0
    v_lshlrev_b32 v2, 7, v2
    v_readfirstlane_b32 s3, v1
    v_and_b32 v0, 63, v0
    s_getreg_b32 s85, hwreg(HW_REG_XCC_ID)
    s_cmp_eq_u32 s3, 0
    s_nop 1
    s_cbranch_scc1 .w0_2
    v_min_u32 v3, (.Lcode_end - .Lpc - 4), v2
    global_load_dword v4, v3, s[98:99]
    v_add_u32 v2, 0x6000, v2
    v_min_u32 v3, (.Lcode_end - .Lpc - 4), v2
    global_load_dword v5, v3, s[98:99]
    v_add_u32 v2, 0x6000, v2
    v_min_u32 v3, (.Lcode_end - .Lpc - 4), v2
    global_load_dword v5, v3, s[98:99]
    s_nop 0
    s_branch .idw_1
.w0_2:
.idw_1:
    v_and_b32 v62, 15, v0
    v_lshrrev_b32 v63, 4, v0
    s_lshr_b32 s72, s2, 4
    s_and_b32 s73, s2, 15
    s_lshl_b32 s60, s73, 4
    s_or_b32 s60, s60, s72
    s_mov_b32 s75, 0x3e0293ee
    s_mov_b32 s76, 0x05040100
    s_mov_b32 s77, 0x07060302
    s_mov_b32 s100, 0xffff0000
    s_mov_b32 s90, 0x00010001
    s_mov_b32 s91, 0x00010001
    s_lshl_b32 s78, s73, 2
    s_add_u32 s78, s78, s3
    s_add_u32 s78, s78, 1536
    s_lshl_b32 s78, s78, 13
    v_lshrrev_b32 v1, 1, v62
    v_lshlrev_b32 v1, 8, v1
    v_and_b32 v7, 1, v62
    v_lshl_add_u32 v1, v7, 6, v1
    v_lshl_add_u32 v1, v63, 4, v1
    v_lshlrev_b32 v2, 9, v63
    v_lshl_add_u32 v2, v62, 4, v2
    s_mul_i32 s81, s72, 0
    s_mul_i32 s61, s60, 57
    s_lshr_b32 s61, s61, 9
    s_mul_i32 s83, s61, 9
    s_sub_u32 s62, s60, s83
    s_sub_u32 s64, s61, 8
    s_mov_b32 s65, s62
    s_sub_u32 s63, s60, 144
    v_lshlrev_b32 v52, 4, v0
    s_waitcnt lgkmcnt(0)
    s_lshl_b32 s83, s72, 24
    s_add_u32 s28, s6, s83
    s_addc_u32 s29, s7, 0
    s_and_b32 s29, s29, 0xffff
    s_mov_b32 s30, 16777216
    s_mov_b32 s31, 0x00020000
    s_add_u32 s32, s8, s83
    s_addc_u32 s33, s9, 0
    s_and_b32 s33, s33, 0xffff
    s_mov_b32 s34, 16777216
    s_mov_b32 s35, 0x00020000
    s_mov_b32 s36, s26
    s_and_b32 s37, s27, 0xffff
    s_mov_b32 s38, 9175040
    s_mov_b32 s39, 0x00020000
    s_mov_b32 s40, s4
    s_and_b32 s41, s5, 0xffff
    s_mov_b32 s42, 1152
    s_mov_b32 s43, 0x00020000
    s_cmp_lg_u32 s3, 3
    s_cbranch_scc1 .nc_3
    v_mov_b32 v8, -1
    v_mov_b32 v9, -1
    v_mov_b32 v10, -1
    v_mov_b32 v11, -1
    s_lshl_b32 s83, s2, 11
    s_add_u32 s83, s83, 1835008
    buffer_store_dwordx4 v[8:11], v52, s[36:39], s83 offen offset:0 sc1
    buffer_store_dwordx4 v[8:11], v52, s[36:39], s83 offen offset:1024 sc1
    s_mul_i32 s83, s2, 7168
    buffer_store_dwordx4 v[8:11], v52, s[36:39], s83 offen offset:0 sc1
    buffer_store_dwordx4 v[8:11], v52, s[36:39], s83 offen offset:1024 sc1
    buffer_store_dwordx4 v[8:11], v52, s[36:39], s83 offen offset:2048 sc1
    buffer_store_dwordx4 v[8:11], v52, s[36:39], s83 offen offset:3072 sc1
    s_add_u32 s83, s83, 4096
    buffer_store_dwordx4 v[8:11], v52, s[36:39], s83 offen offset:0 sc1
    buffer_store_dwordx4 v[8:11], v52, s[36:39], s83 offen offset:1024 sc1
    buffer_store_dwordx4 v[8:11], v52, s[36:39], s83 offen offset:2048 sc1
    s_nop 1
.nc_3:
    s_cmp_ge_u32 s60, 64
    s_cbranch_scc1 .nE_4
    s_mov_b32 s52, s10
    s_and_b32 s53, s11, 0xffff
    s_mov_b32 s54, 4718592
    s_mov_b32 s55, 0x00020000
    v_lshlrev_b32 v58, 4, v0
    v_min_u32 v59, 2, v63
    v_lshlrev_b32 v59, 7, v59
    v_lshl_add_u32 v59, v62, 3, v59
    s_mul_i32 s84, s3, 384
    s_min_u32 s84, s84, 768
    buffer_load_dwordx2 v[56:57], v59, s[40:43], s84 offen
    v_bfe_u32 v10, v0, 1, 2
    v_bfe_u32 v8, v0, 4, 1
    v_xor_b32 v10, v10, v8
    v_lshlrev_b32 v10, 5, v10
    v_and_b32 v8, 1, v0
    v_lshl_add_u32 v10, v8, 4, v10
    v_lshrrev_b32 v8, 3, v0
    v_mul_u32_u24 v8, 8192, v8
    v_add_u32 v8, v8, v10
    v_xor_b32 v9, 64, v8
    s_lshl_b32 s66, s60, 7
    s_mul_i32 s83, s3, 1179648
    s_add_u32 s66, s66, s83
    s_mul_i32 s67, s3, 18432
    s_add_u32 s67, s67, 32768
    s_add_u32 m0, s67, 0
    s_nop 0
    buffer_load_dwordx4 v8, s[52:55], s66 offen nt lds
    s_add_u32 s66, s66, 65536
    s_add_u32 m0, s67, 1024
    s_nop 0
    buffer_load_dwordx4 v9, s[52:55], s66 offen nt lds
    s_add_u32 s66, s66, 65536
    s_add_u32 m0, s67, 2048
    s_nop 0
    buffer_load_dwordx4 v8, s[52:55], s66 offen nt lds
    s_add_u32 s66, s66, 65536
    s_add_u32 m0, s67, 3072
    s_nop 0
    buffer_load_dwordx4 v9, s[52:55], s66 offen nt lds
    s_add_u32 s66, s66, 65536
    s_add_u32 m0, s67, 4096
    s_nop 0
    buffer_load_dwordx4 v8, s[52:55], s66 offen nt lds
    s_add_u32 s66, s66, 65536
    s_add_u32 m0, s67, 5120
    s_nop 0
    buffer_load_dwordx4 v9, s[52:55], s66 offen nt lds
    s_add_u32 s66, s66, 65536
    s_add_u32 m0, s67, 6144
    s_nop 0
    buffer_load_dwordx4 v8, s[52:55], s66 offen nt lds
    s_add_u32 s66, s66, 65536
    s_add_u32 m0, s67, 7168
    s_nop 0
    buffer_load_dwordx4 v9, s[52:55], s66 offen nt lds
    s_add_u32 s66, s66, 65536
    s_add_u32 m0, s67, 8192
    s_nop 0
    buffer_load_dwordx4 v8, s[52:55], s66 offen nt lds
    s_add_u32 s66, s66, 65536
    s_add_u32 m0, s67, 9216
    s_nop 0
    buffer_load_dwordx4 v9, s[52:55], s66 offen nt lds
    s_add_u32 s66, s66, 65536
    s_add_u32 m0, s67, 10240
    s_nop 0
    buffer_load_dwordx4 v8, s[52:55], s66 offen nt lds
    s_add_u32 s66, s66, 65536
    s_add_u32 m0, s67, 11264
    s_nop 0
    buffer_load_dwordx4 v9, s[52:55], s66 offen nt lds
    s_add_u32 s66, s66, 65536
    s_add_u32 m0, s67, 12288
    s_nop 0
    buffer_load_dwordx4 v8, s[52:55], s66 offen nt lds
    s_add_u32 s66, s66, 65536
    s_add_u32 m0, s67, 13312
    s_nop 0
    buffer_load_dwordx4 v9, s[52:55], s66 offen nt lds
    s_add_u32 s66, s66, 65536
    s_add_u32 m0, s67, 14336
    s_nop 0
    buffer_load_dwordx4 v8, s[52:55], s66 offen nt lds
    s_add_u32 s66, s66, 65536
    s_add_u32 m0, s67, 15360
    s_nop 0
    buffer_load_dwordx4 v9, s[52:55], s66 offen nt lds
    s_add_u32 s66, s66, 65536
    s_add_u32 m0, s67, 16384
    s_nop 0
    buffer_load_dwordx4 v8, s[52:55], s66 offen nt lds
    s_add_u32 s66, s66, 65536
    s_add_u32 m0, s67, 17408
    s_nop 0
    buffer_load_dwordx4 v9, s[52:55], s66 offen nt lds
.nE_4:
    s_mov_b32 s79, s78
    s_add_u32 s80, s79, 4096
    buffer_load_dwordx4 a[0:3], v1, s[28:31], s79 offen offset:0 nt
    buffer_load_dwordx4 a[4:7], v1, s[28:31], s79 offen offset:128 nt
    buffer_load_dwordx4 a[8:11], v1, s[28:31], s79 offen offset:2048 nt
    buffer_load_dwordx4 a[12:15], v1, s[28:31], s79 offen offset:2176 nt
    buffer_load_dwordx4 a[16:19], v1, s[28:31], s80 offen offset:0 nt
    buffer_load_dwordx4 a[20:23], v1, s[28:31], s80 offen offset:128 nt
    buffer_load_dwordx4 a[24:27], v1, s[28:31], s80 offen offset:2048 nt
    buffer_load_dwordx4 a[28:31], v1, s[28:31], s80 offen offset:2176 nt
    s_mov_b32 s79, s78
    s_add_u32 s80, s79, 4096
    buffer_load_dwordx4 v[64:67], v2, s[32:35], s79 offen offset:0 nt
    buffer_load_dwordx4 v[68:71], v2, s[32:35], s79 offen offset:256 nt
    buffer_load_dwordx4 v[72:75], v2, s[32:35], s79 offen offset:2048 nt
    buffer_load_dwordx4 v[76:79], v2, s[32:35], s79 offen offset:2304 nt
    buffer_load_dwordx4 v[80:83], v2, s[32:35], s80 offen offset:0 nt
    buffer_load_dwordx4 v[84:87], v2, s[32:35], s80 offen offset:256 nt
    buffer_load_dwordx4 v[88:91], v2, s[32:35], s80 offen offset:2048 nt
    buffer_load_dwordx4 v[92:95], v2, s[32:35], s80 offen offset:2304 nt
    s_add_u32 s79, s78, 0x80000
    s_add_u32 s80, s79, 4096
    buffer_load_dwordx4 a[232:235], v1, s[28:31], s79 offen offset:0 nt
    buffer_load_dwordx4 a[236:239], v1, s[28:31], s79 offen offset:128 nt
    buffer_load_dwordx4 a[240:243], v1, s[28:31], s79 offen offset:2048 nt
    buffer_load_dwordx4 a[244:247], v1, s[28:31], s79 offen offset:2176 nt
    buffer_load_dwordx4 a[248:251], v1, s[28:31], s80 offen offset:0 nt
    buffer_load_dwordx4 a[252:255], v1, s[28:31], s80 offen offset:128 nt
    buffer_load_dwordx4 a[56:59], v1, s[28:31], s80 offen offset:2048 nt
    buffer_load_dwordx4 a[60:63], v1, s[28:31], s80 offen offset:2176 nt
    s_waitcnt vmcnt(24)
    s_add_u32 s79, s78, 0x80000
    s_add_u32 s80, s79, 4096
    buffer_load_dwordx4 v[96:99], v2, s[32:35], s79 offen offset:0 nt
    buffer_load_dwordx4 v[100:103], v2, s[32:35], s79 offen offset:256 nt
    buffer_load_dwordx4 v[104:107], v2, s[32:35], s79 offen offset:2048 nt
    buffer_load_dwordx4 v[108:111], v2, s[32:35], s79 offen offset:2304 nt
    buffer_load_dwordx4 v[112:115], v2, s[32:35], s80 offen offset:0 nt
    buffer_load_dwordx4 v[116:119], v2, s[32:35], s80 offen offset:256 nt
    buffer_load_dwordx4 v[120:123], v2, s[32:35], s80 offen offset:2048 nt
    buffer_load_dwordx4 v[124:127], v2, s[32:35], s80 offen offset:2304 nt
    s_mov_b32 s44, s22
    s_and_b32 s45, s23, 0xffff
    s_mov_b32 s46, 1152
    s_mov_b32 s47, 0x00020000
    s_mov_b32 s48, s24
    s_and_b32 s49, s25, 0xffff
    s_mov_b32 s50, 256
    s_mov_b32 s51, 0x00020000
    s_mov_b32 s52, s12
    s_and_b32 s53, s13, 0xffff
    s_mov_b32 s54, 4718592
    s_mov_b32 s55, 0x00020000
    s_mov_b32 s56, s20
    s_and_b32 s57, s21, 0xffff
    s_mov_b32 s58, 5308416
    s_mov_b32 s59, 0x00020000
    s_cmp_lt_u32 s60, 144
    s_cbranch_scc1 .isB_5
    s_mov_b32 s52, s16
    s_and_b32 s53, s17, 0xffff
    s_mov_b32 s54, 5308416
    s_mov_b32 s55, 0x00020000
    s_mov_b32 s56, s18
    s_and_b32 s57, s19, 0xffff
    s_mov_b32 s58, 5308416
    s_mov_b32 s59, 0x00020000
    s_mov_b32 s74, 73728
    s_lshl_b32 s66, s63, 7
    s_mul_i32 s83, s3, 1327104
    s_add_u32 s66, s66, s83
    s_mov_b32 s69, s66
    s_mul_i32 s67, s3, 18432
    s_add_u32 s70, s67, 73728
    s_cmp_lt_u32 s60, 216
    s_cselect_b32 s68, 9, 0
    s_mov_b32 s71, s68
    s_cselect_b32 s22, 10, 0
    s_branch .wj_6
.isB_5:
    s_mov_b32 s74, 9216
    s_mul_i32 s66, s61, 294912
    s_lshl_b32 s83, s62, 7
    s_add_u32 s66, s66, s83
    s_mul_i32 s84, s3, 73728
    s_add_u32 s66, s66, s84
    s_lshl_b32 s67, s3, 13
    s_mov_b32 s68, 4
    s_mul_i32 s69, s64, 663552
    s_add_u32 s69, s69, s83
    s_mul_i32 s84, s3, 165888
    s_add_u32 s69, s69, s84
    s_mul_i32 s70, s3, 18432
    s_add_u32 s70, s70, 32768
    s_cmp_ge_u32 s60, 72
    s_cselect_b32 s71, 9, 0
    s_cselect_b32 s22, 4, 0
    s_add_u32 s22, s22, s68
.wj_6:
    s_cmp_lg_u32 s3, 3
    s_cbranch_scc1 .nf_7
    s_waitcnt vmcnt(32)
    s_and_b32 s83, s2, 31
    s_lshl_b32 s83, 1, s83
    v_mov_b32 v8, s83
    s_lshr_b32 s83, s2, 5
    s_lshl_b32 s83, s83, 2
    s_mov_b64 exec, 1
    buffer_atomic_or v8, off, s[48:51], s83 offset:128 sc1
    s_mov_b64 exec, -1
.nf_7:
    s_cmp_ge_u32 s60, 64
    s_cbranch_scc1 .nE_8
    s_waitcnt vmcnt(32)
    s_cmp_eq_u32 s3, 3
    s_cbranch_scc1 .p3_9
    v_mov_b32 v12, v56
    v_mov_b32 v13, v57
    v_lshlrev_b32 v16, 16, v12
    v_and_b32 v17, s100, v12
    v_lshlrev_b32 v18, 16, v13
    v_and_b32 v19, s100, v13
    v_add_f32 v20, v16, v17
    v_mul_f32 v21, v16, v16
    v_add_f32 v20, v20, v18
    v_fmac_f32 v21, v17, v17
    v_add_f32 v20, v20, v19
    v_fmac_f32 v21, v18, v18
    v_fmac_f32 v21, v19, v19
    v_cmp_gt_u32 vcc, 48, v0
    s_nop 1
    v_cndmask_b32 v20, 0, v20, vcc
    v_cndmask_b32 v21, 0, v21, vcc
    s_nop 0
    v_add_f32_dpp v20, v20, v20 quad_perm:[1,0,3,2] row_mask:0xf bank_mask:0xf
    v_add_f32_dpp v21, v21, v21 quad_perm:[1,0,3,2] row_mask:0xf bank_mask:0xf
    s_nop 0
    v_add_f32_dpp v20, v20, v20 quad_perm:[2,3,0,1] row_mask:0xf bank_mask:0xf
    v_add_f32_dpp v21, v21, v21 quad_perm:[2,3,0,1] row_mask:0xf bank_mask:0xf
    s_nop 0
    v_add_f32_dpp v20, v20, v20 row_half_mirror row_mask:0xf bank_mask:0xf
    v_add_f32_dpp v21, v21, v21 row_half_mirror row_mask:0xf bank_mask:0xf
    s_nop 0
    v_add_f32_dpp v20, v20, v20 row_mirror row_mask:0xf bank_mask:0xf
    v_add_f32_dpp v21, v21, v21 row_mirror row_mask:0xf bank_mask:0xf
    v_mov_b32 v22, v20
    v_mov_b32 v23, v21
    s_nop 0
    v_permlane16_swap_b32 v20, v22
    v_permlane16_swap_b32 v21, v23
    v_add_f32 v20, v20, v22
    v_add_f32 v21, v21, v23
    v_mov_b32 v22, v20
    v_mov_b32 v23, v21
    s_nop 0
    v_permlane32_swap_b32 v20, v22
    v_permlane32_swap_b32 v21, v23
    v_add_f32 v20, v20, v22
    v_add_f32 v21, v21, v23
    s_lshl_b32 s83, s3, 3
    s_add_u32 s83, s83, 154368
    v_mov_b32 v22, s83
    v_mov_b32 v23, 154368
    s_mov_b64 exec, 1
    ds_write_b64 v22, v[20:21]
    s_mov_b64 exec, -1
    s_mul_i32 s83, s3, 384
    s_add_u32 s83, s83, 147456
    v_add_u32 v59, s83, v59
    s_waitcnt lgkmcnt(0)
    s_barrier
    ds_read_b128 v[24:27], v23
    ds_read_b64 v[28:29], v23 offset:16
    s_waitcnt lgkmcnt(0)
    v_pk_add_f32 v[24:25], v[24:25], v[26:27]
    v_pk_add_f32 v[24:25], v[24:25], v[28:29]
    v_mul_f32 v24, 0x3ae38e39, v24
    v_mul_f32 v25, 0x3ae38e39, v25
    v_fma_f32 v25, -v24, v24, v25
    v_max_f32 v25, 0, v25
    v_cvt_pk_bf16_f32 v25, v25, v25
    v_lshlrev_b32 v25, 16, v25
    v_add_f32 v25, 0x3727c5ac, v25
    v_cvt_pk_bf16_f32 v25, v25, v25
    v_lshlrev_b32 v25, 16, v25
    v_sqrt_f32 v25, v25
    s_nop 0
    v_cvt_pk_bf16_f32 v25, v25, v25
    v_lshlrev_b32 v25, 16, v25
    v_rcp_f32 v25, v25
    v_cvt_pk_bf16_f32 v24, v24, v24
    v_lshlrev_b32 v24, 16, v24
    v_sub_f32 v16, v16, v24
    v_sub_f32 v17, v17, v24
    v_sub_f32 v18, v18, v24
    v_sub_f32 v19, v19, v24
    v_cvt_pk_bf16_f32 v12, v16, v17
    v_cvt_pk_bf16_f32 v13, v18, v19
    v_lshlrev_b32 v16, 16, v12
    v_and_b32 v17, s100, v12
    v_lshlrev_b32 v18, 16, v13
    v_and_b32 v19, s100, v13
    v_mul_f32 v16, v16, v25
    v_mul_f32 v17, v17, v25
    v_mul_f32 v18, v18, v25
    v_mul_f32 v19, v19, v25
    v_cvt_pk_bf16_f32 v12, v16, v17
    v_cvt_pk_bf16_f32 v13, v18, v19
    s_mov_b32 exec_lo, 0xffffffff
    s_mov_b32 exec_hi, 0xffff
    ds_write_b64 v59, v[12:13]
    s_mov_b64 exec, -1
    s_waitcnt lgkmcnt(0)
    s_barrier
    s_branch .pj_10
.p3_9:
    s_barrier
    s_barrier
.pj_10:
    v_bfe_u32 v28, v62, 3, 1
    v_and_b32 v24, 1, v63
    v_lshl_or_b32 v28, v24, 1, v28
    v_xor_b32 v28, s3, v28
    v_lshlrev_b32 v28, 5, v28
    v_and_b32 v24, 3, v62
    v_lshl_add_u32 v28, v24, 3, v28
    v_lshrrev_b32 v24, 2, v62
    v_lshl_add_u32 v24, v63, 3, v24
    v_lshl_add_u32 v24, v24, 7, v28
    v_add_u32 v25, 0x10000, v24
    ds_read_b64_tr_b16 a[192:193], v24 offset:32768
    ds_read_b64_tr_b16 a[194:195], v24 offset:33280
    ds_read_b64_tr_b16 a[196:197], v24 offset:36864
    ds_read_b64_tr_b16 a[198:199], v24 offset:37376
    ds_read_b64_tr_b16 a[200:201], v24 offset:40960
    ds_read_b64_tr_b16 a[202:203], v24 offset:41472
    ds_read_b64_tr_b16 a[204:205], v24 offset:45056
    ds_read_b64_tr_b16 a[206:207], v24 offset:45568
    ds_read_b64_tr_b16 a[208:209], v24 offset:49152
    ds_read_b64_tr_b16 a[210:211], v24 offset:49664
    ds_read_b64_tr_b16 a[212:213], v24 offset:53248
    ds_read_b64_tr_b16 a[214:215], v24 offset:53760
    ds_read_b64_tr_b16 a[216:217], v24 offset:57344
    ds_read_b64_tr_b16 a[218:219], v24 offset:57856
    ds_read_b64_tr_b16 a[220:221], v24 offset:61440
    ds_read_b64_tr_b16 a[222:223], v24 offset:61952
    ds_read_b64_tr_b16 a[224:225], v25 offset:0
    ds_read_b64_tr_b16 a[226:227], v25 offset:512
    ds_read_b64_tr_b16 a[228:229], v25 offset:4096
    ds_read_b64_tr_b16 a[230:231], v25 offset:4608
    v_bfe_u32 v28, v62, 3, 1
    v_and_b32 v24, 1, v63
    v_lshl_or_b32 v28, v24, 1, v28
    v_xor_b32 v28, s3, v28
    v_lshlrev_b32 v28, 5, v28
    v_and_b32 v24, 3, v62
    v_lshl_add_u32 v28, v24, 3, v28
    v_lshrrev_b32 v24, 2, v62
    v_lshl_add_u32 v24, v63, 3, v24
    v_lshl_add_u32 v24, v24, 7, v28
    v_add_u32 v25, 0x10000, v24
    v_lshlrev_b32 v27, 4, v63
    v_add_u32 v27, 147456, v27
    s_lshr_b32 s4, s60, 2
    s_lshl_b32 s4, s4, 15
    s_and_b32 s83, s60, 3
    s_lshl_b32 s83, s83, 7
    s_add_u32 s4, s4, s83
    s_lshl_b32 s83, s3, 5
    s_add_u32 s4, s4, s83
    s_add_u32 s4, s4, 1835008
    v_lshlrev_b32 v28, 11, v62
    v_lshl_add_u32 v28, v63, 3, v28
    s_waitcnt lgkmcnt(0)
    ds_read_b128 v[2:5], v27 offset:0
    ds_read_b128 v[16:19], v27 offset:64
    ds_read_b128 v[20:23], v27 offset:128
    ds_read_b128 v[56:59], v27 offset:192
    s_waitcnt lgkmcnt(3)
    v_mfma_f32_16x16x32_bf16 v[8:11], a[192:195], v[2:5], 0
    ds_read_b64_tr_b16 a[192:193], v25 offset:8192
    ds_read_b64_tr_b16 a[194:195], v25 offset:8704
    ds_read_b128 v[2:5], v27 offset:256
    s_waitcnt lgkmcnt(5)
    v_mfma_f32_16x16x32_bf16 v[8:11], a[196:199], v[16:19], v[8:11]
    ds_read_b64_tr_b16 a[196:197], v25 offset:12288
    ds_read_b64_tr_b16 a[198:199], v25 offset:12800
    ds_read_b128 v[16:19], v27 offset:320
    s_waitcnt lgkmcnt(7)
    v_mfma_f32_16x16x32_bf16 v[8:11], a[200:203], v[20:23], v[8:11]
    ds_read_b64_tr_b16 a[200:201], v25 offset:16384
    ds_read_b64_tr_b16 a[202:203], v25 offset:16896
    ds_read_b128 v[20:23], v27 offset:384
    s_waitcnt lgkmcnt(9)
    v_mfma_f32_16x16x32_bf16 v[8:11], a[204:207], v[56:59], v[8:11]
    ds_read_b64_tr_b16 a[204:205], v25 offset:20480
    ds_read_b64_tr_b16 a[206:207], v25 offset:20992
    ds_read_b128 v[56:59], v27 offset:448
    s_waitcnt lgkmcnt(9)
    v_mfma_f32_16x16x32_bf16 v[8:11], a[208:211], v[2:5], v[8:11]
    ds_read_b64_tr_b16 a[208:209], v25 offset:24576
    ds_read_b64_tr_b16 a[210:211], v25 offset:25088
    ds_read_b128 v[2:5], v27 offset:512
    s_waitcnt lgkmcnt(9)
    v_mfma_f32_16x16x32_bf16 v[8:11], a[212:215], v[16:19], v[8:11]
    ds_read_b64_tr_b16 a[212:213], v25 offset:28672
    ds_read_b64_tr_b16 a[214:215], v25 offset:29184
    ds_read_b128 v[16:19], v27 offset:576
    s_waitcnt lgkmcnt(9)
    v_mfma_f32_16x16x32_bf16 v[8:11], a[216:219], v[20:23], v[8:11]
    ds_read_b64_tr_b16 a[216:217], v25 offset:32768
    ds_read_b64_tr_b16 a[218:219], v25 offset:33280
    ds_read_b128 v[20:23], v27 offset:640
    s_waitcnt lgkmcnt(9)
    v_mfma_f32_16x16x32_bf16 v[8:11], a[220:223], v[56:59], v[8:11]
    ds_read_b64_tr_b16 a[220:221], v25 offset:36864
    ds_read_b64_tr_b16 a[222:223], v25 offset:37376
    ds_read_b128 v[56:59], v27 offset:704
    s_waitcnt lgkmcnt(9)
    v_mfma_f32_16x16x32_bf16 v[8:11], a[224:227], v[2:5], v[8:11]
    ds_read_b128 v[2:5], v27 offset:768
    s_waitcnt lgkmcnt(7)
    v_mfma_f32_16x16x32_bf16 v[8:11], a[228:231], v[16:19], v[8:11]
    ds_read_b128 v[16:19], v27 offset:832
    s_waitcnt lgkmcnt(5)
    v_mfma_f32_16x16x32_bf16 v[8:11], a[192:195], v[20:23], v[8:11]
    ds_read_b128 v[20:23], v27 offset:896
    s_waitcnt lgkmcnt(3)
    v_mfma_f32_16x16x32_bf16 v[8:11], a[196:199], v[56:59], v[8:11]
    ds_read_b128 v[56:59], v27 offset:960
    s_waitcnt lgkmcnt(3)
    v_mfma_f32_16x16x32_bf16 v[8:11], a[200:203], v[2:5], v[8:11]
    ds_read_b128 v[2:5], v27 offset:1024
    s_waitcnt lgkmcnt(3)
    v_mfma_f32_16x16x32_bf16 v[8:11], a[204:207], v[16:19], v[8:11]
    ds_read_b128 v[16:19], v27 offset:1088
    s_waitcnt lgkmcnt(3)
    v_mfma_f32_16x16x32_bf16 v[8:11], a[208:211], v[20:23], v[8:11]
    s_waitcnt lgkmcnt(2)
    v_mfma_f32_16x16x32_bf16 v[8:11], a[212:215], v[56:59], v[8:11]
    s_waitcnt lgkmcnt(1)
    v_mfma_f32_16x16x32_bf16 v[8:11], a[216:219], v[2:5], v[8:11]
    s_waitcnt lgkmcnt(0)
    v_mfma_f32_16x16x32_bf16 v[8:11], a[220:223], v[16:19], v[8:11]
    s_nop 7
    v_cvt_pk_bf16_f32 v18, v8, v9
    v_cvt_pk_bf16_f32 v19, v10, v11
    s_cmp_lg_u32 s3, 3
    s_nop 0
    s_cbranch_scc1 .nf3_11
    s_lshr_b32 s83, s60, 2
    s_lshl_b32 s83, s83, 1
    s_mov_b32 s88, 200000
.fl_12:
    s_mov_b64 exec, 1
    buffer_load_ushort v20, off, s[48:51], s83 offset:128 sc1
    s_waitcnt vmcnt(0)
    v_cmp_ne_u32 vcc, 0xffff, v20
    s_mov_b64 exec, -1
    s_nop 3
    s_cbranch_vccz .fld_13
    s_sleep 4
    s_sub_u32 s88, s88, 1
    s_cmp_lg_u32 s88, 0
    s_cbranch_scc1 .fl_12
.fld_13:
.nf3_11:
    s_barrier
    buffer_store_dwordx2 v[18:19], v28, s[36:39], s4 offen sc1
    v_lshrrev_b32 v1, 1, v62
    v_lshlrev_b32 v1, 8, v1
    v_and_b32 v7, 1, v62
    v_lshl_add_u32 v1, v7, 6, v1
    v_lshl_add_u32 v1, v63, 4, v1
    v_lshlrev_b32 v2, 9, v63
    v_lshl_add_u32 v2, v62, 4, v2
    s_nop 1
.nE_8:
    s_lshr_b32 s83, s74, 3
    v_bfe_u32 v10, v0, 1, 2
    v_bfe_u32 v58, v0, 4, 1
    v_xor_b32 v10, v10, v58
    v_lshlrev_b32 v10, 5, v10
    v_and_b32 v58, 1, v0
    v_lshl_add_u32 v10, v58, 4, v10
    v_lshrrev_b32 v58, 3, v0
    v_mul_u32_u24 v58, s83, v58
    v_add_u32 v58, v58, v10
    v_xor_b32 v59, 64, v58
    v_lshrrev_b32 v60, 1, v62
    v_and_b32 v60, 1, v60
    v_lshlrev_b32 v60, 8, v60
    v_and_b32 v24, 1, v62
    v_lshl_add_u32 v60, v24, 6, v60
    v_lshl_add_u32 v60, v63, 4, v60
    s_waitcnt vmcnt(24)
    s_add_u32 s79, s78, 0x180000
    s_add_u32 s80, s79, 4096
    buffer_load_dwordx4 a[64:67], v1, s[28:31], s79 offen offset:0 nt
    buffer_load_dwordx4 a[68:71], v1, s[28:31], s79 offen offset:128 nt
    buffer_load_dwordx4 a[72:75], v1, s[28:31], s79 offen offset:2048 nt
    buffer_load_dwordx4 a[76:79], v1, s[28:31], s79 offen offset:2176 nt
    buffer_load_dwordx4 a[80:83], v1, s[28:31], s80 offen offset:0 nt
    buffer_load_dwordx4 a[84:87], v1, s[28:31], s80 offen offset:128 nt
    buffer_load_dwordx4 a[88:91], v1, s[28:31], s80 offen offset:2048 nt
    buffer_load_dwordx4 a[92:95], v1, s[28:31], s80 offen offset:2176 nt
    s_waitcnt vmcnt(24)
    s_add_u32 s79, s78, 0x180000
    s_add_u32 s80, s79, 4096
    buffer_load_dwordx4 v[128:131], v2, s[32:35], s79 offen offset:0 nt
    buffer_load_dwordx4 v[132:135], v2, s[32:35], s79 offen offset:256 nt
    buffer_load_dwordx4 v[136:139], v2, s[32:35], s79 offen offset:2048 nt
    buffer_load_dwordx4 v[140:143], v2, s[32:35], s79 offen offset:2304 nt
    buffer_load_dwordx4 v[144:147], v2, s[32:35], s80 offen offset:0 nt
    buffer_load_dwordx4 v[148:151], v2, s[32:35], s80 offen offset:256 nt
    buffer_load_dwordx4 v[152:155], v2, s[32:35], s80 offen offset:2048 nt
    buffer_load_dwordx4 v[156:159], v2, s[32:35], s80 offen offset:2304 nt
    s_waitcnt vmcnt(24)
    s_add_u32 s79, s78, 0x200000
    s_add_u32 s80, s79, 4096
    buffer_load_dwordx4 a[96:99], v1, s[28:31], s79 offen offset:0 nt
    buffer_load_dwordx4 a[100:103], v1, s[28:31], s79 offen offset:128 nt
    buffer_load_dwordx4 a[104:107], v1, s[28:31], s79 offen offset:2048 nt
    buffer_load_dwordx4 a[108:111], v1, s[28:31], s79 offen offset:2176 nt
    buffer_load_dwordx4 a[112:115], v1, s[28:31], s80 offen offset:0 nt
    buffer_load_dwordx4 a[116:119], v1, s[28:31], s80 offen offset:128 nt
    buffer_load_dwordx4 a[120:123], v1, s[28:31], s80 offen offset:2048 nt
    buffer_load_dwordx4 a[124:127], v1, s[28:31], s80 offen offset:2176 nt
    s_waitcnt vmcnt(24)
    s_add_u32 s79, s78, 0x200000
    s_add_u32 s80, s79, 4096
    buffer_load_dwordx4 v[160:163], v2, s[32:35], s79 offen offset:0 nt
    buffer_load_dwordx4 v[164:167], v2, s[32:35], s79 offen offset:256 nt
    buffer_load_dwordx4 v[168:171], v2, s[32:35], s79 offen offset:2048 nt
    buffer_load_dwordx4 v[172:175], v2, s[32:35], s79 offen offset:2304 nt
    buffer_load_dwordx4 v[176:179], v2, s[32:35], s80 offen offset:0 nt
    buffer_load_dwordx4 v[180:183], v2, s[32:35], s80 offen offset:256 nt
    buffer_load_dwordx4 v[184:187], v2, s[32:35], s80 offen offset:2048 nt
    buffer_load_dwordx4 v[188:191], v2, s[32:35], s80 offen offset:2304 nt
    s_waitcnt vmcnt(24)
    s_add_u32 s79, s78, 0x280000
    s_add_u32 s80, s79, 4096
    buffer_load_dwordx4 a[128:131], v1, s[28:31], s79 offen offset:0 nt
    buffer_load_dwordx4 a[132:135], v1, s[28:31], s79 offen offset:128 nt
    buffer_load_dwordx4 a[136:139], v1, s[28:31], s79 offen offset:2048 nt
    buffer_load_dwordx4 a[140:143], v1, s[28:31], s79 offen offset:2176 nt
    buffer_load_dwordx4 a[144:147], v1, s[28:31], s80 offen offset:0 nt
    buffer_load_dwordx4 a[148:151], v1, s[28:31], s80 offen offset:128 nt
    buffer_load_dwordx4 a[152:155], v1, s[28:31], s80 offen offset:2048 nt
    buffer_load_dwordx4 a[156:159], v1, s[28:31], s80 offen offset:2176 nt
    s_waitcnt vmcnt(24)
    s_add_u32 s79, s78, 0x280000
    s_add_u32 s80, s79, 4096
    buffer_load_dwordx4 v[192:195], v2, s[32:35], s79 offen offset:0 nt
    buffer_load_dwordx4 v[196:199], v2, s[32:35], s79 offen offset:256 nt
    buffer_load_dwordx4 v[200:203], v2, s[32:35], s79 offen offset:2048 nt
    buffer_load_dwordx4 v[204:207], v2, s[32:35], s79 offen offset:2304 nt
    buffer_load_dwordx4 v[208:211], v2, s[32:35], s80 offen offset:0 nt
    buffer_load_dwordx4 v[212:215], v2, s[32:35], s80 offen offset:256 nt
    buffer_load_dwordx4 v[216:219], v2, s[32:35], s80 offen offset:2048 nt
    buffer_load_dwordx4 v[220:223], v2, s[32:35], s80 offen offset:2304 nt
    s_lshl_b32 s83, s2, 11
    s_add_u32 s83, s83, 1835008
    buffer_load_dwordx4 a[32:35], v60, s[36:39], s83 offen sc1
    buffer_load_dwordx4 a[36:39], v60, s[36:39], s83 offen offset:128 sc1
    s_waitcnt vmcnt(26)
    s_add_u32 s79, s78, 0x300000
    s_add_u32 s80, s79, 4096
    buffer_load_dwordx4 a[160:163], v1, s[28:31], s79 offen offset:0 nt
    buffer_load_dwordx4 a[164:167], v1, s[28:31], s79 offen offset:128 nt
    buffer_load_dwordx4 a[168:171], v1, s[28:31], s79 offen offset:2048 nt
    buffer_load_dwordx4 a[172:175], v1, s[28:31], s79 offen offset:2176 nt
    buffer_load_dwordx4 a[176:179], v1, s[28:31], s80 offen offset:0 nt
    buffer_load_dwordx4 a[180:183], v1, s[28:31], s80 offen offset:128 nt
    buffer_load_dwordx4 a[184:187], v1, s[28:31], s80 offen offset:2048 nt
    buffer_load_dwordx4 a[188:191], v1, s[28:31], s80 offen offset:2176 nt
    s_lshl_b32 s83, s2, 11
    s_add_u32 s83, s83, 1835008
    buffer_load_dwordx4 a[40:43], v60, s[36:39], s83 offen sc1
    buffer_load_dwordx4 a[44:47], v60, s[36:39], s83 offen offset:128 sc1
    s_waitcnt vmcnt(28)
    s_add_u32 s79, s78, 0x300000
    s_add_u32 s80, s79, 4096
    buffer_load_dwordx4 v[224:227], v2, s[32:35], s79 offen offset:0 nt
    buffer_load_dwordx4 v[228:231], v2, s[32:35], s79 offen offset:256 nt
    buffer_load_dwordx4 v[232:235], v2, s[32:35], s79 offen offset:2048 nt
    buffer_load_dwordx4 v[236:239], v2, s[32:35], s79 offen offset:2304 nt
    buffer_load_dwordx4 v[240:243], v2, s[32:35], s80 offen offset:0 nt
    buffer_load_dwordx4 v[244:247], v2, s[32:35], s80 offen offset:256 nt
    buffer_load_dwordx4 v[248:251], v2, s[32:35], s80 offen offset:2048 nt
    buffer_load_dwordx4 v[252:255], v2, s[32:35], s80 offen offset:2304 nt
    s_lshl_b32 s83, s2, 11
    s_add_u32 s83, s83, 1835008
    buffer_load_dwordx4 a[48:51], v60, s[36:39], s83 offen sc1
    buffer_load_dwordx4 a[52:55], v60, s[36:39], s83 offen offset:128 sc1
    s_waitcnt vmcnt(20)
    v_accvgpr_read_b32 v16, a32
    v_accvgpr_read_b32 v17, a33
    v_accvgpr_read_b32 v18, a34
    v_accvgpr_read_b32 v19, a35
    v_accvgpr_read_b32 v20, a36
    v_accvgpr_read_b32 v21, a37
    v_accvgpr_read_b32 v22, a38
    v_accvgpr_read_b32 v23, a39
    v_max3_u32 v8, v16, v17, v18
    v_max3_u32 v9, v19, v20, v21
    v_max3_u32 v8, v8, v22, v23
    v_max_u32 v8, v8, v9
    v_cmp_eq_u32 vcc, -1, v8
    s_nop 4
    s_cbranch_vccnz .qb_15
    v_accvgpr_write_b32 a224, v16
    v_accvgpr_write_b32 a225, v17
    v_accvgpr_write_b32 a226, v18
    v_accvgpr_write_b32 a227, v19
    v_accvgpr_write_b32 a228, v20
    v_accvgpr_write_b32 a229, v21
    v_accvgpr_write_b32 a230, v22
    v_accvgpr_write_b32 a231, v23
    s_nop 1
    s_branch .qok_14
.qb_15:
    s_waitcnt vmcnt(10)
    v_accvgpr_read_b32 v16, a40
    v_accvgpr_read_b32 v17, a41
    v_accvgpr_read_b32 v18, a42
    v_accvgpr_read_b32 v19, a43
    v_accvgpr_read_b32 v20, a44
    v_accvgpr_read_b32 v21, a45
    v_accvgpr_read_b32 v22, a46
    v_accvgpr_read_b32 v23, a47
    v_max3_u32 v8, v16, v17, v18
    v_max3_u32 v9, v19, v20, v21
    v_max3_u32 v8, v8, v22, v23
    v_max_u32 v8, v8, v9
    v_cmp_eq_u32 vcc, -1, v8
    s_nop 4
    s_cbranch_vccnz .qb_16
    v_accvgpr_write_b32 a224, v16
    v_accvgpr_write_b32 a225, v17
    v_accvgpr_write_b32 a226, v18
    v_accvgpr_write_b32 a227, v19
    v_accvgpr_write_b32 a228, v20
    v_accvgpr_write_b32 a229, v21
    v_accvgpr_write_b32 a230, v22
    v_accvgpr_write_b32 a231, v23
    s_nop 1
    s_branch .qok_14
.qb_16:
    s_waitcnt vmcnt(0)
    v_accvgpr_read_b32 v16, a48
    v_accvgpr_read_b32 v17, a49
    v_accvgpr_read_b32 v18, a50
    v_accvgpr_read_b32 v19, a51
    v_accvgpr_read_b32 v20, a52
    v_accvgpr_read_b32 v21, a53
    v_accvgpr_read_b32 v22, a54
    v_accvgpr_read_b32 v23, a55
    v_max3_u32 v8, v16, v17, v18
    v_max3_u32 v9, v19, v20, v21
    v_max3_u32 v8, v8, v22, v23
    v_max_u32 v8, v8, v9
    v_cmp_eq_u32 vcc, -1, v8
    s_nop 4
    s_cbranch_vccnz .qb_17
    v_accvgpr_write_b32 a224, v16
    v_accvgpr_write_b32 a225, v17
    v_accvgpr_write_b32 a226, v18
    v_accvgpr_write_b32 a227, v19
    v_accvgpr_write_b32 a228, v20
    v_accvgpr_write_b32 a229, v21
    v_accvgpr_write_b32 a230, v22
    v_accvgpr_write_b32 a231, v23
    s_nop 1
    s_branch .qok_14
.qb_17:
    s_mov_b32 s88, 200000
.qw_18:
    s_lshl_b32 s83, s2, 11
    s_add_u32 s83, s83, 1835008
    buffer_load_dwordx4 v[16:19], v60, s[36:39], s83 offen sc1
    buffer_load_dwordx4 v[20:23], v60, s[36:39], s83 offen offset:128 sc1
    s_waitcnt vmcnt(0)
    v_max3_u32 v8, v16, v17, v18
    v_max3_u32 v9, v19, v20, v21
    v_max3_u32 v8, v8, v22, v23
    v_max_u32 v8, v8, v9
    v_cmp_eq_u32 vcc, -1, v8
    s_nop 4
    s_cbranch_vccnz .qwb_20
    v_accvgpr_write_b32 a224, v16
    v_accvgpr_write_b32 a225, v17
    v_accvgpr_write_b32 a226, v18
    v_accvgpr_write_b32 a227, v19
    v_accvgpr_write_b32 a228, v20
    v_accvgpr_write_b32 a229, v21
    v_accvgpr_write_b32 a230, v22
    v_accvgpr_write_b32 a231, v23
    s_nop 1
    s_branch .qwd_19
.qwb_20:
    s_sleep 2
    s_sub_u32 s88, s88, 1
    s_cmp_lg_u32 s88, 0
    s_cbranch_scc1 .qw_18
.qwd_19:
.qok_14:
    s_cmp_lg_u32 s3, 0
    s_cbranch_scc1 .nfl_21
    v_and_b32 v54, 7, v0
    v_lshlrev_b32 v54, 2, v54
    buffer_load_dword v57, v54, s[48:51], 0 offen offset:128 sc1
    s_nop 0
.nfl_21:
    v_accvgpr_write_b32 a192, 0
    v_accvgpr_write_b32 a193, 0
    v_accvgpr_write_b32 a194, 0
    v_accvgpr_write_b32 a195, 0
    v_accvgpr_write_b32 a196, 0
    v_accvgpr_write_b32 a197, 0
    v_accvgpr_write_b32 a198, 0
    v_accvgpr_write_b32 a199, 0
    v_accvgpr_write_b32 a200, 0
    v_accvgpr_write_b32 a201, 0
    v_accvgpr_write_b32 a202, 0
    v_accvgpr_write_b32 a203, 0
    v_accvgpr_write_b32 a204, 0
    v_accvgpr_write_b32 a205, 0
    v_accvgpr_write_b32 a206, 0
    v_accvgpr_write_b32 a207, 0
    v_accvgpr_write_b32 a208, 0
    v_accvgpr_write_b32 a209, 0
    v_accvgpr_write_b32 a210, 0
    v_accvgpr_write_b32 a211, 0
    v_accvgpr_write_b32 a212, 0
    v_accvgpr_write_b32 a213, 0
    v_accvgpr_write_b32 a214, 0
    v_accvgpr_write_b32 a215, 0
    v_accvgpr_write_b32 a216, 0
    v_accvgpr_write_b32 a217, 0
    v_accvgpr_write_b32 a218, 0
    v_accvgpr_write_b32 a219, 0
    v_accvgpr_write_b32 a220, 0
    v_accvgpr_write_b32 a221, 0
    v_accvgpr_write_b32 a222, 0
    v_accvgpr_write_b32 a223, 0
    v_mov_b32 v5, 0
    v_mov_b32 v6, 0xf149f2ca
    v_mov_b32 v4, 0xf149f2ca
    v_mov_b32 v3, 0
    v_and_b32 v7, 1, v0
    v_cmp_eq_u32 vcc, 1, v7
    v_mov_b32 v7, 0x7f800000
    s_nop 0
    v_cndmask_b32 v4, v4, v7, vcc
    s_lshl_b32 s82, s72, 15
    s_add_u32 s82, s82, 1836032
    s_mov_b32 s20, -2
    s_mov_b32 s21, -2
    v_mfma_f32_16x16x32_bf16 v[16:19], a[232:235], a[224:227], 0
    v_mfma_f32_16x16x32_bf16 v[20:23], a[240:243], a[224:227], 0
    v_mfma_f32_16x16x32_bf16 v[24:27], a[248:251], a[224:227], 0
    v_mfma_f32_16x16x32_bf16 v[28:31], a[56:59], a[224:227], 0
    v_mfma_f32_16x16x32_bf16 v[16:19], a[236:239], a[228:231], v[16:19]
    v_mfma_f32_16x16x32_bf16 v[20:23], a[244:247], a[228:231], v[20:23]
    v_mfma_f32_16x16x32_bf16 v[24:27], a[252:255], a[228:231], v[24:27]
    v_mfma_f32_16x16x32_bf16 v[28:31], a[60:63], a[228:231], v[28:31]
    s_add_u32 s79, s78, 0x100000
    s_add_u32 s80, s79, 4096
    buffer_load_dwordx4 a[32:35], v1, s[28:31], s79 offen offset:0 nt
    buffer_load_dwordx4 a[36:39], v1, s[28:31], s79 offen offset:128 nt
    buffer_load_dwordx4 a[40:43], v1, s[28:31], s79 offen offset:2048 nt
    buffer_load_dwordx4 a[44:47], v1, s[28:31], s79 offen offset:2176 nt
    buffer_load_dwordx4 a[48:51], v1, s[28:31], s80 offen offset:0 nt
    buffer_load_dwordx4 a[52:55], v1, s[28:31], s80 offen offset:128 nt
    buffer_load_dwordx4 a[56:59], v1, s[28:31], s80 offen offset:2048 nt
    buffer_load_dwordx4 a[60:63], v1, s[28:31], s80 offen offset:2176 nt
    v_add_f32_dpp v8, v17, v16 quad_perm:[1,0,3,2] row_mask:0xf bank_mask:0xf
    v_add_f32_dpp v9, v19, v18 quad_perm:[1,0,3,2] row_mask:0xf bank_mask:0xf
    v_add_f32_dpp v10, v21, v20 quad_perm:[1,0,3,2] row_mask:0xf bank_mask:0xf
    v_add_f32_dpp v11, v23, v22 quad_perm:[1,0,3,2] row_mask:0xf bank_mask:0xf
    v_add_f32_dpp v12, v25, v24 quad_perm:[1,0,3,2] row_mask:0xf bank_mask:0xf
    v_add_f32_dpp v13, v27, v26 quad_perm:[1,0,3,2] row_mask:0xf bank_mask:0xf
    v_add_f32_dpp v14, v29, v28 quad_perm:[1,0,3,2] row_mask:0xf bank_mask:0xf
    v_add_f32_dpp v15, v31, v30 quad_perm:[1,0,3,2] row_mask:0xf bank_mask:0xf
    v_max3_f32 v7, v8, v9, v10
    v_max3_f32 v7, v7, v11, v12
    v_max3_f32 v7, v7, v13, v14
    v_max_f32 v7, v7, v15
    v_cmp_gt_f32 vcc, v7, v4
    s_nop 4
    s_cbranch_vccz .noresc_22
    s_call_b64 s[94:95], .Lresc
.noresc_22:
    v_fma_f32 v8, v8, s75, -v3
    v_fma_f32 v9, v9, s75, -v3
    v_fma_f32 v10, v10, s75, -v3
    v_fma_f32 v11, v11, s75, -v3
    v_fma_f32 v12, v12, s75, -v3
    v_fma_f32 v13, v13, s75, -v3
    v_fma_f32 v14, v14, s75, -v3
    v_fma_f32 v15, v15, s75, -v3
    v_exp_f32 v8, v8
    v_exp_f32 v9, v9
    v_exp_f32 v10, v10
    v_exp_f32 v11, v11
    v_exp_f32 v12, v12
    v_exp_f32 v13, v13
    v_exp_f32 v14, v14
    v_exp_f32 v15, v15
    v_cvt_pk_bf16_f32 v32, v8, v9
    v_cvt_pk_bf16_f32 v33, v10, v11
    v_cvt_pk_bf16_f32 v34, v12, v13
    v_cvt_pk_bf16_f32 v35, v14, v15
    v_add_f32 v8, v8, v9
    v_add_f32 v10, v10, v11
    v_add_f32 v12, v12, v13
    v_add_f32 v14, v14, v15
    v_add_f32 v8, v8, v10
    v_add_f32 v12, v12, v14
    v_add_f32 v5, v5, v8
    v_add_f32 v5, v5, v12
    v_perm_b32 v36, v100, v96, s76
    v_perm_b32 v37, v108, v104, s76
    v_perm_b32 v38, v116, v112, s76
    v_perm_b32 v39, v124, v120, s76
    v_perm_b32 v40, v100, v96, s77
    v_perm_b32 v41, v108, v104, s77
    v_perm_b32 v42, v116, v112, s77
    v_perm_b32 v43, v124, v120, s77
    v_mfma_f32_16x16x32_bf16 a[192:195], v[36:39], v[32:35], a[192:195]
    v_perm_b32 v44, v101, v97, s76
    v_perm_b32 v45, v109, v105, s76
    v_perm_b32 v46, v117, v113, s76
    v_perm_b32 v47, v125, v121, s76
    v_mfma_f32_16x16x32_bf16 a[196:199], v[40:43], v[32:35], a[196:199]
    v_perm_b32 v48, v101, v97, s77
    v_perm_b32 v49, v109, v105, s77
    v_perm_b32 v50, v117, v113, s77
    v_perm_b32 v51, v125, v121, s77
    v_mfma_f32_16x16x32_bf16 a[200:203], v[44:47], v[32:35], a[200:203]
    v_perm_b32 v36, v102, v98, s76
    v_perm_b32 v37, v110, v106, s76
    v_perm_b32 v38, v118, v114, s76
    v_perm_b32 v39, v126, v122, s76
    v_mfma_f32_16x16x32_bf16 a[204:207], v[48:51], v[32:35], a[204:207]
    v_perm_b32 v40, v102, v98, s77
    v_perm_b32 v41, v110, v106, s77
    v_perm_b32 v42, v118, v114, s77
    v_perm_b32 v43, v126, v122, s77
    v_mfma_f32_16x16x32_bf16 a[208:211], v[36:39], v[32:35], a[208:211]
    v_perm_b32 v44, v103, v99, s76
    v_perm_b32 v45, v111, v107, s76
    v_perm_b32 v46, v119, v115, s76
    v_perm_b32 v47, v127, v123, s76
    v_mfma_f32_16x16x32_bf16 a[212:215], v[40:43], v[32:35], a[212:215]
    v_perm_b32 v48, v103, v99, s77
    v_perm_b32 v49, v111, v107, s77
    v_perm_b32 v50, v119, v115, s77
    v_perm_b32 v51, v127, v123, s77
    v_mfma_f32_16x16x32_bf16 a[216:219], v[44:47], v[32:35], a[216:219]
    s_nop 0
    v_mfma_f32_16x16x32_bf16 a[220:223], v[48:51], v[32:35], a[220:223]
    s_sub_u32 s83, s60, 144
    s_cmp_lt_u32 s83, 72
    s_nop 5
    s_cbranch_scc1 .nsv_23
    s_lshl_b32 s83, s3, 13
    s_add_u32 s83, s83, 108544
    v_lshlrev_b32 v7, 4, v0
    v_add_u32 v7, s83, v7
    ds_write_b128 v7, v[96:99] offset:0
    ds_write_b128 v7, v[100:103] offset:1024
    ds_write_b128 v7, v[104:107] offset:2048
    ds_write_b128 v7, v[108:111] offset:3072
    ds_write_b128 v7, v[112:115] offset:4096
    ds_write_b128 v7, v[116:119] offset:5120
    ds_write_b128 v7, v[120:123] offset:6144
    ds_write_b128 v7, v[124:127] offset:7168
.nsv_23:
    s_add_u32 s79, s78, 0x100000
    s_add_u32 s80, s79, 4096
    buffer_load_dwordx4 v[96:99], v2, s[32:35], s79 offen offset:0 nt
    buffer_load_dwordx4 v[100:103], v2, s[32:35], s79 offen offset:256 nt
    buffer_load_dwordx4 v[104:107], v2, s[32:35], s79 offen offset:2048 nt
    buffer_load_dwordx4 v[108:111], v2, s[32:35], s79 offen offset:2304 nt
    buffer_load_dwordx4 v[112:115], v2, s[32:35], s80 offen offset:0 nt
    buffer_load_dwordx4 v[116:119], v2, s[32:35], s80 offen offset:256 nt
    buffer_load_dwordx4 v[120:123], v2, s[32:35], s80 offen offset:2048 nt
    buffer_load_dwordx4 v[124:127], v2, s[32:35], s80 offen offset:2304 nt
    v_mfma_f32_16x16x32_bf16 v[16:19], a[0:3], a[224:227], 0
    v_mfma_f32_16x16x32_bf16 v[20:23], a[8:11], a[224:227], 0
    v_mfma_f32_16x16x32_bf16 v[24:27], a[16:19], a[224:227], 0
    v_mfma_f32_16x16x32_bf16 v[28:31], a[24:27], a[224:227], 0
    v_mfma_f32_16x16x32_bf16 v[16:19], a[4:7], a[228:231], v[16:19]
    v_mfma_f32_16x16x32_bf16 v[20:23], a[12:15], a[228:231], v[20:23]
    v_mfma_f32_16x16x32_bf16 v[24:27], a[20:23], a[228:231], v[24:27]
    v_mfma_f32_16x16x32_bf16 v[28:31], a[28:31], a[228:231], v[28:31]
    v_mov_b32 v61, 1
    s_mov_b64 exec, 1
    buffer_atomic_add v61, off, s[36:39], s82 sc0 sc1
    s_mov_b64 exec, -1
    s_add_u32 s79, s78, 0x380000
    s_add_u32 s80, s79, 4096
    buffer_load_dwordx4 a[0:3], v1, s[28:31], s79 offen offset:0 nt
    buffer_load_dwordx4 a[4:7], v1, s[28:31], s79 offen offset:128 nt
    buffer_load_dwordx4 a[8:11], v1, s[28:31], s79 offen offset:2048 nt
    buffer_load_dwordx4 a[12:15], v1, s[28:31], s79 offen offset:2176 nt
    buffer_load_dwordx4 a[16:19], v1, s[28:31], s80 offen offset:0 nt
    buffer_load_dwordx4 a[20:23], v1, s[28:31], s80 offen offset:128 nt
    buffer_load_dwordx4 a[24:27], v1, s[28:31], s80 offen offset:2048 nt
    buffer_load_dwordx4 a[28:31], v1, s[28:31], s80 offen offset:2176 nt
    v_add_f32_dpp v8, v17, v16 quad_perm:[1,0,3,2] row_mask:0xf bank_mask:0xf
    v_add_f32_dpp v9, v19, v18 quad_perm:[1,0,3,2] row_mask:0xf bank_mask:0xf
    v_add_f32_dpp v10, v21, v20 quad_perm:[1,0,3,2] row_mask:0xf bank_mask:0xf
    v_add_f32_dpp v11, v23, v22 quad_perm:[1,0,3,2] row_mask:0xf bank_mask:0xf
    v_add_f32_dpp v12, v25, v24 quad_perm:[1,0,3,2] row_mask:0xf bank_mask:0xf
    v_add_f32_dpp v13, v27, v26 quad_perm:[1,0,3,2] row_mask:0xf bank_mask:0xf
    v_add_f32_dpp v14, v29, v28 quad_perm:[1,0,3,2] row_mask:0xf bank_mask:0xf
    v_add_f32_dpp v15, v31, v30 quad_perm:[1,0,3,2] row_mask:0xf bank_mask:0xf
    v_max3_f32 v7, v8, v9, v10
    v_max3_f32 v7, v7, v11, v12
    v_max3_f32 v7, v7, v13, v14
    v_max_f32 v7, v7, v15
    v_cmp_gt_f32 vcc, v7, v4
    s_nop 4
    s_cbranch_vccz .noresc_25
    s_call_b64 s[94:95], .Lresc
.noresc_25:
    v_fma_f32 v8, v8, s75, -v3
    v_fma_f32 v9, v9, s75, -v3
    v_fma_f32 v10, v10, s75, -v3
    v_fma_f32 v11, v11, s75, -v3
    v_fma_f32 v12, v12, s75, -v3
    v_fma_f32 v13, v13, s75, -v3
    v_fma_f32 v14, v14, s75, -v3
    v_fma_f32 v15, v15, s75, -v3
    v_exp_f32 v8, v8
    v_exp_f32 v9, v9
    v_exp_f32 v10, v10
    v_exp_f32 v11, v11
    v_exp_f32 v12, v12
    v_exp_f32 v13, v13
    v_exp_f32 v14, v14
    v_exp_f32 v15, v15
    v_cvt_pk_bf16_f32 v32, v8, v9
    v_cvt_pk_bf16_f32 v33, v10, v11
    v_cvt_pk_bf16_f32 v34, v12, v13
    v_cvt_pk_bf16_f32 v35, v14, v15
    v_add_f32 v8, v8, v9
    v_add_f32 v10, v10, v11
    v_add_f32 v12, v12, v13
    v_add_f32 v14, v14, v15
    v_add_f32 v8, v8, v10
    v_add_f32 v12, v12, v14
    v_add_f32 v5, v5, v8
    v_add_f32 v5, v5, v12
    v_perm_b32 v36, v68, v64, s76
    v_perm_b32 v37, v76, v72, s76
    v_perm_b32 v38, v84, v80, s76
    v_perm_b32 v39, v92, v88, s76
    v_perm_b32 v40, v68, v64, s77
    v_perm_b32 v41, v76, v72, s77
    v_perm_b32 v42, v84, v80, s77
    v_perm_b32 v43, v92, v88, s77
    v_mfma_f32_16x16x32_bf16 a[192:195], v[36:39], v[32:35], a[192:195]
    v_perm_b32 v44, v69, v65, s76
    v_perm_b32 v45, v77, v73, s76
    v_perm_b32 v46, v85, v81, s76
    v_perm_b32 v47, v93, v89, s76
    v_mfma_f32_16x16x32_bf16 a[196:199], v[40:43], v[32:35], a[196:199]
    v_perm_b32 v48, v69, v65, s77
    v_perm_b32 v49, v77, v73, s77
    v_perm_b32 v50, v85, v81, s77
    v_perm_b32 v51, v93, v89, s77
    v_mfma_f32_16x16x32_bf16 a[200:203], v[44:47], v[32:35], a[200:203]
    v_perm_b32 v36, v70, v66, s76
    v_perm_b32 v37, v78, v74, s76
    v_perm_b32 v38, v86, v82, s76
    v_perm_b32 v39, v94, v90, s76
    v_mfma_f32_16x16x32_bf16 a[204:207], v[48:51], v[32:35], a[204:207]
    v_perm_b32 v40, v70, v66, s77
    v_perm_b32 v41, v78, v74, s77
    v_perm_b32 v42, v86, v82, s77
    v_perm_b32 v43, v94, v90, s77
    v_mfma_f32_16x16x32_bf16 a[208:211], v[36:39], v[32:35], a[208:211]
    v_perm_b32 v44, v71, v67, s76
    v_perm_b32 v45, v79, v75, s76
    v_perm_b32 v46, v87, v83, s76
    v_perm_b32 v47, v95, v91, s76
    v_mfma_f32_16x16x32_bf16 a[212:215], v[40:43], v[32:35], a[212:215]
    v_perm_b32 v48, v71, v67, s77
    v_perm_b32 v49, v79, v75, s77
    v_perm_b32 v50, v87, v83, s77
    v_perm_b32 v51, v95, v91, s77
    v_mfma_f32_16x16x32_bf16 a[216:219], v[44:47], v[32:35], a[216:219]
    s_nop 0
    v_mfma_f32_16x16x32_bf16 a[220:223], v[48:51], v[32:35], a[220:223]
    s_add_u32 s79, s78, 0x380000
    s_add_u32 s80, s79, 4096
    buffer_load_dwordx4 v[64:67], v2, s[32:35], s79 offen offset:0 nt
    buffer_load_dwordx4 v[68:71], v2, s[32:35], s79 offen offset:256 nt
    buffer_load_dwordx4 v[72:75], v2, s[32:35], s79 offen offset:2048 nt
    buffer_load_dwordx4 v[76:79], v2, s[32:35], s79 offen offset:2304 nt
    buffer_load_dwordx4 v[80:83], v2, s[32:35], s80 offen offset:0 nt
    buffer_load_dwordx4 v[84:87], v2, s[32:35], s80 offen offset:256 nt
    buffer_load_dwordx4 v[88:91], v2, s[32:35], s80 offen offset:2048 nt
    buffer_load_dwordx4 v[92:95], v2, s[32:35], s80 offen offset:2304 nt
    v_mfma_f32_16x16x32_bf16 v[16:19], a[64:67], a[224:227], 0
    v_mfma_f32_16x16x32_bf16 v[20:23], a[72:75], a[224:227], 0
    v_mfma_f32_16x16x32_bf16 v[24:27], a[80:83], a[224:227], 0
    v_mfma_f32_16x16x32_bf16 v[28:31], a[88:91], a[224:227], 0
    v_mfma_f32_16x16x32_bf16 v[16:19], a[68:71], a[228:231], v[16:19]
    v_mfma_f32_16x16x32_bf16 v[20:23], a[76:79], a[228:231], v[20:23]
    v_mfma_f32_16x16x32_bf16 v[24:27], a[84:87], a[228:231], v[24:27]
    v_mfma_f32_16x16x32_bf16 v[28:31], a[92:95], a[228:231], v[28:31]
    s_nop 4
    v_add_f32_dpp v8, v17, v16 quad_perm:[1,0,3,2] row_mask:0xf bank_mask:0xf
    v_add_f32_dpp v9, v19, v18 quad_perm:[1,0,3,2] row_mask:0xf bank_mask:0xf
    v_add_f32_dpp v10, v21, v20 quad_perm:[1,0,3,2] row_mask:0xf bank_mask:0xf
    v_add_f32_dpp v11, v23, v22 quad_perm:[1,0,3,2] row_mask:0xf bank_mask:0xf
    v_add_f32_dpp v12, v25, v24 quad_perm:[1,0,3,2] row_mask:0xf bank_mask:0xf
    v_add_f32_dpp v13, v27, v26 quad_perm:[1,0,3,2] row_mask:0xf bank_mask:0xf
    v_add_f32_dpp v14, v29, v28 quad_perm:[1,0,3,2] row_mask:0xf bank_mask:0xf
    v_add_f32_dpp v15, v31, v30 quad_perm:[1,0,3,2] row_mask:0xf bank_mask:0xf
    v_max3_f32 v7, v8, v9, v10
    v_max3_f32 v7, v7, v11, v12
    v_max3_f32 v7, v7, v13, v14
    v_max_f32 v7, v7, v15
    v_cmp_gt_f32 vcc, v7, v4
    s_nop 4
    s_cbranch_vccz .noresc_26
    s_call_b64 s[94:95], .Lresc
.noresc_26:
    v_fma_f32 v8, v8, s75, -v3
    v_fma_f32 v9, v9, s75, -v3
    v_fma_f32 v10, v10, s75, -v3
    v_fma_f32 v11, v11, s75, -v3
    v_fma_f32 v12, v12, s75, -v3
    v_fma_f32 v13, v13, s75, -v3
    v_fma_f32 v14, v14, s75, -v3
    v_fma_f32 v15, v15, s75, -v3
    v_exp_f32 v8, v8
    v_exp_f32 v9, v9
    v_exp_f32 v10, v10
    v_exp_f32 v11, v11
    v_exp_f32 v12, v12
    v_exp_f32 v13, v13
    v_exp_f32 v14, v14
    v_exp_f32 v15, v15
    v_cvt_pk_bf16_f32 v32, v8, v9
    v_cvt_pk_bf16_f32 v33, v10, v11
    v_cvt_pk_bf16_f32 v34, v12, v13
    v_cvt_pk_bf16_f32 v35, v14, v15
    v_add_f32 v8, v8, v9
    v_add_f32 v10, v10, v11
    v_add_f32 v12, v12, v13
    v_add_f32 v14, v14, v15
    v_add_f32 v8, v8, v10
    v_add_f32 v12, v12, v14
    v_add_f32 v5, v5, v8
    v_add_f32 v5, v5, v12
    v_perm_b32 v36, v132, v128, s76
    v_perm_b32 v37, v140, v136, s76
    v_perm_b32 v38, v148, v144, s76
    v_perm_b32 v39, v156, v152, s76
    v_perm_b32 v40, v132, v128, s77
    v_perm_b32 v41, v140, v136, s77
    v_perm_b32 v42, v148, v144, s77
    v_perm_b32 v43, v156, v152, s77
    v_mfma_f32_16x16x32_bf16 a[192:195], v[36:39], v[32:35], a[192:195]
    v_perm_b32 v44, v133, v129, s76
    v_perm_b32 v45, v141, v137, s76
    v_perm_b32 v46, v149, v145, s76
    v_perm_b32 v47, v157, v153, s76
    v_mfma_f32_16x16x32_bf16 a[196:199], v[40:43], v[32:35], a[196:199]
    v_perm_b32 v48, v133, v129, s77
    v_perm_b32 v49, v141, v137, s77
    v_perm_b32 v50, v149, v145, s77
    v_perm_b32 v51, v157, v153, s77
    v_mfma_f32_16x16x32_bf16 a[200:203], v[44:47], v[32:35], a[200:203]
    v_perm_b32 v36, v134, v130, s76
    v_perm_b32 v37, v142, v138, s76
    v_perm_b32 v38, v150, v146, s76
    v_perm_b32 v39, v158, v154, s76
    v_mfma_f32_16x16x32_bf16 a[204:207], v[48:51], v[32:35], a[204:207]
    v_perm_b32 v40, v134, v130, s77
    v_perm_b32 v41, v142, v138, s77
    v_perm_b32 v42, v150, v146, s77
    v_perm_b32 v43, v158, v154, s77
    v_mfma_f32_16x16x32_bf16 a[208:211], v[36:39], v[32:35], a[208:211]
    v_perm_b32 v44, v135, v131, s76
    v_perm_b32 v45, v143, v139, s76
    v_perm_b32 v46, v151, v147, s76
    v_perm_b32 v47, v159, v155, s76
    v_mfma_f32_16x16x32_bf16 a[212:215], v[40:43], v[32:35], a[212:215]
    v_perm_b32 v48, v135, v131, s77
    v_perm_b32 v49, v143, v139, s77
    v_perm_b32 v50, v151, v147, s77
    v_perm_b32 v51, v159, v155, s77
    v_mfma_f32_16x16x32_bf16 a[216:219], v[44:47], v[32:35], a[216:219]
    s_nop 0
    v_mfma_f32_16x16x32_bf16 a[220:223], v[48:51], v[32:35], a[220:223]
    v_mfma_f32_16x16x32_bf16 v[16:19], a[96:99], a[224:227], 0
    v_mfma_f32_16x16x32_bf16 v[20:23], a[104:107], a[224:227], 0
    v_mfma_f32_16x16x32_bf16 v[24:27], a[112:115], a[224:227], 0
    v_mfma_f32_16x16x32_bf16 v[28:31], a[120:123], a[224:227], 0
    v_mfma_f32_16x16x32_bf16 v[16:19], a[100:103], a[228:231], v[16:19]
    v_mfma_f32_16x16x32_bf16 v[20:23], a[108:111], a[228:231], v[20:23]
    v_mfma_f32_16x16x32_bf16 v[24:27], a[116:119], a[228:231], v[24:27]
    v_mfma_f32_16x16x32_bf16 v[28:31], a[124:127], a[228:231], v[28:31]
    s_nop 4
    v_add_f32_dpp v8, v17, v16 quad_perm:[1,0,3,2] row_mask:0xf bank_mask:0xf
    v_add_f32_dpp v9, v19, v18 quad_perm:[1,0,3,2] row_mask:0xf bank_mask:0xf
    v_add_f32_dpp v10, v21, v20 quad_perm:[1,0,3,2] row_mask:0xf bank_mask:0xf
    v_add_f32_dpp v11, v23, v22 quad_perm:[1,0,3,2] row_mask:0xf bank_mask:0xf
    v_add_f32_dpp v12, v25, v24 quad_perm:[1,0,3,2] row_mask:0xf bank_mask:0xf
    v_add_f32_dpp v13, v27, v26 quad_perm:[1,0,3,2] row_mask:0xf bank_mask:0xf
    v_add_f32_dpp v14, v29, v28 quad_perm:[1,0,3,2] row_mask:0xf bank_mask:0xf
    v_add_f32_dpp v15, v31, v30 quad_perm:[1,0,3,2] row_mask:0xf bank_mask:0xf
    v_max3_f32 v7, v8, v9, v10
    v_max3_f32 v7, v7, v11, v12
    v_max3_f32 v7, v7, v13, v14
    v_max_f32 v7, v7, v15
    v_cmp_gt_f32 vcc, v7, v4
    s_nop 4
    s_cbranch_vccz .noresc_27
    s_call_b64 s[94:95], .Lresc
.noresc_27:
    v_fma_f32 v8, v8, s75, -v3
    v_fma_f32 v9, v9, s75, -v3
    v_fma_f32 v10, v10, s75, -v3
    v_fma_f32 v11, v11, s75, -v3
    v_fma_f32 v12, v12, s75, -v3
    v_fma_f32 v13, v13, s75, -v3
    v_fma_f32 v14, v14, s75, -v3
    v_fma_f32 v15, v15, s75, -v3
    v_exp_f32 v8, v8
    v_exp_f32 v9, v9
    v_exp_f32 v10, v10
    v_exp_f32 v11, v11
    v_exp_f32 v12, v12
    v_exp_f32 v13, v13
    v_exp_f32 v14, v14
    v_exp_f32 v15, v15
    v_cvt_pk_bf16_f32 v32, v8, v9
    v_cvt_pk_bf16_f32 v33, v10, v11
    v_cvt_pk_bf16_f32 v34, v12, v13
    v_cvt_pk_bf16_f32 v35, v14, v15
    v_add_f32 v8, v8, v9
    v_add_f32 v10, v10, v11
    v_add_f32 v12, v12, v13
    v_add_f32 v14, v14, v15
    v_add_f32 v8, v8, v10
    v_add_f32 v12, v12, v14
    v_add_f32 v5, v5, v8
    v_add_f32 v5, v5, v12
    v_perm_b32 v36, v164, v160, s76
    v_perm_b32 v37, v172, v168, s76
    v_perm_b32 v38, v180, v176, s76
    v_perm_b32 v39, v188, v184, s76
    v_perm_b32 v40, v164, v160, s77
    v_perm_b32 v41, v172, v168, s77
    v_perm_b32 v42, v180, v176, s77
    v_perm_b32 v43, v188, v184, s77
    v_mfma_f32_16x16x32_bf16 a[192:195], v[36:39], v[32:35], a[192:195]
    v_perm_b32 v44, v165, v161, s76
    v_perm_b32 v45, v173, v169, s76
    v_perm_b32 v46, v181, v177, s76
    v_perm_b32 v47, v189, v185, s76
    v_mfma_f32_16x16x32_bf16 a[196:199], v[40:43], v[32:35], a[196:199]
    v_perm_b32 v48, v165, v161, s77
    v_perm_b32 v49, v173, v169, s77
    v_perm_b32 v50, v181, v177, s77
    v_perm_b32 v51, v189, v185, s77
    v_mfma_f32_16x16x32_bf16 a[200:203], v[44:47], v[32:35], a[200:203]
    v_perm_b32 v36, v166, v162, s76
    v_perm_b32 v37, v174, v170, s76
    v_perm_b32 v38, v182, v178, s76
    v_perm_b32 v39, v190, v186, s76
    v_mfma_f32_16x16x32_bf16 a[204:207], v[48:51], v[32:35], a[204:207]
    v_perm_b32 v40, v166, v162, s77
    v_perm_b32 v41, v174, v170, s77
    v_perm_b32 v42, v182, v178, s77
    v_perm_b32 v43, v190, v186, s77
    v_mfma_f32_16x16x32_bf16 a[208:211], v[36:39], v[32:35], a[208:211]
    v_perm_b32 v44, v167, v163, s76
    v_perm_b32 v45, v175, v171, s76
    v_perm_b32 v46, v183, v179, s76
    v_perm_b32 v47, v191, v187, s76
    v_mfma_f32_16x16x32_bf16 a[212:215], v[40:43], v[32:35], a[212:215]
    v_perm_b32 v48, v167, v163, s77
    v_perm_b32 v49, v175, v171, s77
    v_perm_b32 v50, v183, v179, s77
    v_perm_b32 v51, v191, v187, s77
    v_mfma_f32_16x16x32_bf16 a[216:219], v[44:47], v[32:35], a[216:219]
    s_nop 0
    v_mfma_f32_16x16x32_bf16 a[220:223], v[48:51], v[32:35], a[220:223]
    v_mfma_f32_16x16x32_bf16 v[16:19], a[128:131], a[224:227], 0
    v_mfma_f32_16x16x32_bf16 v[20:23], a[136:139], a[224:227], 0
    v_mfma_f32_16x16x32_bf16 v[24:27], a[144:147], a[224:227], 0
    v_mfma_f32_16x16x32_bf16 v[28:31], a[152:155], a[224:227], 0
    v_mfma_f32_16x16x32_bf16 v[16:19], a[132:135], a[228:231], v[16:19]
    v_mfma_f32_16x16x32_bf16 v[20:23], a[140:143], a[228:231], v[20:23]
    v_mfma_f32_16x16x32_bf16 v[24:27], a[148:151], a[228:231], v[24:27]
    v_mfma_f32_16x16x32_bf16 v[28:31], a[156:159], a[228:231], v[28:31]
    s_nop 4
    v_add_f32_dpp v8, v17, v16 quad_perm:[1,0,3,2] row_mask:0xf bank_mask:0xf
    v_add_f32_dpp v9, v19, v18 quad_perm:[1,0,3,2] row_mask:0xf bank_mask:0xf
    v_add_f32_dpp v10, v21, v20 quad_perm:[1,0,3,2] row_mask:0xf bank_mask:0xf
    v_add_f32_dpp v11, v23, v22 quad_perm:[1,0,3,2] row_mask:0xf bank_mask:0xf
    v_add_f32_dpp v12, v25, v24 quad_perm:[1,0,3,2] row_mask:0xf bank_mask:0xf
    v_add_f32_dpp v13, v27, v26 quad_perm:[1,0,3,2] row_mask:0xf bank_mask:0xf
    v_add_f32_dpp v14, v29, v28 quad_perm:[1,0,3,2] row_mask:0xf bank_mask:0xf
    v_add_f32_dpp v15, v31, v30 quad_perm:[1,0,3,2] row_mask:0xf bank_mask:0xf
    v_max3_f32 v7, v8, v9, v10
    v_max3_f32 v7, v7, v11, v12
    v_max3_f32 v7, v7, v13, v14
    v_max_f32 v7, v7, v15
    v_cmp_gt_f32 vcc, v7, v4
    s_nop 4
    s_cbranch_vccz .noresc_28
    s_call_b64 s[94:95], .Lresc
.noresc_28:
    v_fma_f32 v8, v8, s75, -v3
    v_fma_f32 v9, v9, s75, -v3
    v_fma_f32 v10, v10, s75, -v3
    v_fma_f32 v11, v11, s75, -v3
    v_fma_f32 v12, v12, s75, -v3
    v_fma_f32 v13, v13, s75, -v3
    v_fma_f32 v14, v14, s75, -v3
    v_fma_f32 v15, v15, s75, -v3
    v_exp_f32 v8, v8
    v_exp_f32 v9, v9
    v_exp_f32 v10, v10
    v_exp_f32 v11, v11
    v_exp_f32 v12, v12
    v_exp_f32 v13, v13
    v_exp_f32 v14, v14
    v_exp_f32 v15, v15
    v_cvt_pk_bf16_f32 v32, v8, v9
    v_cvt_pk_bf16_f32 v33, v10, v11
    v_cvt_pk_bf16_f32 v34, v12, v13
    v_cvt_pk_bf16_f32 v35, v14, v15
    v_add_f32 v8, v8, v9
    v_add_f32 v10, v10, v11
    v_add_f32 v12, v12, v13
    v_add_f32 v14, v14, v15
    v_add_f32 v8, v8, v10
    v_add_f32 v12, v12, v14
    v_add_f32 v5, v5, v8
    v_add_f32 v5, v5, v12
    v_perm_b32 v36, v196, v192, s76
    v_perm_b32 v37, v204, v200, s76
    v_perm_b32 v38, v212, v208, s76
    v_perm_b32 v39, v220, v216, s76
    v_perm_b32 v40, v196, v192, s77
    v_perm_b32 v41, v204, v200, s77
    v_perm_b32 v42, v212, v208, s77
    v_perm_b32 v43, v220, v216, s77
    v_mfma_f32_16x16x32_bf16 a[192:195], v[36:39], v[32:35], a[192:195]
    v_perm_b32 v44, v197, v193, s76
    v_perm_b32 v45, v205, v201, s76
    v_perm_b32 v46, v213, v209, s76
    v_perm_b32 v47, v221, v217, s76
    v_mfma_f32_16x16x32_bf16 a[196:199], v[40:43], v[32:35], a[196:199]
    v_perm_b32 v48, v197, v193, s77
    v_perm_b32 v49, v205, v201, s77
    v_perm_b32 v50, v213, v209, s77
    v_perm_b32 v51, v221, v217, s77
    v_mfma_f32_16x16x32_bf16 a[200:203], v[44:47], v[32:35], a[200:203]
    v_perm_b32 v36, v198, v194, s76
    v_perm_b32 v37, v206, v202, s76
    v_perm_b32 v38, v214, v210, s76
    v_perm_b32 v39, v222, v218, s76
    v_mfma_f32_16x16x32_bf16 a[204:207], v[48:51], v[32:35], a[204:207]
    v_perm_b32 v40, v198, v194, s77
    v_perm_b32 v41, v206, v202, s77
    v_perm_b32 v42, v214, v210, s77
    v_perm_b32 v43, v222, v218, s77
    v_mfma_f32_16x16x32_bf16 a[208:211], v[36:39], v[32:35], a[208:211]
    v_perm_b32 v44, v199, v195, s76
    v_perm_b32 v45, v207, v203, s76
    v_perm_b32 v46, v215, v211, s76
    v_perm_b32 v47, v223, v219, s76
    v_mfma_f32_16x16x32_bf16 a[212:215], v[40:43], v[32:35], a[212:215]
    v_perm_b32 v48, v199, v195, s77
    v_perm_b32 v49, v207, v203, s77
    v_perm_b32 v50, v215, v211, s77
    v_perm_b32 v51, v223, v219, s77
    v_mfma_f32_16x16x32_bf16 a[216:219], v[44:47], v[32:35], a[216:219]
    s_nop 0
    v_mfma_f32_16x16x32_bf16 a[220:223], v[48:51], v[32:35], a[220:223]
    s_waitcnt vmcnt(45)
    v_mfma_f32_16x16x32_bf16 v[16:19], a[160:163], a[224:227], 0
    v_mfma_f32_16x16x32_bf16 v[20:23], a[168:171], a[224:227], 0
    v_mfma_f32_16x16x32_bf16 v[24:27], a[176:179], a[224:227], 0
    v_mfma_f32_16x16x32_bf16 v[28:31], a[184:187], a[224:227], 0
    v_mfma_f32_16x16x32_bf16 v[16:19], a[164:167], a[228:231], v[16:19]
    v_mfma_f32_16x16x32_bf16 v[20:23], a[172:175], a[228:231], v[20:23]
    v_mfma_f32_16x16x32_bf16 v[24:27], a[180:183], a[228:231], v[24:27]
    v_mfma_f32_16x16x32_bf16 v[28:31], a[188:191], a[228:231], v[28:31]
    s_nop 4
    v_add_f32_dpp v8, v17, v16 quad_perm:[1,0,3,2] row_mask:0xf bank_mask:0xf
    v_add_f32_dpp v9, v19, v18 quad_perm:[1,0,3,2] row_mask:0xf bank_mask:0xf
    v_add_f32_dpp v10, v21, v20 quad_perm:[1,0,3,2] row_mask:0xf bank_mask:0xf
    v_add_f32_dpp v11, v23, v22 quad_perm:[1,0,3,2] row_mask:0xf bank_mask:0xf
    v_add_f32_dpp v12, v25, v24 quad_perm:[1,0,3,2] row_mask:0xf bank_mask:0xf
    v_add_f32_dpp v13, v27, v26 quad_perm:[1,0,3,2] row_mask:0xf bank_mask:0xf
    v_add_f32_dpp v14, v29, v28 quad_perm:[1,0,3,2] row_mask:0xf bank_mask:0xf
    v_add_f32_dpp v15, v31, v30 quad_perm:[1,0,3,2] row_mask:0xf bank_mask:0xf
    v_max3_f32 v7, v8, v9, v10
    v_max3_f32 v7, v7, v11, v12
    v_max3_f32 v7, v7, v13, v14
    v_max_f32 v7, v7, v15
    v_cmp_gt_f32 vcc, v7, v4
    s_nop 4
    s_cbranch_vccz .noresc_29
    s_call_b64 s[94:95], .Lresc
.noresc_29:
    v_fma_f32 v8, v8, s75, -v3
    v_fma_f32 v9, v9, s75, -v3
    v_fma_f32 v10, v10, s75, -v3
    v_fma_f32 v11, v11, s75, -v3
    v_fma_f32 v12, v12, s75, -v3
    v_fma_f32 v13, v13, s75, -v3
    v_fma_f32 v14, v14, s75, -v3
    v_fma_f32 v15, v15, s75, -v3
    v_exp_f32 v8, v8
    v_exp_f32 v9, v9
    v_exp_f32 v10, v10
    v_exp_f32 v11, v11
    v_exp_f32 v12, v12
    v_exp_f32 v13, v13
    v_exp_f32 v14, v14
    v_exp_f32 v15, v15
    v_cvt_pk_bf16_f32 v32, v8, v9
    v_cvt_pk_bf16_f32 v33, v10, v11
    v_cvt_pk_bf16_f32 v34, v12, v13
    v_cvt_pk_bf16_f32 v35, v14, v15
    v_add_f32 v8, v8, v9
    v_add_f32 v10, v10, v11
    v_add_f32 v12, v12, v13
    v_add_f32 v14, v14, v15
    v_add_f32 v8, v8, v10
    v_add_f32 v12, v12, v14
    v_add_f32 v5, v5, v8
    v_add_f32 v5, v5, v12
    s_waitcnt vmcnt(35)
    v_perm_b32 v36, v228, v224, s76
    v_perm_b32 v37, v236, v232, s76
    v_perm_b32 v38, v244, v240, s76
    v_perm_b32 v39, v252, v248, s76
    v_perm_b32 v40, v228, v224, s77
    v_perm_b32 v41, v236, v232, s77
    v_perm_b32 v42, v244, v240, s77
    v_perm_b32 v43, v252, v248, s77
    v_mfma_f32_16x16x32_bf16 a[192:195], v[36:39], v[32:35], a[192:195]
    v_perm_b32 v44, v229, v225, s76
    v_perm_b32 v45, v237, v233, s76
    v_perm_b32 v46, v245, v241, s76
    v_perm_b32 v47, v253, v249, s76
    v_mfma_f32_16x16x32_bf16 a[196:199], v[40:43], v[32:35], a[196:199]
    v_perm_b32 v48, v229, v225, s77
    v_perm_b32 v49, v237, v233, s77
    v_perm_b32 v50, v245, v241, s77
    v_perm_b32 v51, v253, v249, s77
    v_mfma_f32_16x16x32_bf16 a[200:203], v[44:47], v[32:35], a[200:203]
    v_perm_b32 v36, v230, v226, s76
    v_perm_b32 v37, v238, v234, s76
    v_perm_b32 v38, v246, v242, s76
    v_perm_b32 v39, v254, v250, s76
    v_mfma_f32_16x16x32_bf16 a[204:207], v[48:51], v[32:35], a[204:207]
    v_perm_b32 v40, v230, v226, s77
    v_perm_b32 v41, v238, v234, s77
    v_perm_b32 v42, v246, v242, s77
    v_perm_b32 v43, v254, v250, s77
    v_mfma_f32_16x16x32_bf16 a[208:211], v[36:39], v[32:35], a[208:211]
    v_perm_b32 v44, v231, v227, s76
    v_perm_b32 v45, v239, v235, s76
    v_perm_b32 v46, v247, v243, s76
    v_perm_b32 v47, v255, v251, s76
    v_mfma_f32_16x16x32_bf16 a[212:215], v[40:43], v[32:35], a[212:215]
    v_perm_b32 v48, v231, v227, s77
    v_perm_b32 v49, v239, v235, s77
    v_perm_b32 v50, v247, v243, s77
    v_perm_b32 v51, v255, v251, s77
    v_mfma_f32_16x16x32_bf16 a[216:219], v[44:47], v[32:35], a[216:219]
    s_nop 0
    v_mfma_f32_16x16x32_bf16 a[220:223], v[48:51], v[32:35], a[220:223]
    s_waitcnt vmcnt(25)
    v_mfma_f32_16x16x32_bf16 v[16:19], a[32:35], a[224:227], 0
    v_mfma_f32_16x16x32_bf16 v[20:23], a[40:43], a[224:227], 0
    v_mfma_f32_16x16x32_bf16 v[24:27], a[48:51], a[224:227], 0
    v_mfma_f32_16x16x32_bf16 v[28:31], a[56:59], a[224:227], 0
    v_mfma_f32_16x16x32_bf16 v[16:19], a[36:39], a[228:231], v[16:19]
    v_mfma_f32_16x16x32_bf16 v[20:23], a[44:47], a[228:231], v[20:23]
    v_mfma_f32_16x16x32_bf16 v[24:27], a[52:55], a[228:231], v[24:27]
    v_mfma_f32_16x16x32_bf16 v[28:31], a[60:63], a[228:231], v[28:31]
    s_nop 4
    v_add_f32_dpp v8, v17, v16 quad_perm:[1,0,3,2] row_mask:0xf bank_mask:0xf
    v_add_f32_dpp v9, v19, v18 quad_perm:[1,0,3,2] row_mask:0xf bank_mask:0xf
    v_add_f32_dpp v10, v21, v20 quad_perm:[1,0,3,2] row_mask:0xf bank_mask:0xf
    v_add_f32_dpp v11, v23, v22 quad_perm:[1,0,3,2] row_mask:0xf bank_mask:0xf
    v_add_f32_dpp v12, v25, v24 quad_perm:[1,0,3,2] row_mask:0xf bank_mask:0xf
    v_add_f32_dpp v13, v27, v26 quad_perm:[1,0,3,2] row_mask:0xf bank_mask:0xf
    v_add_f32_dpp v14, v29, v28 quad_perm:[1,0,3,2] row_mask:0xf bank_mask:0xf
    v_add_f32_dpp v15, v31, v30 quad_perm:[1,0,3,2] row_mask:0xf bank_mask:0xf
    v_max3_f32 v7, v8, v9, v10
    v_max3_f32 v7, v7, v11, v12
    v_max3_f32 v7, v7, v13, v14
    v_max_f32 v7, v7, v15
    v_cmp_gt_f32 vcc, v7, v4
    s_nop 4
    s_cbranch_vccz .noresc_30
    s_call_b64 s[94:95], .Lresc
.noresc_30:
    v_fma_f32 v8, v8, s75, -v3
    v_fma_f32 v9, v9, s75, -v3
    v_fma_f32 v10, v10, s75, -v3
    v_fma_f32 v11, v11, s75, -v3
    v_fma_f32 v12, v12, s75, -v3
    v_fma_f32 v13, v13, s75, -v3
    v_fma_f32 v14, v14, s75, -v3
    v_fma_f32 v15, v15, s75, -v3
    v_exp_f32 v8, v8
    v_exp_f32 v9, v9
    v_exp_f32 v10, v10
    v_exp_f32 v11, v11
    v_exp_f32 v12, v12
    v_exp_f32 v13, v13
    v_exp_f32 v14, v14
    v_exp_f32 v15, v15
    v_cvt_pk_bf16_f32 v32, v8, v9
    v_cvt_pk_bf16_f32 v33, v10, v11
    v_cvt_pk_bf16_f32 v34, v12, v13
    v_cvt_pk_bf16_f32 v35, v14, v15
    v_add_f32 v8, v8, v9
    v_add_f32 v10, v10, v11
    v_add_f32 v12, v12, v13
    v_add_f32 v14, v14, v15
    v_add_f32 v8, v8, v10
    v_add_f32 v12, v12, v14
    v_add_f32 v5, v5, v8
    v_add_f32 v5, v5, v12
    s_waitcnt vmcnt(17)
    v_perm_b32 v36, v100, v96, s76
    v_perm_b32 v37, v108, v104, s76
    v_perm_b32 v38, v116, v112, s76
    v_perm_b32 v39, v124, v120, s76
    v_perm_b32 v40, v100, v96, s77
    v_perm_b32 v41, v108, v104, s77
    v_perm_b32 v42, v116, v112, s77
    v_perm_b32 v43, v124, v120, s77
    v_mfma_f32_16x16x32_bf16 a[192:195], v[36:39], v[32:35], a[192:195]
    v_perm_b32 v44, v101, v97, s76
    v_perm_b32 v45, v109, v105, s76
    v_perm_b32 v46, v117, v113, s76
    v_perm_b32 v47, v125, v121, s76
    v_mfma_f32_16x16x32_bf16 a[196:199], v[40:43], v[32:35], a[196:199]
    v_perm_b32 v48, v101, v97, s77
    v_perm_b32 v49, v109, v105, s77
    v_perm_b32 v50, v117, v113, s77
    v_perm_b32 v51, v125, v121, s77
    v_mfma_f32_16x16x32_bf16 a[200:203], v[44:47], v[32:35], a[200:203]
    v_perm_b32 v36, v102, v98, s76
    v_perm_b32 v37, v110, v106, s76
    v_perm_b32 v38, v118, v114, s76
    v_perm_b32 v39, v126, v122, s76
    v_mfma_f32_16x16x32_bf16 a[204:207], v[48:51], v[32:35], a[204:207]
    v_perm_b32 v40, v102, v98, s77
    v_perm_b32 v41, v110, v106, s77
    v_perm_b32 v42, v118, v114, s77
    v_perm_b32 v43, v126, v122, s77
    v_mfma_f32_16x16x32_bf16 a[208:211], v[36:39], v[32:35], a[208:211]
    v_perm_b32 v44, v103, v99, s76
    v_perm_b32 v45, v111, v107, s76
    v_perm_b32 v46, v119, v115, s76
    v_perm_b32 v47, v127, v123, s76
    v_mfma_f32_16x16x32_bf16 a[212:215], v[40:43], v[32:35], a[212:215]
    v_perm_b32 v48, v103, v99, s77
    v_perm_b32 v49, v111, v107, s77
    v_perm_b32 v50, v119, v115, s77
    v_perm_b32 v51, v127, v123, s77
    v_mfma_f32_16x16x32_bf16 a[216:219], v[44:47], v[32:35], a[216:219]
    s_nop 0
    v_mfma_f32_16x16x32_bf16 a[220:223], v[48:51], v[32:35], a[220:223]
    s_cmp_lg_u32 s3, 0
    s_nop 6
    s_cbranch_scc1 .ccd_32
    s_mov_b32 s88, 200000
.cc_31:
    v_cmp_ne_u32 vcc, -1, v57
    s_nop 4
    s_cbranch_vccz .ccd_32
    v_and_b32 v54, 7, v0
    v_lshlrev_b32 v54, 2, v54
    buffer_load_dword v57, v54, s[48:51], 0 offen offset:128 sc1
    s_waitcnt vmcnt(0)
    s_sub_u32 s88, s88, 1
    s_cmp_lg_u32 s88, 0
    s_cbranch_scc1 .cc_31
.ccd_32:
.attnA_34:
    s_cmp_eq_u32 s22, 0
    s_cbranch_scc1 .attnB_35
    s_waitcnt vmcnt(8)
    v_readfirstlane_b32 s79, v61
    v_mfma_f32_16x16x32_bf16 v[16:19], a[0:3], a[224:227], 0
    v_mfma_f32_16x16x32_bf16 v[20:23], a[8:11], a[224:227], 0
    v_mfma_f32_16x16x32_bf16 v[24:27], a[16:19], a[224:227], 0
    v_mfma_f32_16x16x32_bf16 v[28:31], a[24:27], a[224:227], 0
    v_mfma_f32_16x16x32_bf16 v[16:19], a[4:7], a[228:231], v[16:19]
    v_mfma_f32_16x16x32_bf16 v[20:23], a[12:15], a[228:231], v[20:23]
    v_mfma_f32_16x16x32_bf16 v[24:27], a[20:23], a[228:231], v[24:27]
    v_mfma_f32_16x16x32_bf16 v[28:31], a[28:31], a[228:231], v[28:31]
    s_add_u32 s79, s79, 1
    s_cmp_ge_u32 s79, 1536
    s_nop 5
    s_cbranch_scc1 .tail_33
    s_mov_b32 s21, s20
    s_mov_b32 s20, s79
    s_bfe_u32 s25, s79, 0x40000
    s_lshl_b32 s79, s79, 13
    s_add_u32 s80, s79, 4096
    v_mov_b32 v61, 1
    s_mov_b64 exec, 1
    buffer_atomic_add v61, off, s[36:39], s82 sc0 sc1
    s_mov_b64 exec, -1
    s_cmp_lt_u32 s25, 9
    s_cbranch_scc0 .mnt_36
    buffer_load_dwordx4 a[0:3], v1, s[28:31], s79 offen offset:0
    buffer_load_dwordx4 a[4:7], v1, s[28:31], s79 offen offset:128
    buffer_load_dwordx4 a[8:11], v1, s[28:31], s79 offen offset:2048
    buffer_load_dwordx4 a[12:15], v1, s[28:31], s79 offen offset:2176
    buffer_load_dwordx4 a[16:19], v1, s[28:31], s80 offen offset:0
    buffer_load_dwordx4 a[20:23], v1, s[28:31], s80 offen offset:128
    buffer_load_dwordx4 a[24:27], v1, s[28:31], s80 offen offset:2048
    buffer_load_dwordx4 a[28:31], v1, s[28:31], s80 offen offset:2176
    s_branch .mj_37
.mnt_36:
    buffer_load_dwordx4 a[0:3], v1, s[28:31], s79 offen offset:0 nt
    buffer_load_dwordx4 a[4:7], v1, s[28:31], s79 offen offset:128 nt
    buffer_load_dwordx4 a[8:11], v1, s[28:31], s79 offen offset:2048 nt
    buffer_load_dwordx4 a[12:15], v1, s[28:31], s79 offen offset:2176 nt
    buffer_load_dwordx4 a[16:19], v1, s[28:31], s80 offen offset:0 nt
    buffer_load_dwordx4 a[20:23], v1, s[28:31], s80 offen offset:128 nt
    buffer_load_dwordx4 a[24:27], v1, s[28:31], s80 offen offset:2048 nt
    buffer_load_dwordx4 a[28:31], v1, s[28:31], s80 offen offset:2176 nt
.mj_37:
    s_cmp_lg_u32 s68, 0
    s_cbranch_scc1 .wgo_38
    s_mov_b64 s[52:53], s[56:57]
    s_mov_b32 s54, s58
    s_mov_b32 s66, s69
    s_mov_b32 s67, s70
    s_mov_b32 s68, s71
.wgo_38:
    s_mov_b32 m0, s67
    s_nop 0
    buffer_load_dwordx4 v58, s[52:55], s66 offen nt lds
    s_add_u32 s66, s66, s74
    s_add_u32 m0, s67, 1024
    s_nop 0
    buffer_load_dwordx4 v59, s[52:55], s66 offen nt lds
    s_add_u32 s66, s66, s74
    s_add_u32 s67, s67, 2048
    s_sub_u32 s68, s68, 1
    s_sub_u32 s22, s22, 1
    s_cmp_lg_u32 s68, 0
    s_cbranch_scc1 .wgo_39
    s_mov_b64 s[52:53], s[56:57]
    s_mov_b32 s54, s58
    s_mov_b32 s66, s69
    s_mov_b32 s67, s70
    s_mov_b32 s68, s71
.wgo_39:
    s_mov_b32 m0, s67
    s_nop 0
    buffer_load_dwordx4 v58, s[52:55], s66 offen nt lds
    s_add_u32 s66, s66, s74
    s_add_u32 m0, s67, 1024
    s_nop 0
    buffer_load_dwordx4 v59, s[52:55], s66 offen nt lds
    s_add_u32 s66, s66, s74
    s_add_u32 s67, s67, 2048
    s_sub_u32 s68, s68, 1
    s_sub_u32 s22, s22, 1
    v_add_f32_dpp v8, v17, v16 quad_perm:[1,0,3,2] row_mask:0xf bank_mask:0xf
    v_add_f32_dpp v9, v19, v18 quad_perm:[1,0,3,2] row_mask:0xf bank_mask:0xf
    v_add_f32_dpp v10, v21, v20 quad_perm:[1,0,3,2] row_mask:0xf bank_mask:0xf
    v_add_f32_dpp v11, v23, v22 quad_perm:[1,0,3,2] row_mask:0xf bank_mask:0xf
    v_add_f32_dpp v12, v25, v24 quad_perm:[1,0,3,2] row_mask:0xf bank_mask:0xf
    v_add_f32_dpp v13, v27, v26 quad_perm:[1,0,3,2] row_mask:0xf bank_mask:0xf
    v_add_f32_dpp v14, v29, v28 quad_perm:[1,0,3,2] row_mask:0xf bank_mask:0xf
    v_add_f32_dpp v15, v31, v30 quad_perm:[1,0,3,2] row_mask:0xf bank_mask:0xf
    v_max3_f32 v7, v8, v9, v10
    v_max3_f32 v7, v7, v11, v12
    v_max3_f32 v7, v7, v13, v14
    v_max_f32 v7, v7, v15
    v_cmp_gt_f32 vcc, v7, v4
    s_nop 4
    s_cbranch_vccz .noresc_40
    s_call_b64 s[94:95], .Lresc
.noresc_40:
    v_fma_f32 v8, v8, s75, -v3
    v_fma_f32 v9, v9, s75, -v3
    v_fma_f32 v10, v10, s75, -v3
    v_fma_f32 v11, v11, s75, -v3
    v_fma_f32 v12, v12, s75, -v3
    v_fma_f32 v13, v13, s75, -v3
    v_fma_f32 v14, v14, s75, -v3
    v_fma_f32 v15, v15, s75, -v3
    v_exp_f32 v8, v8
    v_exp_f32 v9, v9
    v_exp_f32 v10, v10
    v_exp_f32 v11, v11
    v_exp_f32 v12, v12
    v_exp_f32 v13, v13
    v_exp_f32 v14, v14
    v_exp_f32 v15, v15
    v_cvt_pk_bf16_f32 v32, v8, v9
    v_cvt_pk_bf16_f32 v33, v10, v11
    v_cvt_pk_bf16_f32 v34, v12, v13
    v_cvt_pk_bf16_f32 v35, v14, v15
    v_add_f32 v8, v8, v9
    v_add_f32 v10, v10, v11
    v_add_f32 v12, v12, v13
    v_add_f32 v14, v14, v15
    v_add_f32 v8, v8, v10
    v_add_f32 v12, v12, v14
    v_add_f32 v5, v5, v8
    v_add_f32 v5, v5, v12
    s_waitcnt vmcnt(13)
    v_perm_b32 v36, v68, v64, s76
    v_perm_b32 v37, v76, v72, s76
    v_perm_b32 v38, v84, v80, s76
    v_perm_b32 v39, v92, v88, s76
    v_perm_b32 v40, v68, v64, s77
    v_perm_b32 v41, v76, v72, s77
    v_perm_b32 v42, v84, v80, s77
    v_perm_b32 v43, v92, v88, s77
    v_mfma_f32_16x16x32_bf16 a[192:195], v[36:39], v[32:35], a[192:195]
    v_perm_b32 v44, v69, v65, s76
    v_perm_b32 v45, v77, v73, s76
    v_perm_b32 v46, v85, v81, s76
    v_perm_b32 v47, v93, v89, s76
    v_mfma_f32_16x16x32_bf16 a[196:199], v[40:43], v[32:35], a[196:199]
    v_perm_b32 v48, v69, v65, s77
    v_perm_b32 v49, v77, v73, s77
    v_perm_b32 v50, v85, v81, s77
    v_perm_b32 v51, v93, v89, s77
    v_mfma_f32_16x16x32_bf16 a[200:203], v[44:47], v[32:35], a[200:203]
    v_perm_b32 v36, v70, v66, s76
    v_perm_b32 v37, v78, v74, s76
    v_perm_b32 v38, v86, v82, s76
    v_perm_b32 v39, v94, v90, s76
    v_mfma_f32_16x16x32_bf16 a[204:207], v[48:51], v[32:35], a[204:207]
    v_perm_b32 v40, v70, v66, s77
    v_perm_b32 v41, v78, v74, s77
    v_perm_b32 v42, v86, v82, s77
    v_perm_b32 v43, v94, v90, s77
    v_mfma_f32_16x16x32_bf16 a[208:211], v[36:39], v[32:35], a[208:211]
    v_perm_b32 v44, v71, v67, s76
    v_perm_b32 v45, v79, v75, s76
    v_perm_b32 v46, v87, v83, s76
    v_perm_b32 v47, v95, v91, s76
    v_mfma_f32_16x16x32_bf16 a[212:215], v[40:43], v[32:35], a[212:215]
    v_perm_b32 v48, v71, v67, s77
    v_perm_b32 v49, v79, v75, s77
    v_perm_b32 v50, v87, v83, s77
    v_perm_b32 v51, v95, v91, s77
    v_mfma_f32_16x16x32_bf16 a[216:219], v[44:47], v[32:35], a[216:219]
    s_nop 0
    v_mfma_f32_16x16x32_bf16 a[220:223], v[48:51], v[32:35], a[220:223]
    s_cmp_lt_u32 s25, 9
    s_nop 6
    s_cbranch_scc0 .mnt_41
    buffer_load_dwordx4 v[64:67], v2, s[32:35], s79 offen offset:0
    buffer_load_dwordx4 v[68:71], v2, s[32:35], s79 offen offset:256
    buffer_load_dwordx4 v[72:75], v2, s[32:35], s79 offen offset:2048
    buffer_load_dwordx4 v[76:79], v2, s[32:35], s79 offen offset:2304
    buffer_load_dwordx4 v[80:83], v2, s[32:35], s80 offen offset:0
    buffer_load_dwordx4 v[84:87], v2, s[32:35], s80 offen offset:256
    buffer_load_dwordx4 v[88:91], v2, s[32:35], s80 offen offset:2048
    buffer_load_dwordx4 v[92:95], v2, s[32:35], s80 offen offset:2304
    s_branch .mj_42
.mnt_41:
    buffer_load_dwordx4 v[64:67], v2, s[32:35], s79 offen offset:0 nt
    buffer_load_dwordx4 v[68:71], v2, s[32:35], s79 offen offset:256 nt
    buffer_load_dwordx4 v[72:75], v2, s[32:35], s79 offen offset:2048 nt
    buffer_load_dwordx4 v[76:79], v2, s[32:35], s79 offen offset:2304 nt
    buffer_load_dwordx4 v[80:83], v2, s[32:35], s80 offen offset:0 nt
    buffer_load_dwordx4 v[84:87], v2, s[32:35], s80 offen offset:256 nt
    buffer_load_dwordx4 v[88:91], v2, s[32:35], s80 offen offset:2048 nt
    buffer_load_dwordx4 v[92:95], v2, s[32:35], s80 offen offset:2304 nt
.mj_42:
    s_branch .attnA_34
.attnB_35:
    s_waitcnt vmcnt(8)
    v_readfirstlane_b32 s79, v61
    v_mfma_f32_16x16x32_bf16 v[16:19], a[0:3], a[224:227], 0
    v_mfma_f32_16x16x32_bf16 v[20:23], a[8:11], a[224:227], 0
    v_mfma_f32_16x16x32_bf16 v[24:27], a[16:19], a[224:227], 0
    v_mfma_f32_16x16x32_bf16 v[28:31], a[24:27], a[224:227], 0
    v_mfma_f32_16x16x32_bf16 v[16:19], a[4:7], a[228:231], v[16:19]
    v_mfma_f32_16x16x32_bf16 v[20:23], a[12:15], a[228:231], v[20:23]
    v_mfma_f32_16x16x32_bf16 v[24:27], a[20:23], a[228:231], v[24:27]
    v_mfma_f32_16x16x32_bf16 v[28:31], a[28:31], a[228:231], v[28:31]
    s_add_u32 s79, s79, 1
    s_cmp_ge_u32 s79, 1536
    s_nop 5
    s_cbranch_scc1 .tail_33
    s_mov_b32 s21, s20
    s_mov_b32 s20, s79
    s_bfe_u32 s25, s79, 0x40000
    s_lshl_b32 s79, s79, 13
    s_add_u32 s80, s79, 4096
    v_mov_b32 v61, 1
    s_mov_b64 exec, 1
    buffer_atomic_add v61, off, s[36:39], s82 sc0 sc1
    s_mov_b64 exec, -1
    s_cmp_lt_u32 s25, 9
    s_cbranch_scc0 .mnt_43
    buffer_load_dwordx4 a[0:3], v1, s[28:31], s79 offen offset:0
    buffer_load_dwordx4 a[4:7], v1, s[28:31], s79 offen offset:128
    buffer_load_dwordx4 a[8:11], v1, s[28:31], s79 offen offset:2048
    buffer_load_dwordx4 a[12:15], v1, s[28:31], s79 offen offset:2176
    buffer_load_dwordx4 a[16:19], v1, s[28:31], s80 offen offset:0
    buffer_load_dwordx4 a[20:23], v1, s[28:31], s80 offen offset:128
    buffer_load_dwordx4 a[24:27], v1, s[28:31], s80 offen offset:2048
    buffer_load_dwordx4 a[28:31], v1, s[28:31], s80 offen offset:2176
    s_branch .mj_44
.mnt_43:
    buffer_load_dwordx4 a[0:3], v1, s[28:31], s79 offen offset:0 nt
    buffer_load_dwordx4 a[4:7], v1, s[28:31], s79 offen offset:128 nt
    buffer_load_dwordx4 a[8:11], v1, s[28:31], s79 offen offset:2048 nt
    buffer_load_dwordx4 a[12:15], v1, s[28:31], s79 offen offset:2176 nt
    buffer_load_dwordx4 a[16:19], v1, s[28:31], s80 offen offset:0 nt
    buffer_load_dwordx4 a[20:23], v1, s[28:31], s80 offen offset:128 nt
    buffer_load_dwordx4 a[24:27], v1, s[28:31], s80 offen offset:2048 nt
    buffer_load_dwordx4 a[28:31], v1, s[28:31], s80 offen offset:2176 nt
.mj_44:
    v_add_f32_dpp v8, v17, v16 quad_perm:[1,0,3,2] row_mask:0xf bank_mask:0xf
    v_add_f32_dpp v9, v19, v18 quad_perm:[1,0,3,2] row_mask:0xf bank_mask:0xf
    v_add_f32_dpp v10, v21, v20 quad_perm:[1,0,3,2] row_mask:0xf bank_mask:0xf
    v_add_f32_dpp v11, v23, v22 quad_perm:[1,0,3,2] row_mask:0xf bank_mask:0xf
    v_add_f32_dpp v12, v25, v24 quad_perm:[1,0,3,2] row_mask:0xf bank_mask:0xf
    v_add_f32_dpp v13, v27, v26 quad_perm:[1,0,3,2] row_mask:0xf bank_mask:0xf
    v_add_f32_dpp v14, v29, v28 quad_perm:[1,0,3,2] row_mask:0xf bank_mask:0xf
    v_add_f32_dpp v15, v31, v30 quad_perm:[1,0,3,2] row_mask:0xf bank_mask:0xf
    v_max3_f32 v7, v8, v9, v10
    v_max3_f32 v7, v7, v11, v12
    v_max3_f32 v7, v7, v13, v14
    v_max_f32 v7, v7, v15
    v_cmp_gt_f32 vcc, v7, v4
    s_nop 4
    s_cbranch_vccz .noresc_45
    s_call_b64 s[94:95], .Lresc
.noresc_45:
    v_fma_f32 v8, v8, s75, -v3
    v_fma_f32 v9, v9, s75, -v3
    v_fma_f32 v10, v10, s75, -v3
    v_fma_f32 v11, v11, s75, -v3
    v_fma_f32 v12, v12, s75, -v3
    v_fma_f32 v13, v13, s75, -v3
    v_fma_f32 v14, v14, s75, -v3
    v_fma_f32 v15, v15, s75, -v3
    v_exp_f32 v8, v8
    v_exp_f32 v9, v9
    v_exp_f32 v10, v10
    v_exp_f32 v11, v11
    v_exp_f32 v12, v12
    v_exp_f32 v13, v13
    v_exp_f32 v14, v14
    v_exp_f32 v15, v15
    v_cvt_pk_bf16_f32 v32, v8, v9
    v_cvt_pk_bf16_f32 v33, v10, v11
    v_cvt_pk_bf16_f32 v34, v12, v13
    v_cvt_pk_bf16_f32 v35, v14, v15
    v_add_f32 v8, v8, v9
    v_add_f32 v10, v10, v11
    v_add_f32 v12, v12, v13
    v_add_f32 v14, v14, v15
    v_add_f32 v8, v8, v10
    v_add_f32 v12, v12, v14
    v_add_f32 v5, v5, v8
    v_add_f32 v5, v5, v12
    s_waitcnt vmcnt(9)
    v_perm_b32 v36, v68, v64, s76
    v_perm_b32 v37, v76, v72, s76
    v_perm_b32 v38, v84, v80, s76
    v_perm_b32 v39, v92, v88, s76
    v_perm_b32 v40, v68, v64, s77
    v_perm_b32 v41, v76, v72, s77
    v_perm_b32 v42, v84, v80, s77
    v_perm_b32 v43, v92, v88, s77
    v_mfma_f32_16x16x32_bf16 a[192:195], v[36:39], v[32:35], a[192:195]
    v_perm_b32 v44, v69, v65, s76
    v_perm_b32 v45, v77, v73, s76
    v_perm_b32 v46, v85, v81, s76
    v_perm_b32 v47, v93, v89, s76
    v_mfma_f32_16x16x32_bf16 a[196:199], v[40:43], v[32:35], a[196:199]
    v_perm_b32 v48, v69, v65, s77
    v_perm_b32 v49, v77, v73, s77
    v_perm_b32 v50, v85, v81, s77
    v_perm_b32 v51, v93, v89, s77
    v_mfma_f32_16x16x32_bf16 a[200:203], v[44:47], v[32:35], a[200:203]
    v_perm_b32 v36, v70, v66, s76
    v_perm_b32 v37, v78, v74, s76
    v_perm_b32 v38, v86, v82, s76
    v_perm_b32 v39, v94, v90, s76
    v_mfma_f32_16x16x32_bf16 a[204:207], v[48:51], v[32:35], a[204:207]
    v_perm_b32 v40, v70, v66, s77
    v_perm_b32 v41, v78, v74, s77
    v_perm_b32 v42, v86, v82, s77
    v_perm_b32 v43, v94, v90, s77
    v_mfma_f32_16x16x32_bf16 a[208:211], v[36:39], v[32:35], a[208:211]
    v_perm_b32 v44, v71, v67, s76
    v_perm_b32 v45, v79, v75, s76
    v_perm_b32 v46, v87, v83, s76
    v_perm_b32 v47, v95, v91, s76
    v_mfma_f32_16x16x32_bf16 a[212:215], v[40:43], v[32:35], a[212:215]
    v_perm_b32 v48, v71, v67, s77
    v_perm_b32 v49, v79, v75, s77
    v_perm_b32 v50, v87, v83, s77
    v_perm_b32 v51, v95, v91, s77
    v_mfma_f32_16x16x32_bf16 a[216:219], v[44:47], v[32:35], a[216:219]
    s_nop 0
    v_mfma_f32_16x16x32_bf16 a[220:223], v[48:51], v[32:35], a[220:223]
    s_cmp_lt_u32 s25, 9
    s_nop 6
    s_cbranch_scc0 .mnt_46
    buffer_load_dwordx4 v[64:67], v2, s[32:35], s79 offen offset:0
    buffer_load_dwordx4 v[68:71], v2, s[32:35], s79 offen offset:256
    buffer_load_dwordx4 v[72:75], v2, s[32:35], s79 offen offset:2048
    buffer_load_dwordx4 v[76:79], v2, s[32:35], s79 offen offset:2304
    buffer_load_dwordx4 v[80:83], v2, s[32:35], s80 offen offset:0
    buffer_load_dwordx4 v[84:87], v2, s[32:35], s80 offen offset:256
    buffer_load_dwordx4 v[88:91], v2, s[32:35], s80 offen offset:2048
    buffer_load_dwordx4 v[92:95], v2, s[32:35], s80 offen offset:2304
    s_branch .mj_47
.mnt_46:
    buffer_load_dwordx4 v[64:67], v2, s[32:35], s79 offen offset:0 nt
    buffer_load_dwordx4 v[68:71], v2, s[32:35], s79 offen offset:256 nt
    buffer_load_dwordx4 v[72:75], v2, s[32:35], s79 offen offset:2048 nt
    buffer_load_dwordx4 v[76:79], v2, s[32:35], s79 offen offset:2304 nt
    buffer_load_dwordx4 v[80:83], v2, s[32:35], s80 offen offset:0 nt
    buffer_load_dwordx4 v[84:87], v2, s[32:35], s80 offen offset:256 nt
    buffer_load_dwordx4 v[88:91], v2, s[32:35], s80 offen offset:2048 nt
    buffer_load_dwordx4 v[92:95], v2, s[32:35], s80 offen offset:2304 nt
.mj_47:
    s_branch .attnB_35
.tail_33:
    v_add_f32_dpp v8, v17, v16 quad_perm:[1,0,3,2] row_mask:0xf bank_mask:0xf
    v_add_f32_dpp v9, v19, v18 quad_perm:[1,0,3,2] row_mask:0xf bank_mask:0xf
    v_add_f32_dpp v10, v21, v20 quad_perm:[1,0,3,2] row_mask:0xf bank_mask:0xf
    v_add_f32_dpp v11, v23, v22 quad_perm:[1,0,3,2] row_mask:0xf bank_mask:0xf
    v_add_f32_dpp v12, v25, v24 quad_perm:[1,0,3,2] row_mask:0xf bank_mask:0xf
    v_add_f32_dpp v13, v27, v26 quad_perm:[1,0,3,2] row_mask:0xf bank_mask:0xf
    v_add_f32_dpp v14, v29, v28 quad_perm:[1,0,3,2] row_mask:0xf bank_mask:0xf
    v_add_f32_dpp v15, v31, v30 quad_perm:[1,0,3,2] row_mask:0xf bank_mask:0xf
    v_max3_f32 v7, v8, v9, v10
    v_max3_f32 v7, v7, v11, v12
    v_max3_f32 v7, v7, v13, v14
    v_max_f32 v7, v7, v15
    v_cmp_gt_f32 vcc, v7, v4
    s_nop 4
    s_cbranch_vccz .noresc_48
    s_call_b64 s[94:95], .Lresc
.noresc_48:
    v_fma_f32 v8, v8, s75, -v3
    v_fma_f32 v9, v9, s75, -v3
    v_fma_f32 v10, v10, s75, -v3
    v_fma_f32 v11, v11, s75, -v3
    v_fma_f32 v12, v12, s75, -v3
    v_fma_f32 v13, v13, s75, -v3
    v_fma_f32 v14, v14, s75, -v3
    v_fma_f32 v15, v15, s75, -v3
    v_exp_f32 v8, v8
    v_exp_f32 v9, v9
    v_exp_f32 v10, v10
    v_exp_f32 v11, v11
    v_exp_f32 v12, v12
    v_exp_f32 v13, v13
    v_exp_f32 v14, v14
    v_exp_f32 v15, v15
    v_cvt_pk_bf16_f32 v32, v8, v9
    v_cvt_pk_bf16_f32 v33, v10, v11
    v_cvt_pk_bf16_f32 v34, v12, v13
    v_cvt_pk_bf16_f32 v35, v14, v15
    v_add_f32 v8, v8, v9
    v_add_f32 v10, v10, v11
    v_add_f32 v12, v12, v13
    v_add_f32 v14, v14, v15
    v_add_f32 v8, v8, v10
    v_add_f32 v12, v12, v14
    v_add_f32 v5, v5, v8
    v_add_f32 v5, v5, v12
    s_nop 1
.wrest_49:
    s_cmp_eq_u32 s22, 0
    s_cbranch_scc1 .wrestd_50
    s_cmp_lg_u32 s68, 0
    s_cbranch_scc1 .wgo_51
    s_mov_b64 s[52:53], s[56:57]
    s_mov_b32 s54, s58
    s_mov_b32 s66, s69
    s_mov_b32 s67, s70
    s_mov_b32 s68, s71
.wgo_51:
    s_mov_b32 m0, s67
    s_nop 0
    buffer_load_dwordx4 v58, s[52:55], s66 offen nt lds
    s_add_u32 s66, s66, s74
    s_add_u32 m0, s67, 1024
    s_nop 0
    buffer_load_dwordx4 v59, s[52:55], s66 offen nt lds
    s_add_u32 s66, s66, s74
    s_add_u32 s67, s67, 2048
    s_sub_u32 s68, s68, 1
    s_sub_u32 s22, s22, 1
    s_branch .wrest_49
.wrestd_50:
    s_waitcnt vmcnt(0)
    v_perm_b32 v36, v68, v64, s76
    v_perm_b32 v37, v76, v72, s76
    v_perm_b32 v38, v84, v80, s76
    v_perm_b32 v39, v92, v88, s76
    v_perm_b32 v40, v68, v64, s77
    v_perm_b32 v41, v76, v72, s77
    v_perm_b32 v42, v84, v80, s77
    v_perm_b32 v43, v92, v88, s77
    v_mfma_f32_16x16x32_bf16 a[192:195], v[36:39], v[32:35], a[192:195]
    v_perm_b32 v44, v69, v65, s76
    v_perm_b32 v45, v77, v73, s76
    v_perm_b32 v46, v85, v81, s76
    v_perm_b32 v47, v93, v89, s76
    v_mfma_f32_16x16x32_bf16 a[196:199], v[40:43], v[32:35], a[196:199]
    v_perm_b32 v48, v69, v65, s77
    v_perm_b32 v49, v77, v73, s77
    v_perm_b32 v50, v85, v81, s77
    v_perm_b32 v51, v93, v89, s77
    v_mfma_f32_16x16x32_bf16 a[200:203], v[44:47], v[32:35], a[200:203]
    v_perm_b32 v36, v70, v66, s76
    v_perm_b32 v37, v78, v74, s76
    v_perm_b32 v38, v86, v82, s76
    v_perm_b32 v39, v94, v90, s76
    v_mfma_f32_16x16x32_bf16 a[204:207], v[48:51], v[32:35], a[204:207]
    v_perm_b32 v40, v70, v66, s77
    v_perm_b32 v41, v78, v74, s77
    v_perm_b32 v42, v86, v82, s77
    v_perm_b32 v43, v94, v90, s77
    v_mfma_f32_16x16x32_bf16 a[208:211], v[36:39], v[32:35], a[208:211]
    v_perm_b32 v44, v71, v67, s76
    v_perm_b32 v45, v79, v75, s76
    v_perm_b32 v46, v87, v83, s76
    v_perm_b32 v47, v95, v91, s76
    v_mfma_f32_16x16x32_bf16 a[212:215], v[40:43], v[32:35], a[212:215]
    v_perm_b32 v48, v71, v67, s77
    v_perm_b32 v49, v79, v75, s77
    v_perm_b32 v50, v87, v83, s77
    v_perm_b32 v51, v95, v91, s77
    v_mfma_f32_16x16x32_bf16 a[216:219], v[44:47], v[32:35], a[216:219]
    s_nop 0
    v_mfma_f32_16x16x32_bf16 a[220:223], v[48:51], v[32:35], a[220:223]
    s_mov_b32 s89, 0
    s_nop 6
    s_call_b64 s[86:87], .Lchain
    s_cmp_lt_u32 s60, 216
    s_cbranch_scc1 .nsc_52
    v_mov_b32 v8, -1
    v_mov_b32 v9, -1
    v_mov_b32 v10, -1
    v_mov_b32 v11, -1
    v_lshlrev_b32 v7, 4, v0
    s_sub_u32 s83, s60, 216
    s_lshl_b32 s83, s83, 2
    s_add_u32 s83, s83, s3
    s_mul_i32 s83, s83, 40960
    s_add_u32 s83, s83, 2621440
    buffer_store_dwordx4 v[8:11], v7, s[36:39], s83 offen offset:0 sc1
    buffer_store_dwordx4 v[8:11], v7, s[36:39], s83 offen offset:1024 sc1
    buffer_store_dwordx4 v[8:11], v7, s[36:39], s83 offen offset:2048 sc1
    buffer_store_dwordx4 v[8:11], v7, s[36:39], s83 offen offset:3072 sc1
    s_add_u32 s83, s83, 4096
    buffer_store_dwordx4 v[8:11], v7, s[36:39], s83 offen offset:0 sc1
    buffer_store_dwordx4 v[8:11], v7, s[36:39], s83 offen offset:1024 sc1
    buffer_store_dwordx4 v[8:11], v7, s[36:39], s83 offen offset:2048 sc1
    buffer_store_dwordx4 v[8:11], v7, s[36:39], s83 offen offset:3072 sc1
    s_add_u32 s83, s83, 4096
    buffer_store_dwordx4 v[8:11], v7, s[36:39], s83 offen offset:0 sc1
    buffer_store_dwordx4 v[8:11], v7, s[36:39], s83 offen offset:1024 sc1
    buffer_store_dwordx4 v[8:11], v7, s[36:39], s83 offen offset:2048 sc1
    buffer_store_dwordx4 v[8:11], v7, s[36:39], s83 offen offset:3072 sc1
    s_add_u32 s83, s83, 4096
    buffer_store_dwordx4 v[8:11], v7, s[36:39], s83 offen offset:0 sc1
    buffer_store_dwordx4 v[8:11], v7, s[36:39], s83 offen offset:1024 sc1
    buffer_store_dwordx4 v[8:11], v7, s[36:39], s83 offen offset:2048 sc1
    buffer_store_dwordx4 v[8:11], v7, s[36:39], s83 offen offset:3072 sc1
    s_add_u32 s83, s83, 4096
    buffer_store_dwordx4 v[8:11], v7, s[36:39], s83 offen offset:0 sc1
    buffer_store_dwordx4 v[8:11], v7, s[36:39], s83 offen offset:1024 sc1
    buffer_store_dwordx4 v[8:11], v7, s[36:39], s83 offen offset:2048 sc1
    buffer_store_dwordx4 v[8:11], v7, s[36:39], s83 offen offset:3072 sc1
    s_add_u32 s83, s83, 4096
    buffer_store_dwordx4 v[8:11], v7, s[36:39], s83 offen offset:0 sc1
    buffer_store_dwordx4 v[8:11], v7, s[36:39], s83 offen offset:1024 sc1
    buffer_store_dwordx4 v[8:11], v7, s[36:39], s83 offen offset:2048 sc1
    buffer_store_dwordx4 v[8:11], v7, s[36:39], s83 offen offset:3072 sc1
    s_add_u32 s83, s83, 4096
    buffer_store_dwordx4 v[8:11], v7, s[36:39], s83 offen offset:0 sc1
    buffer_store_dwordx4 v[8:11], v7, s[36:39], s83 offen offset:1024 sc1
    buffer_store_dwordx4 v[8:11], v7, s[36:39], s83 offen offset:2048 sc1
    buffer_store_dwordx4 v[8:11], v7, s[36:39], s83 offen offset:3072 sc1
    s_add_u32 s83, s83, 4096
    buffer_store_dwordx4 v[8:11], v7, s[36:39], s83 offen offset:0 sc1
    buffer_store_dwordx4 v[8:11], v7, s[36:39], s83 offen offset:1024 sc1
    buffer_store_dwordx4 v[8:11], v7, s[36:39], s83 offen offset:2048 sc1
    buffer_store_dwordx4 v[8:11], v7, s[36:39], s83 offen offset:3072 sc1
    s_add_u32 s83, s83, 4096
    buffer_store_dwordx4 v[8:11], v7, s[36:39], s83 offen offset:0 sc1
    buffer_store_dwordx4 v[8:11], v7, s[36:39], s83 offen offset:1024 sc1
    buffer_store_dwordx4 v[8:11], v7, s[36:39], s83 offen offset:2048 sc1
    buffer_store_dwordx4 v[8:11], v7, s[36:39], s83 offen offset:3072 sc1
    s_add_u32 s83, s83, 4096
    buffer_store_dwordx4 v[8:11], v7, s[36:39], s83 offen offset:0 sc1
    buffer_store_dwordx4 v[8:11], v7, s[36:39], s83 offen offset:1024 sc1
    buffer_store_dwordx4 v[8:11], v7, s[36:39], s83 offen offset:2048 sc1
    buffer_store_dwordx4 v[8:11], v7, s[36:39], s83 offen offset:3072 sc1
    s_nop 1
    v_mov_b32 v8, 1
    s_waitcnt vmcnt(0)
    s_mov_b64 exec, 1
    buffer_atomic_add v8, off, s[48:51], 0 offset:72 sc1
    s_mov_b64 exec, -1
.nsc_52:
    v_lshrrev_b32 v1, 1, v62
    v_lshlrev_b32 v1, 8, v1
    v_and_b32 v7, 1, v62
    v_lshl_add_u32 v1, v7, 6, v1
    v_lshl_add_u32 v1, v63, 4, v1
    v_lshlrev_b32 v2, 9, v63
    v_lshl_add_u32 v2, v62, 4, v2
    v_lshrrev_b32 v60, 1, v62
    v_and_b32 v60, 1, v60
    v_lshlrev_b32 v60, 8, v60
    v_and_b32 v24, 1, v62
    v_lshl_add_u32 v60, v24, 6, v60
    v_lshl_add_u32 v60, v63, 4, v60
    s_cmp_lt_u32 s60, 72
    s_nop 0
    s_cbranch_scc1 .npn_53
    s_and_b32 s84, s2, 15
    s_mul_i32 s84, s84, 1280
    s_add_u32 s84, s84, 593920
    s_mov_b32 s88, 200000
    s_mov_b64 exec, 1
.pw_54:
    buffer_load_dword v8, off, s[36:39], s84 sc1
    s_waitcnt vmcnt(0)
    v_cmp_eq_u32 vcc, -1, v8
    s_nop 4
    s_cbranch_vccz .pwd_55
    s_sub_u32 s88, s88, 1
    s_cmp_lg_u32 s88, 0
    s_cbranch_scc1 .pw_54
.pwd_55:
    s_mov_b64 exec, -1
    s_waitcnt vmcnt(0)
    s_lshl_b32 s4, s3, 14
    s_lshl_b32 s5, s73, 9
    s_add_u32 s4, s4, s5
    s_add_u32 s4, s4, 0x8e0000
    s_add_u32 s5, s4, 0x100000
    s_mov_b64 exec, 1
    buffer_load_dword v8, off, s[28:31], s5 nt
    s_add_u32 s5, s4, 0x2000
    s_movk_i32 s12, 0x7fff
    s_movk_i32 s13, 0x7fff
    s_waitcnt vmcnt(0)
    s_memtime s[6:7]
    s_waitcnt lgkmcnt(0)
    buffer_load_dword v8, off, s[28:31], s4 offset:0 nt
    s_waitcnt vmcnt(0)
    s_memtime s[8:9]
    s_waitcnt lgkmcnt(0)
    s_sub_u32 s6, s8, s6
    s_min_u32 s12, s12, s6
    s_memtime s[6:7]
    s_waitcnt lgkmcnt(0)
    buffer_load_dword v8, off, s[28:31], s5 offset:0 nt
    s_waitcnt vmcnt(0)
    s_memtime s[8:9]
    s_waitcnt lgkmcnt(0)
    s_sub_u32 s6, s8, s6
    s_min_u32 s13, s13, s6
    s_memtime s[6:7]
    s_waitcnt lgkmcnt(0)
    buffer_load_dword v8, off, s[28:31], s4 offset:128 nt
    s_waitcnt vmcnt(0)
    s_memtime s[8:9]
    s_waitcnt lgkmcnt(0)
    s_sub_u32 s6, s8, s6
    s_min_u32 s12, s12, s6
    s_memtime s[6:7]
    s_waitcnt lgkmcnt(0)
    buffer_load_dword v8, off, s[28:31], s5 offset:128 nt
    s_waitcnt vmcnt(0)
    s_memtime s[8:9]
    s_waitcnt lgkmcnt(0)
    s_sub_u32 s6, s8, s6
    s_min_u32 s13, s13, s6
    s_memtime s[6:7]
    s_waitcnt lgkmcnt(0)
    buffer_load_dword v8, off, s[28:31], s4 offset:256 nt
    s_waitcnt vmcnt(0)
    s_memtime s[8:9]
    s_waitcnt lgkmcnt(0)
    s_sub_u32 s6, s8, s6
    s_min_u32 s12, s12, s6
    s_memtime s[6:7]
    s_waitcnt lgkmcnt(0)
    buffer_load_dword v8, off, s[28:31], s5 offset:256 nt
    s_waitcnt vmcnt(0)
    s_memtime s[8:9]
    s_waitcnt lgkmcnt(0)
    s_sub_u32 s6, s8, s6
    s_min_u32 s13, s13, s6
    s_mov_b64 exec, -1
    s_sub_i32 s12, s13, s12
    s_max_i32 s12, s12, -300
    s_min_i32 s12, s12, 300
    s_lshl_b32 s5, s3, 2
    s_add_u32 s5, s5, 158528
    v_mov_b32 v8, s5
    v_mov_b32 v9, s12
    ds_write_b32 v8, v9
    v_mov_b32 v8, 158528
    s_waitcnt lgkmcnt(0)
    s_barrier
    ds_read_b128 v[8:11], v8
    s_waitcnt lgkmcnt(0)
    v_add_u32 v8, v8, v9
    v_add_u32 v10, v10, v11
    v_add_u32 v8, v8, v10
    s_nop 0
    v_readfirstlane_b32 s12, v8
    s_nop 0
    s_cmp_lt_i32 s12, 0
    s_cselect_b32 s81, 1, 0
    s_nop 1
.npn_53:
    s_cmp_lt_u32 s60, 64
    s_cbranch_scc1 .npf_56
    v_lshlrev_b32 v7, 7, v62
    v_mul_u32_u24 v8, 2048, v63
    v_add_u32 v7, v7, v8
    s_mov_b32 s79, s78
    s_add_u32 s80, s79, 4096
    buffer_load_dword a192, v7, s[28:31], s79 offen
    s_mov_b32 s79, s78
    s_add_u32 s80, s79, 4096
    buffer_load_dword a194, v7, s[32:35], s79 offen
.npf_56:
    v_lshlrev_b32 v10, 2, v0
    s_lshl_b32 s84, s72, 15
    s_add_u32 s84, s84, 1838080
    s_mov_b32 s88, 200000
    s_mov_b64 s[12:13], -1
.fg_60:
    s_mov_b64 exec, s[12:13]
    s_cbranch_execz .fgs_62
    buffer_load_dword v58, v10, s[36:39], s84 offen sc1
    buffer_load_dword v59, v10, s[36:39], s84 offen offset:256 sc1
.fgs_62:
    s_mov_b64 exec, -1
    s_waitcnt vmcnt(0)
    s_cmp_eq_u64 s[12:13], 0
    s_cbranch_scc1 .fgc_63
    v_max_u32 v8, v58, v59
    v_cmp_eq_u32 s[12:13], -1, v8
    s_nop 4
.fgc_63:
    s_cmp_eq_u64 s[12:13], 0
    s_cbranch_scc1 .fgd_61
    s_sub_u32 s88, s88, 1
    s_cmp_lg_u32 s88, 0
    s_cbranch_scc1 .fg_60
.fgd_61:
    v_lshrrev_b32 v8, 8, v58
    v_xor_b32 v8, v8, v58
    v_and_b32 v8, 1, v8
    v_ashrrev_i32 v9, 1, v58
    v_lshl_add_u32 v8, v8, 12, v9
    v_cmp_gt_i32 vcc, 0, v58
    s_nop 1
    v_cndmask_b32 v58, v8, -1, vcc
    v_lshrrev_b32 v8, 8, v59
    v_xor_b32 v8, v8, v59
    v_and_b32 v8, 1, v8
    v_ashrrev_i32 v9, 1, v59
    v_lshl_add_u32 v8, v8, 12, v9
    v_cmp_gt_i32 vcc, 0, v59
    s_nop 1
    v_cndmask_b32 v59, v8, -1, vcc
    s_movk_i32 s83, 4096
    v_cmp_le_i32 vcc, s83, v58
    s_nop 0
    s_bcnt1_i32_b64 s69, vcc
    v_cmp_le_i32 vcc, s83, v59
    s_nop 0
    s_bcnt1_i32_b64 s84, vcc
    s_add_u32 s69, s69, s84
    v_cmp_le_i32 vcc, 0, v58
    s_nop 0
    s_bcnt1_i32_b64 s67, vcc
    v_cmp_le_i32 vcc, 0, v59
    s_nop 0
    s_bcnt1_i32_b64 s84, vcc
    s_add_u32 s67, s67, s84
    s_sub_u32 s67, s67, s69
    s_sub_u32 s67, 768, s67
    s_sub_u32 s68, 768, s69
    s_mov_b32 s66, s81
    s_lshl_b32 s70, s81, 1
    s_sub_i32 s70, 1, s70
    s_and_b32 s84, s2, 15
    s_mul_i32 s84, s84, 1280
    s_add_u32 s84, s84, 844800
    s_mov_b32 s88, 200000
    s_mov_b64 exec, 1
.pw_64:
    buffer_load_dword v8, off, s[36:39], s84 sc1
    s_waitcnt vmcnt(0)
    v_cmp_eq_u32 vcc, -1, v8
    s_nop 4
    s_cbranch_vccz .pwd_65
    s_sub_u32 s88, s88, 1
    s_cmp_lg_u32 s88, 0
    s_cbranch_scc1 .pw_64
.pwd_65:
    s_mov_b64 exec, -1
    s_lshl_b32 s85, s72, 15
    s_add_u32 s85, s85, 1840128
    s_mov_b32 s88, 200000
.qw_57:
    s_lshl_b32 s83, s2, 11
    s_add_u32 s83, s83, 1835520
    buffer_load_dwordx4 v[16:19], v60, s[36:39], s83 offen sc1
    buffer_load_dwordx4 v[20:23], v60, s[36:39], s83 offen offset:128 sc1
    buffer_load_dword v24, off, s[36:39], s85 sc1
    buffer_load_dword v25, off, s[48:51], 0 offset:72 sc1
    s_waitcnt vmcnt(0)
    v_max3_u32 v8, v16, v17, v18
    v_max3_u32 v9, v19, v20, v21
    v_max3_u32 v8, v8, v22, v23
    v_max3_u32 v9, v9, v24, v24
    v_max_u32 v8, v8, v9
    v_cmp_eq_u32 vcc, -1, v8
    s_nop 4
    s_cbranch_vccnz .qwb_59
    v_accvgpr_write_b32 a224, v16
    v_accvgpr_write_b32 a225, v17
    v_accvgpr_write_b32 a226, v18
    v_accvgpr_write_b32 a227, v19
    v_accvgpr_write_b32 a228, v20
    v_accvgpr_write_b32 a229, v21
    v_accvgpr_write_b32 a230, v22
    v_accvgpr_write_b32 a231, v23
    v_readfirstlane_b32 s16, v24
    v_readfirstlane_b32 s83, v25
    s_cmp_lg_u32 s16, 1
    s_nop 3
    s_cbranch_scc1 .qwd_58
    s_cmp_lt_u32 s83, 160
    s_cbranch_scc1 .qwb_59
    s_branch .qwd_58
.qwb_59:
    s_sleep 2
    s_sub_u32 s88, s88, 1
    s_cmp_lg_u32 s88, 0
    s_cbranch_scc1 .qw_57
.qwd_58:
    s_cmp_lg_u32 s16, 1
    s_cbranch_scc1 .p2n_66
    v_accvgpr_write_b32 a192, 0
    v_accvgpr_write_b32 a193, 0
    v_accvgpr_write_b32 a194, 0
    v_accvgpr_write_b32 a195, 0
    v_accvgpr_write_b32 a196, 0
    v_accvgpr_write_b32 a197, 0
    v_accvgpr_write_b32 a198, 0
    v_accvgpr_write_b32 a199, 0
    v_accvgpr_write_b32 a200, 0
    v_accvgpr_write_b32 a201, 0
    v_accvgpr_write_b32 a202, 0
    v_accvgpr_write_b32 a203, 0
    v_accvgpr_write_b32 a204, 0
    v_accvgpr_write_b32 a205, 0
    v_accvgpr_write_b32 a206, 0
    v_accvgpr_write_b32 a207, 0
    v_accvgpr_write_b32 a208, 0
    v_accvgpr_write_b32 a209, 0
    v_accvgpr_write_b32 a210, 0
    v_accvgpr_write_b32 a211, 0
    v_accvgpr_write_b32 a212, 0
    v_accvgpr_write_b32 a213, 0
    v_accvgpr_write_b32 a214, 0
    v_accvgpr_write_b32 a215, 0
    v_accvgpr_write_b32 a216, 0
    v_accvgpr_write_b32 a217, 0
    v_accvgpr_write_b32 a218, 0
    v_accvgpr_write_b32 a219, 0
    v_accvgpr_write_b32 a220, 0
    v_accvgpr_write_b32 a221, 0
    v_accvgpr_write_b32 a222, 0
    v_accvgpr_write_b32 a223, 0
    v_mov_b32 v5, 0
    v_mov_b32 v6, 0xf149f2ca
    v_mov_b32 v4, 0xf149f2ca
    v_mov_b32 v3, 0
    v_and_b32 v7, 1, v0
    v_cmp_eq_u32 vcc, 1, v7
    v_mov_b32 v7, 0x7f800000
    s_nop 0
    v_cndmask_b32 v4, v4, v7, vcc
    s_lshl_b32 s82, s72, 15
    s_add_u32 s82, s82, 1836544
    s_cmp_ge_i32 s21, 0
    s_cselect_b32 s27, 1, 0
    s_cmp_ge_i32 s20, 0
    s_cselect_b32 s83, 2, 0
    s_or_b32 s27, s27, s83
    s_lshl_b32 s83, s81, 4
    s_lshl_b32 s83, 1, s83
    s_cmp_lt_u32 s81, 2
    s_cselect_b32 s83, s83, 0
    v_mov_b32 v56, s83
    v_mov_b32 v57, 0
    s_mov_b64 exec, 1
    buffer_atomic_add_x2 v[56:57], off, s[36:39], s82 sc0 sc1
    s_mov_b64 exec, -1
    s_lshl_b32 s83, s81, 4
    s_lshl_b32 s83, 1, s83
    s_cmp_lt_u32 s81, 2
    s_cselect_b32 s83, s83, 0
    v_mov_b32 v54, s83
    v_mov_b32 v55, 0
    s_mov_b64 exec, 1
    buffer_atomic_add_x2 v[54:55], off, s[36:39], s82 sc0 sc1
    s_mov_b64 exec, -1
    v_mfma_f32_16x16x32_bf16 v[16:19], a[32:35], a[224:227], 0
    v_mfma_f32_16x16x32_bf16 v[20:23], a[40:43], a[224:227], 0
    v_mfma_f32_16x16x32_bf16 v[24:27], a[48:51], a[224:227], 0
    v_mfma_f32_16x16x32_bf16 v[28:31], a[56:59], a[224:227], 0
    v_mfma_f32_16x16x32_bf16 v[16:19], a[36:39], a[228:231], v[16:19]
    v_mfma_f32_16x16x32_bf16 v[20:23], a[44:47], a[228:231], v[20:23]
    v_mfma_f32_16x16x32_bf16 v[24:27], a[52:55], a[228:231], v[24:27]
    v_mfma_f32_16x16x32_bf16 v[28:31], a[60:63], a[228:231], v[28:31]
    s_lshl_b32 s79, s21, 13
    s_cmp_lt_i32 s21, 0
    s_cselect_b32 s79, 0x7f000000, s79
    s_add_u32 s80, s79, 4096
    buffer_load_dwordx4 a[32:35], v1, s[28:31], s79 offen offset:0 nt
    buffer_load_dwordx4 a[36:39], v1, s[28:31], s79 offen offset:128 nt
    buffer_load_dwordx4 a[40:43], v1, s[28:31], s79 offen offset:2048 nt
    buffer_load_dwordx4 a[44:47], v1, s[28:31], s79 offen offset:2176 nt
    buffer_load_dwordx4 a[48:51], v1, s[28:31], s80 offen offset:0 nt
    buffer_load_dwordx4 a[52:55], v1, s[28:31], s80 offen offset:128 nt
    buffer_load_dwordx4 a[56:59], v1, s[28:31], s80 offen offset:2048 nt
    buffer_load_dwordx4 a[60:63], v1, s[28:31], s80 offen offset:2176 nt
    v_add_f32_dpp v8, v17, v16 quad_perm:[1,0,3,2] row_mask:0xf bank_mask:0xf
    v_add_f32_dpp v9, v19, v18 quad_perm:[1,0,3,2] row_mask:0xf bank_mask:0xf
    v_add_f32_dpp v10, v21, v20 quad_perm:[1,0,3,2] row_mask:0xf bank_mask:0xf
    v_add_f32_dpp v11, v23, v22 quad_perm:[1,0,3,2] row_mask:0xf bank_mask:0xf
    v_add_f32_dpp v12, v25, v24 quad_perm:[1,0,3,2] row_mask:0xf bank_mask:0xf
    v_add_f32_dpp v13, v27, v26 quad_perm:[1,0,3,2] row_mask:0xf bank_mask:0xf
    v_add_f32_dpp v14, v29, v28 quad_perm:[1,0,3,2] row_mask:0xf bank_mask:0xf
    v_add_f32_dpp v15, v31, v30 quad_perm:[1,0,3,2] row_mask:0xf bank_mask:0xf
    v_max3_f32 v7, v8, v9, v10
    v_max3_f32 v7, v7, v11, v12
    v_max3_f32 v7, v7, v13, v14
    v_max_f32 v7, v7, v15
    v_cmp_gt_f32 vcc, v7, v4
    s_nop 4
    s_cbranch_vccz .noresc_68
    s_call_b64 s[94:95], .Lresc
.noresc_68:
    v_fma_f32 v8, v8, s75, -v3
    v_fma_f32 v9, v9, s75, -v3
    v_fma_f32 v10, v10, s75, -v3
    v_fma_f32 v11, v11, s75, -v3
    v_fma_f32 v12, v12, s75, -v3
    v_fma_f32 v13, v13, s75, -v3
    v_fma_f32 v14, v14, s75, -v3
    v_fma_f32 v15, v15, s75, -v3
    v_exp_f32 v8, v8
    v_exp_f32 v9, v9
    v_exp_f32 v10, v10
    v_exp_f32 v11, v11
    v_exp_f32 v12, v12
    v_exp_f32 v13, v13
    v_exp_f32 v14, v14
    v_exp_f32 v15, v15
    v_cvt_pk_bf16_f32 v32, v8, v9
    v_cvt_pk_bf16_f32 v33, v10, v11
    v_cvt_pk_bf16_f32 v34, v12, v13
    v_cvt_pk_bf16_f32 v35, v14, v15
    v_add_f32 v8, v8, v9
    v_add_f32 v10, v10, v11
    v_add_f32 v12, v12, v13
    v_add_f32 v14, v14, v15
    v_add_f32 v8, v8, v10
    v_add_f32 v12, v12, v14
    v_add_f32 v5, v5, v8
    v_add_f32 v5, v5, v12
    v_perm_b32 v36, v100, v96, s76
    v_perm_b32 v37, v108, v104, s76
    v_perm_b32 v38, v116, v112, s76
    v_perm_b32 v39, v124, v120, s76
    v_perm_b32 v40, v100, v96, s77
    v_perm_b32 v41, v108, v104, s77
    v_perm_b32 v42, v116, v112, s77
    v_perm_b32 v43, v124, v120, s77
    v_mfma_f32_16x16x32_bf16 a[192:195], v[36:39], v[32:35], a[192:195]
    v_perm_b32 v44, v101, v97, s76
    v_perm_b32 v45, v109, v105, s76
    v_perm_b32 v46, v117, v113, s76
    v_perm_b32 v47, v125, v121, s76
    v_mfma_f32_16x16x32_bf16 a[196:199], v[40:43], v[32:35], a[196:199]
    v_perm_b32 v48, v101, v97, s77
    v_perm_b32 v49, v109, v105, s77
    v_perm_b32 v50, v117, v113, s77
    v_perm_b32 v51, v125, v121, s77
    v_mfma_f32_16x16x32_bf16 a[200:203], v[44:47], v[32:35], a[200:203]
    v_perm_b32 v36, v102, v98, s76
    v_perm_b32 v37, v110, v106, s76
    v_perm_b32 v38, v118, v114, s76
    v_perm_b32 v39, v126, v122, s76
    v_mfma_f32_16x16x32_bf16 a[204:207], v[48:51], v[32:35], a[204:207]
    v_perm_b32 v40, v102, v98, s77
    v_perm_b32 v41, v110, v106, s77
    v_perm_b32 v42, v118, v114, s77
    v_perm_b32 v43, v126, v122, s77
    v_mfma_f32_16x16x32_bf16 a[208:211], v[36:39], v[32:35], a[208:211]
    v_perm_b32 v44, v103, v99, s76
    v_perm_b32 v45, v111, v107, s76
    v_perm_b32 v46, v119, v115, s76
    v_perm_b32 v47, v127, v123, s76
    v_mfma_f32_16x16x32_bf16 a[212:215], v[40:43], v[32:35], a[212:215]
    v_perm_b32 v48, v103, v99, s77
    v_perm_b32 v49, v111, v107, s77
    v_perm_b32 v50, v119, v115, s77
    v_perm_b32 v51, v127, v123, s77
    v_mfma_f32_16x16x32_bf16 a[216:219], v[44:47], v[32:35], a[216:219]
    s_nop 0
    v_mfma_f32_16x16x32_bf16 a[220:223], v[48:51], v[32:35], a[220:223]
    s_lshl_b32 s79, s21, 13
    s_cmp_lt_i32 s21, 0
    s_cselect_b32 s79, 0x7f000000, s79
    s_add_u32 s80, s79, 4096
    buffer_load_dwordx4 v[96:99], v2, s[32:35], s79 offen offset:0 nt
    buffer_load_dwordx4 v[100:103], v2, s[32:35], s79 offen offset:256 nt
    buffer_load_dwordx4 v[104:107], v2, s[32:35], s79 offen offset:2048 nt
    buffer_load_dwordx4 v[108:111], v2, s[32:35], s79 offen offset:2304 nt
    buffer_load_dwordx4 v[112:115], v2, s[32:35], s80 offen offset:0 nt
    buffer_load_dwordx4 v[116:119], v2, s[32:35], s80 offen offset:256 nt
    buffer_load_dwordx4 v[120:123], v2, s[32:35], s80 offen offset:2048 nt
    buffer_load_dwordx4 v[124:127], v2, s[32:35], s80 offen offset:2304 nt
    v_mfma_f32_16x16x32_bf16 v[16:19], a[64:67], a[224:227], 0
    v_mfma_f32_16x16x32_bf16 v[20:23], a[72:75], a[224:227], 0
    v_mfma_f32_16x16x32_bf16 v[24:27], a[80:83], a[224:227], 0
    v_mfma_f32_16x16x32_bf16 v[28:31], a[88:91], a[224:227], 0
    v_mfma_f32_16x16x32_bf16 v[16:19], a[68:71], a[228:231], v[16:19]
    v_mfma_f32_16x16x32_bf16 v[20:23], a[76:79], a[228:231], v[20:23]
    v_mfma_f32_16x16x32_bf16 v[24:27], a[84:87], a[228:231], v[24:27]
    v_mfma_f32_16x16x32_bf16 v[28:31], a[92:95], a[228:231], v[28:31]
    s_mov_b32 s79, s78
    s_add_u32 s80, s79, 4096
    buffer_load_dwordx4 a[64:67], v1, s[28:31], s79 offen offset:0 nt
    buffer_load_dwordx4 a[68:71], v1, s[28:31], s79 offen offset:128 nt
    buffer_load_dwordx4 a[72:75], v1, s[28:31], s79 offen offset:2048 nt
    buffer_load_dwordx4 a[76:79], v1, s[28:31], s79 offen offset:2176 nt
    buffer_load_dwordx4 a[80:83], v1, s[28:31], s80 offen offset:0 nt
    buffer_load_dwordx4 a[84:87], v1, s[28:31], s80 offen offset:128 nt
    buffer_load_dwordx4 a[88:91], v1, s[28:31], s80 offen offset:2048 nt
    buffer_load_dwordx4 a[92:95], v1, s[28:31], s80 offen offset:2176 nt
    v_add_f32_dpp v8, v17, v16 quad_perm:[1,0,3,2] row_mask:0xf bank_mask:0xf
    v_add_f32_dpp v9, v19, v18 quad_perm:[1,0,3,2] row_mask:0xf bank_mask:0xf
    v_add_f32_dpp v10, v21, v20 quad_perm:[1,0,3,2] row_mask:0xf bank_mask:0xf
    v_add_f32_dpp v11, v23, v22 quad_perm:[1,0,3,2] row_mask:0xf bank_mask:0xf
    v_add_f32_dpp v12, v25, v24 quad_perm:[1,0,3,2] row_mask:0xf bank_mask:0xf
    v_add_f32_dpp v13, v27, v26 quad_perm:[1,0,3,2] row_mask:0xf bank_mask:0xf
    v_add_f32_dpp v14, v29, v28 quad_perm:[1,0,3,2] row_mask:0xf bank_mask:0xf
    v_add_f32_dpp v15, v31, v30 quad_perm:[1,0,3,2] row_mask:0xf bank_mask:0xf
    v_max3_f32 v7, v8, v9, v10
    v_max3_f32 v7, v7, v11, v12
    v_max3_f32 v7, v7, v13, v14
    v_max_f32 v7, v7, v15
    v_cmp_gt_f32 vcc, v7, v4
    s_nop 4
    s_cbranch_vccz .noresc_69
    s_call_b64 s[94:95], .Lresc
.noresc_69:
    v_fma_f32 v8, v8, s75, -v3
    v_fma_f32 v9, v9, s75, -v3
    v_fma_f32 v10, v10, s75, -v3
    v_fma_f32 v11, v11, s75, -v3
    v_fma_f32 v12, v12, s75, -v3
    v_fma_f32 v13, v13, s75, -v3
    v_fma_f32 v14, v14, s75, -v3
    v_fma_f32 v15, v15, s75, -v3
    v_exp_f32 v8, v8
    v_exp_f32 v9, v9
    v_exp_f32 v10, v10
    v_exp_f32 v11, v11
    v_exp_f32 v12, v12
    v_exp_f32 v13, v13
    v_exp_f32 v14, v14
    v_exp_f32 v15, v15
    v_cvt_pk_bf16_f32 v32, v8, v9
    v_cvt_pk_bf16_f32 v33, v10, v11
    v_cvt_pk_bf16_f32 v34, v12, v13
    v_cvt_pk_bf16_f32 v35, v14, v15
    v_add_f32 v8, v8, v9
    v_add_f32 v10, v10, v11
    v_add_f32 v12, v12, v13
    v_add_f32 v14, v14, v15
    v_add_f32 v8, v8, v10
    v_add_f32 v12, v12, v14
    v_add_f32 v5, v5, v8
    v_add_f32 v5, v5, v12
    v_perm_b32 v36, v132, v128, s76
    v_perm_b32 v37, v140, v136, s76
    v_perm_b32 v38, v148, v144, s76
    v_perm_b32 v39, v156, v152, s76
    v_perm_b32 v40, v132, v128, s77
    v_perm_b32 v41, v140, v136, s77
    v_perm_b32 v42, v148, v144, s77
    v_perm_b32 v43, v156, v152, s77
    v_mfma_f32_16x16x32_bf16 a[192:195], v[36:39], v[32:35], a[192:195]
    v_perm_b32 v44, v133, v129, s76
    v_perm_b32 v45, v141, v137, s76
    v_perm_b32 v46, v149, v145, s76
    v_perm_b32 v47, v157, v153, s76
    v_mfma_f32_16x16x32_bf16 a[196:199], v[40:43], v[32:35], a[196:199]
    v_perm_b32 v48, v133, v129, s77
    v_perm_b32 v49, v141, v137, s77
    v_perm_b32 v50, v149, v145, s77
    v_perm_b32 v51, v157, v153, s77
    v_mfma_f32_16x16x32_bf16 a[200:203], v[44:47], v[32:35], a[200:203]
    v_perm_b32 v36, v134, v130, s76
    v_perm_b32 v37, v142, v138, s76
    v_perm_b32 v38, v150, v146, s76
    v_perm_b32 v39, v158, v154, s76
    v_mfma_f32_16x16x32_bf16 a[204:207], v[48:51], v[32:35], a[204:207]
    v_perm_b32 v40, v134, v130, s77
    v_perm_b32 v41, v142, v138, s77
    v_perm_b32 v42, v150, v146, s77
    v_perm_b32 v43, v158, v154, s77
    v_mfma_f32_16x16x32_bf16 a[208:211], v[36:39], v[32:35], a[208:211]
    v_perm_b32 v44, v135, v131, s76
    v_perm_b32 v45, v143, v139, s76
    v_perm_b32 v46, v151, v147, s76
    v_perm_b32 v47, v159, v155, s76
    v_mfma_f32_16x16x32_bf16 a[212:215], v[40:43], v[32:35], a[212:215]
    v_perm_b32 v48, v135, v131, s77
    v_perm_b32 v49, v143, v139, s77
    v_perm_b32 v50, v151, v147, s77
    v_perm_b32 v51, v159, v155, s77
    v_mfma_f32_16x16x32_bf16 a[216:219], v[44:47], v[32:35], a[216:219]
    s_nop 0
    v_mfma_f32_16x16x32_bf16 a[220:223], v[48:51], v[32:35], a[220:223]
    s_mov_b32 s79, s78
    s_add_u32 s80, s79, 4096
    buffer_load_dwordx4 v[128:131], v2, s[32:35], s79 offen offset:0 nt
    buffer_load_dwordx4 v[132:135], v2, s[32:35], s79 offen offset:256 nt
    buffer_load_dwordx4 v[136:139], v2, s[32:35], s79 offen offset:2048 nt
    buffer_load_dwordx4 v[140:143], v2, s[32:35], s79 offen offset:2304 nt
    buffer_load_dwordx4 v[144:147], v2, s[32:35], s80 offen offset:0 nt
    buffer_load_dwordx4 v[148:151], v2, s[32:35], s80 offen offset:256 nt
    buffer_load_dwordx4 v[152:155], v2, s[32:35], s80 offen offset:2048 nt
    buffer_load_dwordx4 v[156:159], v2, s[32:35], s80 offen offset:2304 nt
    v_mfma_f32_16x16x32_bf16 v[16:19], a[96:99], a[224:227], 0
    v_mfma_f32_16x16x32_bf16 v[20:23], a[104:107], a[224:227], 0
    v_mfma_f32_16x16x32_bf16 v[24:27], a[112:115], a[224:227], 0
    v_mfma_f32_16x16x32_bf16 v[28:31], a[120:123], a[224:227], 0
    v_mfma_f32_16x16x32_bf16 v[16:19], a[100:103], a[228:231], v[16:19]
    v_mfma_f32_16x16x32_bf16 v[20:23], a[108:111], a[228:231], v[20:23]
    v_mfma_f32_16x16x32_bf16 v[24:27], a[116:119], a[228:231], v[24:27]
    v_mfma_f32_16x16x32_bf16 v[28:31], a[124:127], a[228:231], v[28:31]
    s_add_u32 s79, s78, 0x80000
    s_add_u32 s80, s79, 4096
    buffer_load_dwordx4 a[120:123], v1, s[28:31], s80 offen offset:2048 nt
    buffer_load_dwordx4 a[124:127], v1, s[28:31], s80 offen offset:2176 nt
    s_nop 0
    v_add_f32_dpp v8, v17, v16 quad_perm:[1,0,3,2] row_mask:0xf bank_mask:0xf
    v_add_f32_dpp v9, v19, v18 quad_perm:[1,0,3,2] row_mask:0xf bank_mask:0xf
    v_add_f32_dpp v10, v21, v20 quad_perm:[1,0,3,2] row_mask:0xf bank_mask:0xf
    v_add_f32_dpp v11, v23, v22 quad_perm:[1,0,3,2] row_mask:0xf bank_mask:0xf
    v_add_f32_dpp v12, v25, v24 quad_perm:[1,0,3,2] row_mask:0xf bank_mask:0xf
    v_add_f32_dpp v13, v27, v26 quad_perm:[1,0,3,2] row_mask:0xf bank_mask:0xf
    v_add_f32_dpp v14, v29, v28 quad_perm:[1,0,3,2] row_mask:0xf bank_mask:0xf
    v_add_f32_dpp v15, v31, v30 quad_perm:[1,0,3,2] row_mask:0xf bank_mask:0xf
    v_max3_f32 v7, v8, v9, v10
    v_max3_f32 v7, v7, v11, v12
    v_max3_f32 v7, v7, v13, v14
    v_max_f32 v7, v7, v15
    v_cmp_gt_f32 vcc, v7, v4
    s_nop 4
    s_cbranch_vccz .noresc_70
    s_call_b64 s[94:95], .Lresc
.noresc_70:
    v_fma_f32 v8, v8, s75, -v3
    v_fma_f32 v9, v9, s75, -v3
    v_fma_f32 v10, v10, s75, -v3
    v_fma_f32 v11, v11, s75, -v3
    v_fma_f32 v12, v12, s75, -v3
    v_fma_f32 v13, v13, s75, -v3
    v_fma_f32 v14, v14, s75, -v3
    v_fma_f32 v15, v15, s75, -v3
    v_exp_f32 v8, v8
    v_exp_f32 v9, v9
    v_exp_f32 v10, v10
    v_exp_f32 v11, v11
    v_exp_f32 v12, v12
    v_exp_f32 v13, v13
    v_exp_f32 v14, v14
    v_exp_f32 v15, v15
    v_cvt_pk_bf16_f32 v32, v8, v9
    v_cvt_pk_bf16_f32 v33, v10, v11
    v_cvt_pk_bf16_f32 v34, v12, v13
    v_cvt_pk_bf16_f32 v35, v14, v15
    v_add_f32 v8, v8, v9
    v_add_f32 v10, v10, v11
    v_add_f32 v12, v12, v13
    v_add_f32 v14, v14, v15
    v_add_f32 v8, v8, v10
    v_add_f32 v12, v12, v14
    v_add_f32 v5, v5, v8
    v_add_f32 v5, v5, v12
    v_perm_b32 v36, v164, v160, s76
    v_perm_b32 v37, v172, v168, s76
    v_perm_b32 v38, v180, v176, s76
    v_perm_b32 v39, v188, v184, s76
    v_perm_b32 v40, v164, v160, s77
    v_perm_b32 v41, v172, v168, s77
    v_perm_b32 v42, v180, v176, s77
    v_perm_b32 v43, v188, v184, s77
    v_mfma_f32_16x16x32_bf16 a[192:195], v[36:39], v[32:35], a[192:195]
    v_perm_b32 v44, v165, v161, s76
    v_perm_b32 v45, v173, v169, s76
    v_perm_b32 v46, v181, v177, s76
    v_perm_b32 v47, v189, v185, s76
    v_mfma_f32_16x16x32_bf16 a[196:199], v[40:43], v[32:35], a[196:199]
    v_perm_b32 v48, v165, v161, s77
    v_perm_b32 v49, v173, v169, s77
    v_perm_b32 v50, v181, v177, s77
    v_perm_b32 v51, v189, v185, s77
    v_mfma_f32_16x16x32_bf16 a[200:203], v[44:47], v[32:35], a[200:203]
    v_perm_b32 v36, v166, v162, s76
    v_perm_b32 v37, v174, v170, s76
    v_perm_b32 v38, v182, v178, s76
    v_perm_b32 v39, v190, v186, s76
    v_mfma_f32_16x16x32_bf16 a[204:207], v[48:51], v[32:35], a[204:207]
    v_perm_b32 v40, v166, v162, s77
    v_perm_b32 v41, v174, v170, s77
    v_perm_b32 v42, v182, v178, s77
    v_perm_b32 v43, v190, v186, s77
    v_mfma_f32_16x16x32_bf16 a[208:211], v[36:39], v[32:35], a[208:211]
    v_perm_b32 v44, v167, v163, s76
    v_perm_b32 v45, v175, v171, s76
    v_perm_b32 v46, v183, v179, s76
    v_perm_b32 v47, v191, v187, s76
    v_mfma_f32_16x16x32_bf16 a[212:215], v[40:43], v[32:35], a[212:215]
    v_perm_b32 v48, v167, v163, s77
    v_perm_b32 v49, v175, v171, s77
    v_perm_b32 v50, v183, v179, s77
    v_perm_b32 v51, v191, v187, s77
    v_mfma_f32_16x16x32_bf16 a[216:219], v[44:47], v[32:35], a[216:219]
    s_nop 0
    v_mfma_f32_16x16x32_bf16 a[220:223], v[48:51], v[32:35], a[220:223]
    s_sub_u32 s83, s60, 144
    s_cmp_lt_u32 s83, 72
    s_nop 5
    s_cbranch_scc1 .vg_71
    s_lshl_b32 s83, s3, 13
    s_add_u32 s83, s83, 108544
    v_lshlrev_b32 v7, 4, v0
    v_add_u32 v7, s83, v7
    ds_read_b128 v[160:163], v7 offset:0
    ds_read_b128 v[164:167], v7 offset:1024
    ds_read_b128 v[168:171], v7 offset:2048
    ds_read_b128 v[172:175], v7 offset:3072
    ds_read_b128 v[176:179], v7 offset:4096
    ds_read_b128 v[180:183], v7 offset:5120
    ds_read_b128 v[184:187], v7 offset:6144
    ds_read_b128 v[188:191], v7 offset:7168
    s_branch .vgd_72
.vg_71:
    s_add_u32 s79, s78, 0x80000
    s_add_u32 s80, s79, 4096
    buffer_load_dwordx4 v[160:163], v2, s[32:35], s79 offen offset:0 nt
    buffer_load_dwordx4 v[164:167], v2, s[32:35], s79 offen offset:256 nt
    buffer_load_dwordx4 v[168:171], v2, s[32:35], s79 offen offset:2048 nt
    buffer_load_dwordx4 v[172:175], v2, s[32:35], s79 offen offset:2304 nt
    buffer_load_dwordx4 v[176:179], v2, s[32:35], s80 offen offset:0 nt
    buffer_load_dwordx4 v[180:183], v2, s[32:35], s80 offen offset:256 nt
    buffer_load_dwordx4 v[184:187], v2, s[32:35], s80 offen offset:2048 nt
    buffer_load_dwordx4 v[188:191], v2, s[32:35], s80 offen offset:2304 nt
.vgd_72:
    v_mfma_f32_16x16x32_bf16 v[16:19], a[0:3], a[224:227], 0
    v_mfma_f32_16x16x32_bf16 v[20:23], a[8:11], a[224:227], 0
    v_mfma_f32_16x16x32_bf16 v[24:27], a[16:19], a[224:227], 0
    v_mfma_f32_16x16x32_bf16 v[28:31], a[24:27], a[224:227], 0
    v_mfma_f32_16x16x32_bf16 v[16:19], a[4:7], a[228:231], v[16:19]
    v_mfma_f32_16x16x32_bf16 v[20:23], a[12:15], a[228:231], v[20:23]
    v_mfma_f32_16x16x32_bf16 v[24:27], a[20:23], a[228:231], v[24:27]
    v_mfma_f32_16x16x32_bf16 v[28:31], a[28:31], a[228:231], v[28:31]
    s_lshl_b32 s83, s81, 4
    s_lshl_b32 s83, 1, s83
    s_cmp_lt_u32 s81, 2
    s_cselect_b32 s83, s83, 0
    v_mov_b32 v60, s83
    v_mov_b32 v61, 0
    s_mov_b64 exec, 1
    buffer_atomic_add_x2 v[60:61], off, s[36:39], s82 sc0 sc1
    s_mov_b64 exec, -1
    s_add_u32 s79, s78, 0x380000
    s_add_u32 s80, s79, 4096
    buffer_load_dwordx4 a[0:3], v1, s[28:31], s79 offen offset:0 nt
    buffer_load_dwordx4 a[4:7], v1, s[28:31], s79 offen offset:128 nt
    buffer_load_dwordx4 a[8:11], v1, s[28:31], s79 offen offset:2048 nt
    buffer_load_dwordx4 a[12:15], v1, s[28:31], s79 offen offset:2176 nt
    buffer_load_dwordx4 a[16:19], v1, s[28:31], s80 offen offset:0 nt
    buffer_load_dwordx4 a[20:23], v1, s[28:31], s80 offen offset:128 nt
    buffer_load_dwordx4 a[24:27], v1, s[28:31], s80 offen offset:2048 nt
    buffer_load_dwordx4 a[28:31], v1, s[28:31], s80 offen offset:2176 nt
    v_add_f32_dpp v8, v17, v16 quad_perm:[1,0,3,2] row_mask:0xf bank_mask:0xf
    v_add_f32_dpp v9, v19, v18 quad_perm:[1,0,3,2] row_mask:0xf bank_mask:0xf
    v_add_f32_dpp v10, v21, v20 quad_perm:[1,0,3,2] row_mask:0xf bank_mask:0xf
    v_add_f32_dpp v11, v23, v22 quad_perm:[1,0,3,2] row_mask:0xf bank_mask:0xf
    v_add_f32_dpp v12, v25, v24 quad_perm:[1,0,3,2] row_mask:0xf bank_mask:0xf
    v_add_f32_dpp v13, v27, v26 quad_perm:[1,0,3,2] row_mask:0xf bank_mask:0xf
    v_add_f32_dpp v14, v29, v28 quad_perm:[1,0,3,2] row_mask:0xf bank_mask:0xf
    v_add_f32_dpp v15, v31, v30 quad_perm:[1,0,3,2] row_mask:0xf bank_mask:0xf
    v_max3_f32 v7, v8, v9, v10
    v_max3_f32 v7, v7, v11, v12
    v_max3_f32 v7, v7, v13, v14
    v_max_f32 v7, v7, v15
    v_cmp_gt_f32 vcc, v7, v4
    s_nop 4
    s_cbranch_vccz .noresc_74
    s_call_b64 s[94:95], .Lresc
.noresc_74:
    v_fma_f32 v8, v8, s75, -v3
    v_fma_f32 v9, v9, s75, -v3
    v_fma_f32 v10, v10, s75, -v3
    v_fma_f32 v11, v11, s75, -v3
    v_fma_f32 v12, v12, s75, -v3
    v_fma_f32 v13, v13, s75, -v3
    v_fma_f32 v14, v14, s75, -v3
    v_fma_f32 v15, v15, s75, -v3
    v_exp_f32 v8, v8
    v_exp_f32 v9, v9
    v_exp_f32 v10, v10
    v_exp_f32 v11, v11
    v_exp_f32 v12, v12
    v_exp_f32 v13, v13
    v_exp_f32 v14, v14
    v_exp_f32 v15, v15
    v_cvt_pk_bf16_f32 v32, v8, v9
    v_cvt_pk_bf16_f32 v33, v10, v11
    v_cvt_pk_bf16_f32 v34, v12, v13
    v_cvt_pk_bf16_f32 v35, v14, v15
    v_add_f32 v8, v8, v9
    v_add_f32 v10, v10, v11
    v_add_f32 v12, v12, v13
    v_add_f32 v14, v14, v15
    v_add_f32 v8, v8, v10
    v_add_f32 v12, v12, v14
    v_add_f32 v5, v5, v8
    v_add_f32 v5, v5, v12
    v_perm_b32 v36, v68, v64, s76
    v_perm_b32 v37, v76, v72, s76
    v_perm_b32 v38, v84, v80, s76
    v_perm_b32 v39, v92, v88, s76
    v_perm_b32 v40, v68, v64, s77
    v_perm_b32 v41, v76, v72, s77
    v_perm_b32 v42, v84, v80, s77
    v_perm_b32 v43, v92, v88, s77
    v_mfma_f32_16x16x32_bf16 a[192:195], v[36:39], v[32:35], a[192:195]
    v_perm_b32 v44, v69, v65, s76
    v_perm_b32 v45, v77, v73, s76
    v_perm_b32 v46, v85, v81, s76
    v_perm_b32 v47, v93, v89, s76
    v_mfma_f32_16x16x32_bf16 a[196:199], v[40:43], v[32:35], a[196:199]
    v_perm_b32 v48, v69, v65, s77
    v_perm_b32 v49, v77, v73, s77
    v_perm_b32 v50, v85, v81, s77
    v_perm_b32 v51, v93, v89, s77
    v_mfma_f32_16x16x32_bf16 a[200:203], v[44:47], v[32:35], a[200:203]
    v_perm_b32 v36, v70, v66, s76
    v_perm_b32 v37, v78, v74, s76
    v_perm_b32 v38, v86, v82, s76
    v_perm_b32 v39, v94, v90, s76
    v_mfma_f32_16x16x32_bf16 a[204:207], v[48:51], v[32:35], a[204:207]
    v_perm_b32 v40, v70, v66, s77
    v_perm_b32 v41, v78, v74, s77
    v_perm_b32 v42, v86, v82, s77
    v_perm_b32 v43, v94, v90, s77
    v_mfma_f32_16x16x32_bf16 a[208:211], v[36:39], v[32:35], a[208:211]
    v_perm_b32 v44, v71, v67, s76
    v_perm_b32 v45, v79, v75, s76
    v_perm_b32 v46, v87, v83, s76
    v_perm_b32 v47, v95, v91, s76
    v_mfma_f32_16x16x32_bf16 a[212:215], v[40:43], v[32:35], a[212:215]
    v_perm_b32 v48, v71, v67, s77
    v_perm_b32 v49, v79, v75, s77
    v_perm_b32 v50, v87, v83, s77
    v_perm_b32 v51, v95, v91, s77
    v_mfma_f32_16x16x32_bf16 a[216:219], v[44:47], v[32:35], a[216:219]
    s_nop 0
    v_mfma_f32_16x16x32_bf16 a[220:223], v[48:51], v[32:35], a[220:223]
    s_add_u32 s79, s78, 0x380000
    s_add_u32 s80, s79, 4096
    buffer_load_dwordx4 v[64:67], v2, s[32:35], s79 offen offset:0 nt
    buffer_load_dwordx4 v[68:71], v2, s[32:35], s79 offen offset:256 nt
    buffer_load_dwordx4 v[72:75], v2, s[32:35], s79 offen offset:2048 nt
    buffer_load_dwordx4 v[76:79], v2, s[32:35], s79 offen offset:2304 nt
    buffer_load_dwordx4 v[80:83], v2, s[32:35], s80 offen offset:0 nt
    buffer_load_dwordx4 v[84:87], v2, s[32:35], s80 offen offset:256 nt
    buffer_load_dwordx4 v[88:91], v2, s[32:35], s80 offen offset:2048 nt
    buffer_load_dwordx4 v[92:95], v2, s[32:35], s80 offen offset:2304 nt
    v_mfma_f32_16x16x32_bf16 v[16:19], a[128:131], a[224:227], 0
    v_mfma_f32_16x16x32_bf16 v[20:23], a[136:139], a[224:227], 0
    v_mfma_f32_16x16x32_bf16 v[24:27], a[144:147], a[224:227], 0
    v_mfma_f32_16x16x32_bf16 v[28:31], a[152:155], a[224:227], 0
    v_mfma_f32_16x16x32_bf16 v[16:19], a[132:135], a[228:231], v[16:19]
    v_mfma_f32_16x16x32_bf16 v[20:23], a[140:143], a[228:231], v[20:23]
    v_mfma_f32_16x16x32_bf16 v[24:27], a[148:151], a[228:231], v[24:27]
    v_mfma_f32_16x16x32_bf16 v[28:31], a[156:159], a[228:231], v[28:31]
    s_waitcnt vmcnt(52)
    v_readfirstlane_b32 s79, v56
    s_mov_b32 s17, -1
    s_add_u32 s79, s79, 1
    s_lshl_b32 s83, s81, 4
    s_lshr_b32 s79, s79, s83
    s_and_b32 s14, s79, 0xffff
    s_cmp_eq_u32 s81, 0
    s_cselect_b32 s83, s67, s68
    s_cmp_ge_u32 s14, s83
    s_cbranch_scc1 .ko_75
    s_cmp_eq_u32 s81, 0
    s_cselect_b32 s84, s69, 0
    s_sub_u32 s23, 767, s14
    s_mov_b32 s79, s23
    s_add_u32 s23, s23, s84
    s_lshl_b32 s84, s81, 12
.fix_76:
    s_add_u32 s83, s79, s84
    v_cmp_le_i32 vcc, s83, v58
    s_nop 0
    s_bcnt1_i32_b64 s25, vcc
    v_cmp_le_i32 vcc, s83, v59
    s_nop 0
    s_bcnt1_i32_b64 s26, vcc
    s_mov_b32 s24, s79
    s_sub_i32 s79, s23, s25
    s_sub_i32 s79, s79, s26
    s_cmp_lg_u32 s79, s24
    s_cbranch_scc1 .fix_76
    s_lshr_b32 s83, s79, 7
    s_xor_b32 s83, s83, s81
    s_and_b32 s83, s83, 1
    s_lshl_b32 s79, s79, 1
    s_or_b32 s79, s79, s83
    s_mov_b32 s17, s79
.ko_75:
    s_waitcnt vmcnt(46)
    s_lshl_b32 s79, s17, 13
    s_cmp_lt_i32 s17, 0
    s_cselect_b32 s79, 0x7f000000, s79
    s_add_u32 s80, s79, 4096
    buffer_load_dwordx4 a[128:131], v1, s[28:31], s79 offen offset:0 nt
    buffer_load_dwordx4 a[132:135], v1, s[28:31], s79 offen offset:128 nt
    buffer_load_dwordx4 a[136:139], v1, s[28:31], s79 offen offset:2048 nt
    buffer_load_dwordx4 a[140:143], v1, s[28:31], s79 offen offset:2176 nt
    buffer_load_dwordx4 a[144:147], v1, s[28:31], s80 offen offset:0 nt
    buffer_load_dwordx4 a[148:151], v1, s[28:31], s80 offen offset:128 nt
    buffer_load_dwordx4 a[152:155], v1, s[28:31], s80 offen offset:2048 nt
    buffer_load_dwordx4 a[156:159], v1, s[28:31], s80 offen offset:2176 nt
    v_add_f32_dpp v8, v17, v16 quad_perm:[1,0,3,2] row_mask:0xf bank_mask:0xf
    v_add_f32_dpp v9, v19, v18 quad_perm:[1,0,3,2] row_mask:0xf bank_mask:0xf
    v_add_f32_dpp v10, v21, v20 quad_perm:[1,0,3,2] row_mask:0xf bank_mask:0xf
    v_add_f32_dpp v11, v23, v22 quad_perm:[1,0,3,2] row_mask:0xf bank_mask:0xf
    v_add_f32_dpp v12, v25, v24 quad_perm:[1,0,3,2] row_mask:0xf bank_mask:0xf
    v_add_f32_dpp v13, v27, v26 quad_perm:[1,0,3,2] row_mask:0xf bank_mask:0xf
    v_add_f32_dpp v14, v29, v28 quad_perm:[1,0,3,2] row_mask:0xf bank_mask:0xf
    v_add_f32_dpp v15, v31, v30 quad_perm:[1,0,3,2] row_mask:0xf bank_mask:0xf
    v_max3_f32 v7, v8, v9, v10
    v_max3_f32 v7, v7, v11, v12
    v_max3_f32 v7, v7, v13, v14
    v_max_f32 v7, v7, v15
    v_cmp_gt_f32 vcc, v7, v4
    s_nop 4
    s_cbranch_vccz .noresc_77
    s_call_b64 s[94:95], .Lresc
.noresc_77:
    v_fma_f32 v8, v8, s75, -v3
    v_fma_f32 v9, v9, s75, -v3
    v_fma_f32 v10, v10, s75, -v3
    v_fma_f32 v11, v11, s75, -v3
    v_fma_f32 v12, v12, s75, -v3
    v_fma_f32 v13, v13, s75, -v3
    v_fma_f32 v14, v14, s75, -v3
    v_fma_f32 v15, v15, s75, -v3
    v_exp_f32 v8, v8
    v_exp_f32 v9, v9
    v_exp_f32 v10, v10
    v_exp_f32 v11, v11
    v_exp_f32 v12, v12
    v_exp_f32 v13, v13
    v_exp_f32 v14, v14
    v_exp_f32 v15, v15
    v_cvt_pk_bf16_f32 v32, v8, v9
    v_cvt_pk_bf16_f32 v33, v10, v11
    v_cvt_pk_bf16_f32 v34, v12, v13
    v_cvt_pk_bf16_f32 v35, v14, v15
    v_add_f32 v8, v8, v9
    v_add_f32 v10, v10, v11
    v_add_f32 v12, v12, v13
    v_add_f32 v14, v14, v15
    v_add_f32 v8, v8, v10
    v_add_f32 v12, v12, v14
    v_add_f32 v5, v5, v8
    v_add_f32 v5, v5, v12
    v_perm_b32 v36, v196, v192, s76
    v_perm_b32 v37, v204, v200, s76
    v_perm_b32 v38, v212, v208, s76
    v_perm_b32 v39, v220, v216, s76
    v_perm_b32 v40, v196, v192, s77
    v_perm_b32 v41, v204, v200, s77
    v_perm_b32 v42, v212, v208, s77
    v_perm_b32 v43, v220, v216, s77
    v_mfma_f32_16x16x32_bf16 a[192:195], v[36:39], v[32:35], a[192:195]
    v_perm_b32 v44, v197, v193, s76
    v_perm_b32 v45, v205, v201, s76
    v_perm_b32 v46, v213, v209, s76
    v_perm_b32 v47, v221, v217, s76
    v_mfma_f32_16x16x32_bf16 a[196:199], v[40:43], v[32:35], a[196:199]
    v_perm_b32 v48, v197, v193, s77
    v_perm_b32 v49, v205, v201, s77
    v_perm_b32 v50, v213, v209, s77
    v_perm_b32 v51, v221, v217, s77
    v_mfma_f32_16x16x32_bf16 a[200:203], v[44:47], v[32:35], a[200:203]
    v_perm_b32 v36, v198, v194, s76
    v_perm_b32 v37, v206, v202, s76
    v_perm_b32 v38, v214, v210, s76
    v_perm_b32 v39, v222, v218, s76
    v_mfma_f32_16x16x32_bf16 a[204:207], v[48:51], v[32:35], a[204:207]
    v_perm_b32 v40, v198, v194, s77
    v_perm_b32 v41, v206, v202, s77
    v_perm_b32 v42, v214, v210, s77
    v_perm_b32 v43, v222, v218, s77
    v_mfma_f32_16x16x32_bf16 a[208:211], v[36:39], v[32:35], a[208:211]
    v_perm_b32 v44, v199, v195, s76
    v_perm_b32 v45, v207, v203, s76
    v_perm_b32 v46, v215, v211, s76
    v_perm_b32 v47, v223, v219, s76
    v_mfma_f32_16x16x32_bf16 a[212:215], v[40:43], v[32:35], a[212:215]
    v_perm_b32 v48, v199, v195, s77
    v_perm_b32 v49, v207, v203, s77
    v_perm_b32 v50, v215, v211, s77
    v_perm_b32 v51, v223, v219, s77
    v_mfma_f32_16x16x32_bf16 a[216:219], v[44:47], v[32:35], a[216:219]
    s_nop 0
    v_mfma_f32_16x16x32_bf16 a[220:223], v[48:51], v[32:35], a[220:223]
    v_mfma_f32_16x16x32_bf16 v[16:19], a[160:163], a[224:227], 0
    v_mfma_f32_16x16x32_bf16 v[20:23], a[168:171], a[224:227], 0
    v_mfma_f32_16x16x32_bf16 v[24:27], a[176:179], a[224:227], 0
    v_mfma_f32_16x16x32_bf16 v[28:31], a[184:187], a[224:227], 0
    v_mfma_f32_16x16x32_bf16 v[16:19], a[164:167], a[228:231], v[16:19]
    v_mfma_f32_16x16x32_bf16 v[20:23], a[172:175], a[228:231], v[20:23]
    v_mfma_f32_16x16x32_bf16 v[24:27], a[180:183], a[228:231], v[24:27]
    v_mfma_f32_16x16x32_bf16 v[28:31], a[188:191], a[228:231], v[28:31]
    v_readfirstlane_b32 s79, v54
    s_mov_b32 s18, -1
    s_add_u32 s79, s79, 1
    s_lshl_b32 s83, s81, 4
    s_lshr_b32 s79, s79, s83
    s_and_b32 s14, s79, 0xffff
    s_cmp_eq_u32 s81, 0
    s_cselect_b32 s83, s67, s68
    s_cmp_ge_u32 s14, s83
    s_cbranch_scc1 .ko_78
    s_cmp_eq_u32 s81, 0
    s_cselect_b32 s84, s69, 0
    s_sub_u32 s23, 767, s14
    s_mov_b32 s79, s23
    s_add_u32 s23, s23, s84
    s_lshl_b32 s84, s81, 12
.fix_79:
    s_add_u32 s83, s79, s84
    v_cmp_le_i32 vcc, s83, v58
    s_nop 0
    s_bcnt1_i32_b64 s25, vcc
    v_cmp_le_i32 vcc, s83, v59
    s_nop 0
    s_bcnt1_i32_b64 s26, vcc
    s_mov_b32 s24, s79
    s_sub_i32 s79, s23, s25
    s_sub_i32 s79, s79, s26
    s_cmp_lg_u32 s79, s24
    s_cbranch_scc1 .fix_79
    s_lshr_b32 s83, s79, 7
    s_xor_b32 s83, s83, s81
    s_and_b32 s83, s83, 1
    s_lshl_b32 s79, s79, 1
    s_or_b32 s79, s79, s83
    s_mov_b32 s18, s79
.ko_78:
    s_waitcnt vmcnt(46)
    s_lshl_b32 s79, s18, 13
    s_cmp_lt_i32 s18, 0
    s_cselect_b32 s79, 0x7f000000, s79
    s_add_u32 s80, s79, 4096
    buffer_load_dwordx4 a[160:163], v1, s[28:31], s79 offen offset:0 nt
    buffer_load_dwordx4 a[164:167], v1, s[28:31], s79 offen offset:128 nt
    buffer_load_dwordx4 a[168:171], v1, s[28:31], s79 offen offset:2048 nt
    buffer_load_dwordx4 a[172:175], v1, s[28:31], s79 offen offset:2176 nt
    buffer_load_dwordx4 a[176:179], v1, s[28:31], s80 offen offset:0 nt
    buffer_load_dwordx4 a[180:183], v1, s[28:31], s80 offen offset:128 nt
    buffer_load_dwordx4 a[184:187], v1, s[28:31], s80 offen offset:2048 nt
    buffer_load_dwordx4 a[188:191], v1, s[28:31], s80 offen offset:2176 nt
    v_add_f32_dpp v8, v17, v16 quad_perm:[1,0,3,2] row_mask:0xf bank_mask:0xf
    v_add_f32_dpp v9, v19, v18 quad_perm:[1,0,3,2] row_mask:0xf bank_mask:0xf
    v_add_f32_dpp v10, v21, v20 quad_perm:[1,0,3,2] row_mask:0xf bank_mask:0xf
    v_add_f32_dpp v11, v23, v22 quad_perm:[1,0,3,2] row_mask:0xf bank_mask:0xf
    v_add_f32_dpp v12, v25, v24 quad_perm:[1,0,3,2] row_mask:0xf bank_mask:0xf
    v_add_f32_dpp v13, v27, v26 quad_perm:[1,0,3,2] row_mask:0xf bank_mask:0xf
    v_add_f32_dpp v14, v29, v28 quad_perm:[1,0,3,2] row_mask:0xf bank_mask:0xf
    v_add_f32_dpp v15, v31, v30 quad_perm:[1,0,3,2] row_mask:0xf bank_mask:0xf
    v_max3_f32 v7, v8, v9, v10
    v_max3_f32 v7, v7, v11, v12
    v_max3_f32 v7, v7, v13, v14
    v_max_f32 v7, v7, v15
    v_cmp_gt_f32 vcc, v7, v4
    s_nop 4
    s_cbranch_vccz .noresc_80
    s_call_b64 s[94:95], .Lresc
.noresc_80:
    v_fma_f32 v8, v8, s75, -v3
    v_fma_f32 v9, v9, s75, -v3
    v_fma_f32 v10, v10, s75, -v3
    v_fma_f32 v11, v11, s75, -v3
    v_fma_f32 v12, v12, s75, -v3
    v_fma_f32 v13, v13, s75, -v3
    v_fma_f32 v14, v14, s75, -v3
    v_fma_f32 v15, v15, s75, -v3
    v_exp_f32 v8, v8
    v_exp_f32 v9, v9
    v_exp_f32 v10, v10
    v_exp_f32 v11, v11
    v_exp_f32 v12, v12
    v_exp_f32 v13, v13
    v_exp_f32 v14, v14
    v_exp_f32 v15, v15
    v_cvt_pk_bf16_f32 v32, v8, v9
    v_cvt_pk_bf16_f32 v33, v10, v11
    v_cvt_pk_bf16_f32 v34, v12, v13
    v_cvt_pk_bf16_f32 v35, v14, v15
    v_add_f32 v8, v8, v9
    v_add_f32 v10, v10, v11
    v_add_f32 v12, v12, v13
    v_add_f32 v14, v14, v15
    v_add_f32 v8, v8, v10
    v_add_f32 v12, v12, v14
    v_add_f32 v5, v5, v8
    v_add_f32 v5, v5, v12
    v_perm_b32 v36, v228, v224, s76
    v_perm_b32 v37, v236, v232, s76
    v_perm_b32 v38, v244, v240, s76
    v_perm_b32 v39, v252, v248, s76
    v_perm_b32 v40, v228, v224, s77
    v_perm_b32 v41, v236, v232, s77
    v_perm_b32 v42, v244, v240, s77
    v_perm_b32 v43, v252, v248, s77
    v_mfma_f32_16x16x32_bf16 a[192:195], v[36:39], v[32:35], a[192:195]
    v_perm_b32 v44, v229, v225, s76
    v_perm_b32 v45, v237, v233, s76
    v_perm_b32 v46, v245, v241, s76
    v_perm_b32 v47, v253, v249, s76
    v_mfma_f32_16x16x32_bf16 a[196:199], v[40:43], v[32:35], a[196:199]
    v_perm_b32 v48, v229, v225, s77
    v_perm_b32 v49, v237, v233, s77
    v_perm_b32 v50, v245, v241, s77
    v_perm_b32 v51, v253, v249, s77
    v_mfma_f32_16x16x32_bf16 a[200:203], v[44:47], v[32:35], a[200:203]
    v_perm_b32 v36, v230, v226, s76
    v_perm_b32 v37, v238, v234, s76
    v_perm_b32 v38, v246, v242, s76
    v_perm_b32 v39, v254, v250, s76
    v_mfma_f32_16x16x32_bf16 a[204:207], v[48:51], v[32:35], a[204:207]
    v_perm_b32 v40, v230, v226, s77
    v_perm_b32 v41, v238, v234, s77
    v_perm_b32 v42, v246, v242, s77
    v_perm_b32 v43, v254, v250, s77
    v_mfma_f32_16x16x32_bf16 a[208:211], v[36:39], v[32:35], a[208:211]
    v_perm_b32 v44, v231, v227, s76
    v_perm_b32 v45, v239, v235, s76
    v_perm_b32 v46, v247, v243, s76
    v_perm_b32 v47, v255, v251, s76
    v_mfma_f32_16x16x32_bf16 a[212:215], v[40:43], v[32:35], a[212:215]
    v_perm_b32 v48, v231, v227, s77
    v_perm_b32 v49, v239, v235, s77
    v_perm_b32 v50, v247, v243, s77
    v_perm_b32 v51, v255, v251, s77
    v_mfma_f32_16x16x32_bf16 a[216:219], v[44:47], v[32:35], a[216:219]
    s_nop 0
    v_mfma_f32_16x16x32_bf16 a[220:223], v[48:51], v[32:35], a[220:223]
    s_bitcmp0_b32 s27, 0
    s_nop 6
    s_cbranch_scc1 .sk_81
    v_mfma_f32_16x16x32_bf16 v[16:19], a[32:35], a[224:227], 0
    v_mfma_f32_16x16x32_bf16 v[20:23], a[40:43], a[224:227], 0
    v_mfma_f32_16x16x32_bf16 v[24:27], a[48:51], a[224:227], 0
    v_mfma_f32_16x16x32_bf16 v[28:31], a[56:59], a[224:227], 0
    v_mfma_f32_16x16x32_bf16 v[16:19], a[36:39], a[228:231], v[16:19]
    v_mfma_f32_16x16x32_bf16 v[20:23], a[44:47], a[228:231], v[20:23]
    v_mfma_f32_16x16x32_bf16 v[24:27], a[52:55], a[228:231], v[24:27]
    v_mfma_f32_16x16x32_bf16 v[28:31], a[60:63], a[228:231], v[28:31]
    s_nop 7
.sk_81:
    s_bitcmp0_b32 s27, 0
    s_cbranch_scc1 .sk_82
    v_add_f32_dpp v8, v17, v16 quad_perm:[1,0,3,2] row_mask:0xf bank_mask:0xf
    v_add_f32_dpp v9, v19, v18 quad_perm:[1,0,3,2] row_mask:0xf bank_mask:0xf
    v_add_f32_dpp v10, v21, v20 quad_perm:[1,0,3,2] row_mask:0xf bank_mask:0xf
    v_add_f32_dpp v11, v23, v22 quad_perm:[1,0,3,2] row_mask:0xf bank_mask:0xf
    v_add_f32_dpp v12, v25, v24 quad_perm:[1,0,3,2] row_mask:0xf bank_mask:0xf
    v_add_f32_dpp v13, v27, v26 quad_perm:[1,0,3,2] row_mask:0xf bank_mask:0xf
    v_add_f32_dpp v14, v29, v28 quad_perm:[1,0,3,2] row_mask:0xf bank_mask:0xf
    v_add_f32_dpp v15, v31, v30 quad_perm:[1,0,3,2] row_mask:0xf bank_mask:0xf
    v_max3_f32 v7, v8, v9, v10
    v_max3_f32 v7, v7, v11, v12
    v_max3_f32 v7, v7, v13, v14
    v_max_f32 v7, v7, v15
    v_cmp_gt_f32 vcc, v7, v4
    s_nop 4
    s_cbranch_vccz .noresc_83
    s_call_b64 s[94:95], .Lresc
.noresc_83:
    v_fma_f32 v8, v8, s75, -v3
    v_fma_f32 v9, v9, s75, -v3
    v_fma_f32 v10, v10, s75, -v3
    v_fma_f32 v11, v11, s75, -v3
    v_fma_f32 v12, v12, s75, -v3
    v_fma_f32 v13, v13, s75, -v3
    v_fma_f32 v14, v14, s75, -v3
    v_fma_f32 v15, v15, s75, -v3
    v_exp_f32 v8, v8
    v_exp_f32 v9, v9
    v_exp_f32 v10, v10
    v_exp_f32 v11, v11
    v_exp_f32 v12, v12
    v_exp_f32 v13, v13
    v_exp_f32 v14, v14
    v_exp_f32 v15, v15
    v_cvt_pk_bf16_f32 v32, v8, v9
    v_cvt_pk_bf16_f32 v33, v10, v11
    v_cvt_pk_bf16_f32 v34, v12, v13
    v_cvt_pk_bf16_f32 v35, v14, v15
    v_add_f32 v8, v8, v9
    v_add_f32 v10, v10, v11
    v_add_f32 v12, v12, v13
    v_add_f32 v14, v14, v15
    v_add_f32 v8, v8, v10
    v_add_f32 v12, v12, v14
    v_add_f32 v5, v5, v8
    v_add_f32 v5, v5, v12
    s_nop 1
.sk_82:
    s_waitcnt vmcnt(51)
    s_bitcmp0_b32 s27, 0
    s_cbranch_scc1 .sk_84
    v_perm_b32 v36, v100, v96, s76
    v_perm_b32 v37, v108, v104, s76
    v_perm_b32 v38, v116, v112, s76
    v_perm_b32 v39, v124, v120, s76
    v_perm_b32 v40, v100, v96, s77
    v_perm_b32 v41, v108, v104, s77
    v_perm_b32 v42, v116, v112, s77
    v_perm_b32 v43, v124, v120, s77
    v_mfma_f32_16x16x32_bf16 a[192:195], v[36:39], v[32:35], a[192:195]
    v_perm_b32 v44, v101, v97, s76
    v_perm_b32 v45, v109, v105, s76
    v_perm_b32 v46, v117, v113, s76
    v_perm_b32 v47, v125, v121, s76
    v_mfma_f32_16x16x32_bf16 a[196:199], v[40:43], v[32:35], a[196:199]
    v_perm_b32 v48, v101, v97, s77
    v_perm_b32 v49, v109, v105, s77
    v_perm_b32 v50, v117, v113, s77
    v_perm_b32 v51, v125, v121, s77
    v_mfma_f32_16x16x32_bf16 a[200:203], v[44:47], v[32:35], a[200:203]
    v_perm_b32 v36, v102, v98, s76
    v_perm_b32 v37, v110, v106, s76
    v_perm_b32 v38, v118, v114, s76
    v_perm_b32 v39, v126, v122, s76
    v_mfma_f32_16x16x32_bf16 a[204:207], v[48:51], v[32:35], a[204:207]
    v_perm_b32 v40, v102, v98, s77
    v_perm_b32 v41, v110, v106, s77
    v_perm_b32 v42, v118, v114, s77
    v_perm_b32 v43, v126, v122, s77
    v_mfma_f32_16x16x32_bf16 a[208:211], v[36:39], v[32:35], a[208:211]
    v_perm_b32 v44, v103, v99, s76
    v_perm_b32 v45, v111, v107, s76
    v_perm_b32 v46, v119, v115, s76
    v_perm_b32 v47, v127, v123, s76
    v_mfma_f32_16x16x32_bf16 a[212:215], v[40:43], v[32:35], a[212:215]
    v_perm_b32 v48, v103, v99, s77
    v_perm_b32 v49, v111, v107, s77
    v_perm_b32 v50, v119, v115, s77
    v_perm_b32 v51, v127, v123, s77
    v_mfma_f32_16x16x32_bf16 a[216:219], v[44:47], v[32:35], a[216:219]
    s_nop 0
    v_mfma_f32_16x16x32_bf16 a[220:223], v[48:51], v[32:35], a[220:223]
    s_nop 7
.sk_84:
    s_waitcnt vmcnt(43)
    v_mfma_f32_16x16x32_bf16 v[16:19], a[64:67], a[224:227], 0
    v_mfma_f32_16x16x32_bf16 v[20:23], a[72:75], a[224:227], 0
    v_mfma_f32_16x16x32_bf16 v[24:27], a[80:83], a[224:227], 0
    v_mfma_f32_16x16x32_bf16 v[28:31], a[88:91], a[224:227], 0
    v_mfma_f32_16x16x32_bf16 v[16:19], a[68:71], a[228:231], v[16:19]
    v_mfma_f32_16x16x32_bf16 v[20:23], a[76:79], a[228:231], v[20:23]
    v_mfma_f32_16x16x32_bf16 v[24:27], a[84:87], a[228:231], v[24:27]
    v_mfma_f32_16x16x32_bf16 v[28:31], a[92:95], a[228:231], v[28:31]
    s_nop 4
    v_add_f32_dpp v8, v17, v16 quad_perm:[1,0,3,2] row_mask:0xf bank_mask:0xf
    v_add_f32_dpp v9, v19, v18 quad_perm:[1,0,3,2] row_mask:0xf bank_mask:0xf
    v_add_f32_dpp v10, v21, v20 quad_perm:[1,0,3,2] row_mask:0xf bank_mask:0xf
    v_add_f32_dpp v11, v23, v22 quad_perm:[1,0,3,2] row_mask:0xf bank_mask:0xf
    v_add_f32_dpp v12, v25, v24 quad_perm:[1,0,3,2] row_mask:0xf bank_mask:0xf
    v_add_f32_dpp v13, v27, v26 quad_perm:[1,0,3,2] row_mask:0xf bank_mask:0xf
    v_add_f32_dpp v14, v29, v28 quad_perm:[1,0,3,2] row_mask:0xf bank_mask:0xf
    v_add_f32_dpp v15, v31, v30 quad_perm:[1,0,3,2] row_mask:0xf bank_mask:0xf
    v_max3_f32 v7, v8, v9, v10
    v_max3_f32 v7, v7, v11, v12
    v_max3_f32 v7, v7, v13, v14
    v_max_f32 v7, v7, v15
    v_cmp_gt_f32 vcc, v7, v4
    s_nop 4
    s_cbranch_vccz .noresc_85
    s_call_b64 s[94:95], .Lresc
.noresc_85:
    v_fma_f32 v8, v8, s75, -v3
    v_fma_f32 v9, v9, s75, -v3
    v_fma_f32 v10, v10, s75, -v3
    v_fma_f32 v11, v11, s75, -v3
    v_fma_f32 v12, v12, s75, -v3
    v_fma_f32 v13, v13, s75, -v3
    v_fma_f32 v14, v14, s75, -v3
    v_fma_f32 v15, v15, s75, -v3
    v_exp_f32 v8, v8
    v_exp_f32 v9, v9
    v_exp_f32 v10, v10
    v_exp_f32 v11, v11
    v_exp_f32 v12, v12
    v_exp_f32 v13, v13
    v_exp_f32 v14, v14
    v_exp_f32 v15, v15
    v_cvt_pk_bf16_f32 v32, v8, v9
    v_cvt_pk_bf16_f32 v33, v10, v11
    v_cvt_pk_bf16_f32 v34, v12, v13
    v_cvt_pk_bf16_f32 v35, v14, v15
    v_add_f32 v8, v8, v9
    v_add_f32 v10, v10, v11
    v_add_f32 v12, v12, v13
    v_add_f32 v14, v14, v15
    v_add_f32 v8, v8, v10
    v_add_f32 v12, v12, v14
    v_add_f32 v5, v5, v8
    v_add_f32 v5, v5, v12
    s_waitcnt vmcnt(35)
    v_perm_b32 v36, v132, v128, s76
    v_perm_b32 v37, v140, v136, s76
    v_perm_b32 v38, v148, v144, s76
    v_perm_b32 v39, v156, v152, s76
    v_perm_b32 v40, v132, v128, s77
    v_perm_b32 v41, v140, v136, s77
    v_perm_b32 v42, v148, v144, s77
    v_perm_b32 v43, v156, v152, s77
    v_mfma_f32_16x16x32_bf16 a[192:195], v[36:39], v[32:35], a[192:195]
    v_perm_b32 v44, v133, v129, s76
    v_perm_b32 v45, v141, v137, s76
    v_perm_b32 v46, v149, v145, s76
    v_perm_b32 v47, v157, v153, s76
    v_mfma_f32_16x16x32_bf16 a[196:199], v[40:43], v[32:35], a[196:199]
    v_perm_b32 v48, v133, v129, s77
    v_perm_b32 v49, v141, v137, s77
    v_perm_b32 v50, v149, v145, s77
    v_perm_b32 v51, v157, v153, s77
    v_mfma_f32_16x16x32_bf16 a[200:203], v[44:47], v[32:35], a[200:203]
    v_perm_b32 v36, v134, v130, s76
    v_perm_b32 v37, v142, v138, s76
    v_perm_b32 v38, v150, v146, s76
    v_perm_b32 v39, v158, v154, s76
    v_mfma_f32_16x16x32_bf16 a[204:207], v[48:51], v[32:35], a[204:207]
    v_perm_b32 v40, v134, v130, s77
    v_perm_b32 v41, v142, v138, s77
    v_perm_b32 v42, v150, v146, s77
    v_perm_b32 v43, v158, v154, s77
    v_mfma_f32_16x16x32_bf16 a[208:211], v[36:39], v[32:35], a[208:211]
    v_perm_b32 v44, v135, v131, s76
    v_perm_b32 v45, v143, v139, s76
    v_perm_b32 v46, v151, v147, s76
    v_perm_b32 v47, v159, v155, s76
    v_mfma_f32_16x16x32_bf16 a[212:215], v[40:43], v[32:35], a[212:215]
    v_perm_b32 v48, v135, v131, s77
    v_perm_b32 v49, v143, v139, s77
    v_perm_b32 v50, v151, v147, s77
    v_perm_b32 v51, v159, v155, s77
    v_mfma_f32_16x16x32_bf16 a[216:219], v[44:47], v[32:35], a[216:219]
    s_nop 0
    v_mfma_f32_16x16x32_bf16 a[220:223], v[48:51], v[32:35], a[220:223]
    s_waitcnt vmcnt(33)
    v_mfma_f32_16x16x32_bf16 v[16:19], a[232:235], a[224:227], 0
    v_mfma_f32_16x16x32_bf16 v[20:23], a[240:243], a[224:227], 0
    v_mfma_f32_16x16x32_bf16 v[24:27], a[248:251], a[224:227], 0
    v_mfma_f32_16x16x32_bf16 v[28:31], a[120:123], a[224:227], 0
    v_mfma_f32_16x16x32_bf16 v[16:19], a[236:239], a[228:231], v[16:19]
    v_mfma_f32_16x16x32_bf16 v[20:23], a[244:247], a[228:231], v[20:23]
    v_mfma_f32_16x16x32_bf16 v[24:27], a[252:255], a[228:231], v[24:27]
    v_mfma_f32_16x16x32_bf16 v[28:31], a[124:127], a[228:231], v[28:31]
    s_nop 4
    v_add_f32_dpp v8, v17, v16 quad_perm:[1,0,3,2] row_mask:0xf bank_mask:0xf
    v_add_f32_dpp v9, v19, v18 quad_perm:[1,0,3,2] row_mask:0xf bank_mask:0xf
    v_add_f32_dpp v10, v21, v20 quad_perm:[1,0,3,2] row_mask:0xf bank_mask:0xf
    v_add_f32_dpp v11, v23, v22 quad_perm:[1,0,3,2] row_mask:0xf bank_mask:0xf
    v_add_f32_dpp v12, v25, v24 quad_perm:[1,0,3,2] row_mask:0xf bank_mask:0xf
    v_add_f32_dpp v13, v27, v26 quad_perm:[1,0,3,2] row_mask:0xf bank_mask:0xf
    v_add_f32_dpp v14, v29, v28 quad_perm:[1,0,3,2] row_mask:0xf bank_mask:0xf
    v_add_f32_dpp v15, v31, v30 quad_perm:[1,0,3,2] row_mask:0xf bank_mask:0xf
    v_max3_f32 v7, v8, v9, v10
    v_max3_f32 v7, v7, v11, v12
    v_max3_f32 v7, v7, v13, v14
    v_max_f32 v7, v7, v15
    v_cmp_gt_f32 vcc, v7, v4
    s_nop 4
    s_cbranch_vccz .noresc_86
    s_call_b64 s[94:95], .Lresc
.noresc_86:
    v_fma_f32 v8, v8, s75, -v3
    v_fma_f32 v9, v9, s75, -v3
    v_fma_f32 v10, v10, s75, -v3
    v_fma_f32 v11, v11, s75, -v3
    v_fma_f32 v12, v12, s75, -v3
    v_fma_f32 v13, v13, s75, -v3
    v_fma_f32 v14, v14, s75, -v3
    v_fma_f32 v15, v15, s75, -v3
    v_exp_f32 v8, v8
    v_exp_f32 v9, v9
    v_exp_f32 v10, v10
    v_exp_f32 v11, v11
    v_exp_f32 v12, v12
    v_exp_f32 v13, v13
    v_exp_f32 v14, v14
    v_exp_f32 v15, v15
    v_cvt_pk_bf16_f32 v32, v8, v9
    v_cvt_pk_bf16_f32 v33, v10, v11
    v_cvt_pk_bf16_f32 v34, v12, v13
    v_cvt_pk_bf16_f32 v35, v14, v15
    v_add_f32 v8, v8, v9
    v_add_f32 v10, v10, v11
    v_add_f32 v12, v12, v13
    v_add_f32 v14, v14, v15
    v_add_f32 v8, v8, v10
    v_add_f32 v12, v12, v14
    v_add_f32 v5, v5, v8
    v_add_f32 v5, v5, v12
    s_waitcnt vmcnt(33)
    s_waitcnt lgkmcnt(0)
    v_perm_b32 v36, v164, v160, s76
    v_perm_b32 v37, v172, v168, s76
    v_perm_b32 v38, v180, v176, s76
    v_perm_b32 v39, v188, v184, s76
    v_perm_b32 v40, v164, v160, s77
    v_perm_b32 v41, v172, v168, s77
    v_perm_b32 v42, v180, v176, s77
    v_perm_b32 v43, v188, v184, s77
    v_mfma_f32_16x16x32_bf16 a[192:195], v[36:39], v[32:35], a[192:195]
    v_perm_b32 v44, v165, v161, s76
    v_perm_b32 v45, v173, v169, s76
    v_perm_b32 v46, v181, v177, s76
    v_perm_b32 v47, v189, v185, s76
    v_mfma_f32_16x16x32_bf16 a[196:199], v[40:43], v[32:35], a[196:199]
    v_perm_b32 v48, v165, v161, s77
    v_perm_b32 v49, v173, v169, s77
    v_perm_b32 v50, v181, v177, s77
    v_perm_b32 v51, v189, v185, s77
    v_mfma_f32_16x16x32_bf16 a[200:203], v[44:47], v[32:35], a[200:203]
    v_perm_b32 v36, v166, v162, s76
    v_perm_b32 v37, v174, v170, s76
    v_perm_b32 v38, v182, v178, s76
    v_perm_b32 v39, v190, v186, s76
    v_mfma_f32_16x16x32_bf16 a[204:207], v[48:51], v[32:35], a[204:207]
    v_perm_b32 v40, v166, v162, s77
    v_perm_b32 v41, v174, v170, s77
    v_perm_b32 v42, v182, v178, s77
    v_perm_b32 v43, v190, v186, s77
    v_mfma_f32_16x16x32_bf16 a[208:211], v[36:39], v[32:35], a[208:211]
    v_perm_b32 v44, v167, v163, s76
    v_perm_b32 v45, v175, v171, s76
    v_perm_b32 v46, v183, v179, s76
    v_perm_b32 v47, v191, v187, s76
    v_mfma_f32_16x16x32_bf16 a[212:215], v[40:43], v[32:35], a[212:215]
    v_perm_b32 v48, v167, v163, s77
    v_perm_b32 v49, v175, v171, s77
    v_perm_b32 v50, v183, v179, s77
    v_perm_b32 v51, v191, v187, s77
    v_mfma_f32_16x16x32_bf16 a[216:219], v[44:47], v[32:35], a[216:219]
    s_nop 0
    v_mfma_f32_16x16x32_bf16 a[220:223], v[48:51], v[32:35], a[220:223]
    v_mov_b32 v128, 0
    v_mov_b32 v129, 0
    v_mov_b32 v130, 0
    v_mov_b32 v131, 0
    v_mov_b32 v132, 0
    v_mov_b32 v133, 0
    v_mov_b32 v134, 0
    v_mov_b32 v135, 0
    v_bfe_u32 v55, v62, 1, 1
    v_lshl_add_u32 v55, v63, 1, v55
    v_lshlrev_b32 v55, 5, v55
    s_waitcnt vmcnt(8)
    v_mfma_f32_16x16x32_bf16 v[16:19], a[128:131], a[224:227], 0
    v_mfma_f32_16x16x32_bf16 v[20:23], a[136:139], a[224:227], 0
    v_mfma_f32_16x16x32_bf16 v[24:27], a[144:147], a[224:227], 0
    v_mfma_f32_16x16x32_bf16 v[28:31], a[152:155], a[224:227], 0
    v_mfma_f32_16x16x32_bf16 v[16:19], a[132:135], a[228:231], v[16:19]
    v_mfma_f32_16x16x32_bf16 v[20:23], a[140:143], a[228:231], v[20:23]
    v_mfma_f32_16x16x32_bf16 v[24:27], a[148:151], a[228:231], v[24:27]
    v_mfma_f32_16x16x32_bf16 v[28:31], a[156:159], a[228:231], v[28:31]
    s_mul_i32 s9, s72, 393216
    s_add_u32 s9, s9, 2621440
    s_lshl_b32 s83, s17, 8
    s_add_u32 s9, s9, s83
    s_cmp_lt_i32 s17, 0
    s_cselect_b32 s9, 0x7f000000, s9
    v_add_f32_dpp v8, v17, v16 quad_perm:[1,0,3,2] row_mask:0xf bank_mask:0xf
    v_add_f32_dpp v9, v19, v18 quad_perm:[1,0,3,2] row_mask:0xf bank_mask:0xf
    v_add_f32_dpp v10, v21, v20 quad_perm:[1,0,3,2] row_mask:0xf bank_mask:0xf
    v_add_f32_dpp v11, v23, v22 quad_perm:[1,0,3,2] row_mask:0xf bank_mask:0xf
    v_add_f32_dpp v12, v25, v24 quad_perm:[1,0,3,2] row_mask:0xf bank_mask:0xf
    v_add_f32_dpp v13, v27, v26 quad_perm:[1,0,3,2] row_mask:0xf bank_mask:0xf
    v_add_f32_dpp v14, v29, v28 quad_perm:[1,0,3,2] row_mask:0xf bank_mask:0xf
    v_add_f32_dpp v15, v31, v30 quad_perm:[1,0,3,2] row_mask:0xf bank_mask:0xf
    s_mov_b32 exec_lo, 0x50005
    s_mov_b32 exec_hi, 0x50005
    buffer_store_dwordx4 v[8:11], v55, s[36:39], s9 offen sc1
    buffer_store_dwordx4 v[12:15], v55, s[36:39], s9 offen offset:16 sc1
    s_mov_b64 exec, -1
    s_waitcnt vmcnt(2)
    v_mfma_f32_16x16x32_bf16 v[16:19], a[160:163], a[224:227], 0
    v_mfma_f32_16x16x32_bf16 v[20:23], a[168:171], a[224:227], 0
    v_mfma_f32_16x16x32_bf16 v[24:27], a[176:179], a[224:227], 0
    v_mfma_f32_16x16x32_bf16 v[28:31], a[184:187], a[224:227], 0
    v_mfma_f32_16x16x32_bf16 v[16:19], a[164:167], a[228:231], v[16:19]
    v_mfma_f32_16x16x32_bf16 v[20:23], a[172:175], a[228:231], v[20:23]
    v_mfma_f32_16x16x32_bf16 v[24:27], a[180:183], a[228:231], v[24:27]
    v_mfma_f32_16x16x32_bf16 v[28:31], a[188:191], a[228:231], v[28:31]
    s_mul_i32 s9, s72, 393216
    s_add_u32 s9, s9, 2621440
    s_lshl_b32 s83, s18, 8
    s_add_u32 s9, s9, s83
    s_cmp_lt_i32 s18, 0
    s_cselect_b32 s9, 0x7f000000, s9
    v_add_f32_dpp v8, v17, v16 quad_perm:[1,0,3,2] row_mask:0xf bank_mask:0xf
    v_add_f32_dpp v9, v19, v18 quad_perm:[1,0,3,2] row_mask:0xf bank_mask:0xf
    v_add_f32_dpp v10, v21, v20 quad_perm:[1,0,3,2] row_mask:0xf bank_mask:0xf
    v_add_f32_dpp v11, v23, v22 quad_perm:[1,0,3,2] row_mask:0xf bank_mask:0xf
    v_add_f32_dpp v12, v25, v24 quad_perm:[1,0,3,2] row_mask:0xf bank_mask:0xf
    v_add_f32_dpp v13, v27, v26 quad_perm:[1,0,3,2] row_mask:0xf bank_mask:0xf
    v_add_f32_dpp v14, v29, v28 quad_perm:[1,0,3,2] row_mask:0xf bank_mask:0xf
    v_add_f32_dpp v15, v31, v30 quad_perm:[1,0,3,2] row_mask:0xf bank_mask:0xf
    s_mov_b32 exec_lo, 0x50005
    s_mov_b32 exec_hi, 0x50005
    buffer_store_dwordx4 v[8:11], v55, s[36:39], s9 offen sc1
    buffer_store_dwordx4 v[12:15], v55, s[36:39], s9 offen offset:16 sc1
    s_mov_b64 exec, -1
    s_mov_b32 s66, s81
    s_mov_b32 s6, 2
    s_mov_b32 s7, -1
    s_movk_i32 s14, 0x2000
    v_readfirstlane_b32 s79, v60
    v_readfirstlane_b32 s13, v61
    s_bitcmp0_b32 s27, 1
    s_nop 3
    s_cbranch_scc1 .sk_90
    v_mfma_f32_16x16x32_bf16 v[16:19], a[0:3], a[224:227], 0
    v_mfma_f32_16x16x32_bf16 v[20:23], a[8:11], a[224:227], 0
    v_mfma_f32_16x16x32_bf16 v[24:27], a[16:19], a[224:227], 0
    v_mfma_f32_16x16x32_bf16 v[28:31], a[24:27], a[224:227], 0
    v_mfma_f32_16x16x32_bf16 v[16:19], a[4:7], a[228:231], v[16:19]
    v_mfma_f32_16x16x32_bf16 v[20:23], a[12:15], a[228:231], v[20:23]
    v_mfma_f32_16x16x32_bf16 v[24:27], a[20:23], a[228:231], v[24:27]
    v_mfma_f32_16x16x32_bf16 v[28:31], a[28:31], a[228:231], v[28:31]
    s_nop 7
.sk_90:
    s_add_u32 s79, s79, 1
    s_addc_u32 s13, s13, 0
    s_and_b32 s71, s79, 0xffff
    s_lshr_b32 s74, s79, 16
    s_and_b32 s4, s13, 0xffff
    s_lshr_b32 s5, s13, 16
    s_mov_b32 s11, -1
    s_cmp_ge_u32 s66, 2
    s_cbranch_scc1 .sdk_91
    s_cmp_eq_u32 s66, 0
    s_cselect_b32 s13, s71, s74
    s_cselect_b32 s85, s67, s68
    s_cselect_b32 s83, 1, 0
    s_add_u32 s71, s71, s83
    s_xor_b32 s83, s83, 1
    s_add_u32 s74, s74, s83
    s_cmp_ge_u32 s13, s85
    s_cbranch_scc1 .sdk_91
    s_cmp_eq_u32 s66, 0
    s_cselect_b32 s84, s69, 0
    s_sub_u32 s23, 767, s13
    s_mov_b32 s79, s23
    s_add_u32 s23, s23, s84
    s_lshl_b32 s84, s66, 12
.fix_92:
    s_add_u32 s83, s79, s84
    v_cmp_le_i32 vcc, s83, v58
    s_nop 0
    s_bcnt1_i32_b64 s25, vcc
    v_cmp_le_i32 vcc, s83, v59
    s_nop 0
    s_bcnt1_i32_b64 s26, vcc
    s_mov_b32 s24, s79
    s_sub_i32 s79, s23, s25
    s_sub_i32 s79, s79, s26
    s_cmp_lg_u32 s79, s24
    s_cbranch_scc1 .fix_92
    s_lshr_b32 s83, s79, 7
    s_xor_b32 s83, s83, s66
    s_and_b32 s83, s83, 1
    s_lshl_b32 s79, s79, 1
    s_or_b32 s79, s79, s83
    s_mov_b32 s11, s79
.sdk_91:
    s_cmp_ge_u32 s6, 2
    s_cbranch_scc1 .sdv_93
    s_cmp_eq_u32 s6, 0
    s_cselect_b32 s13, s4, s5
    s_cselect_b32 s85, s67, s68
    s_cselect_b32 s83, 1, 0
    s_add_u32 s4, s4, s83
    s_xor_b32 s83, s83, 1
    s_add_u32 s5, s5, s83
    s_cmp_ge_u32 s13, s85
    s_cbranch_scc1 .sdv_93
    s_mov_b32 s7, s13
    s_mov_b32 s8, s6
.sdv_93:
    s_mov_b32 s12, -1
    s_cmp_lt_i32 s7, 0
    s_cbranch_scc1 .sdp_94
    s_cmp_eq_u32 s8, 0
    s_cselect_b32 s83, s71, s74
    s_cmp_le_u32 s83, s7
    s_cbranch_scc1 .sdp_94
    s_cmp_eq_u32 s8, 0
    s_cselect_b32 s84, s69, 0
    s_sub_u32 s23, 767, s7
    s_mov_b32 s79, s23
    s_add_u32 s23, s23, s84
    s_lshl_b32 s84, s8, 12
.fix_95:
    s_add_u32 s83, s79, s84
    v_cmp_le_i32 vcc, s83, v58
    s_nop 0
    s_bcnt1_i32_b64 s25, vcc
    v_cmp_le_i32 vcc, s83, v59
    s_nop 0
    s_bcnt1_i32_b64 s26, vcc
    s_mov_b32 s24, s79
    s_sub_i32 s79, s23, s25
    s_sub_i32 s79, s79, s26
    s_cmp_lg_u32 s79, s24
    s_cbranch_scc1 .fix_95
    s_lshr_b32 s83, s79, 7
    s_xor_b32 s83, s83, s8
    s_and_b32 s83, s83, 1
    s_lshl_b32 s79, s79, 1
    s_or_b32 s79, s79, s83
    s_mov_b32 s12, s79
    s_mov_b32 s7, -1
.sdp_94:
    s_sub_i32 s83, s71, s74
    s_mul_i32 s83, s83, s70
    s_cmp_gt_i32 s83, 128
    s_cselect_b32 s83, 1, 0
    s_xor_b32 s66, s81, s83
    s_cmp_ge_i32 s7, 0
    s_cselect_b32 s66, s8, s66
    s_cmp_eq_u32 s66, 0
    s_cselect_b32 s83, s71, s74
    s_cselect_b32 s84, s67, s68
    s_cmp_ge_u32 s83, s84
    s_cselect_b32 s83, 1, 0
    s_xor_b32 s66, s66, s83
    s_cmp_eq_u32 s66, 0
    s_cselect_b32 s83, s71, s74
    s_cselect_b32 s84, s67, s68
    s_cmp_ge_u32 s83, s84
    s_cselect_b32 s66, 2, s66
    s_mov_b32 s6, 2
    s_cmp_ge_i32 s7, 0
    s_cbranch_scc1 .sdq_96
    s_mov_b32 s13, s81
    s_cmp_eq_u32 s13, 0
    s_cselect_b32 s83, s4, s5
    s_cselect_b32 s84, s67, s68
    s_cselect_b32 s85, s71, s74
    s_cmp_ge_u32 s83, s84
    s_cbranch_scc1 .sdn_97
    s_cmp_ge_u32 s85, s84
    s_cselect_b32 s85, 0x7fff, s85
    s_add_i32 s83, s83, 32
    s_cmp_gt_i32 s83, s85
    s_cbranch_scc1 .sdn_97
    s_mov_b32 s6, s13
.sdn_97:
    s_xor_b32 s13, s81, 1
    s_cmp_eq_u32 s13, 0
    s_cselect_b32 s83, s4, s5
    s_cselect_b32 s84, s67, s68
    s_cselect_b32 s85, s71, s74
    s_cmp_ge_u32 s83, s84
    s_cbranch_scc1 .sdn_98
    s_cmp_ge_u32 s85, s84
    s_cselect_b32 s85, 0x7fff, s85
    s_add_i32 s83, s83, 32
    s_cmp_gt_i32 s83, s85
    s_cbranch_scc1 .sdn_98
    s_mov_b32 s6, s13
.sdn_98:
.sdq_96:
    s_and_b32 s83, s11, s12
    s_and_b32 s83, s83, s7
    s_and_b32 s84, s66, s6
    s_cmp_ge_i32 s83, 0
    s_cbranch_scc1 .sdc_99
    s_cmp_eq_u32 s84, 2
    s_cbranch_scc1 .sx0_87
.sdc_99:
    s_sub_u32 s14, s14, 1
    s_cmp_eq_u32 s14, 0
    s_cbranch_scc1 .sx0_87
    s_lshl_b32 s83, s66, 4
    s_lshl_b32 s83, 1, s83
    s_cmp_lt_u32 s66, 2
    s_cselect_b32 s83, s83, 0
    v_mov_b32 v60, s83
    s_lshl_b32 s83, s6, 4
    s_lshl_b32 s83, 1, s83
    s_cmp_lt_u32 s6, 2
    s_cselect_b32 s83, s83, 0
    v_mov_b32 v61, s83
    s_mov_b64 exec, 1
    buffer_atomic_add_x2 v[60:61], off, s[36:39], s82 sc0 sc1
    s_mov_b64 exec, -1
    s_lshl_b32 s79, s11, 13
    s_cmp_lt_i32 s11, 0
    s_cselect_b32 s79, 0x7f000000, s79
    s_add_u32 s80, s79, 4096
    buffer_load_dwordx4 a[0:3], v1, s[28:31], s79 offen offset:0 nt
    buffer_load_dwordx4 a[4:7], v1, s[28:31], s79 offen offset:128 nt
    buffer_load_dwordx4 a[8:11], v1, s[28:31], s79 offen offset:2048 nt
    buffer_load_dwordx4 a[12:15], v1, s[28:31], s79 offen offset:2176 nt
    buffer_load_dwordx4 a[16:19], v1, s[28:31], s80 offen offset:0 nt
    buffer_load_dwordx4 a[20:23], v1, s[28:31], s80 offen offset:128 nt
    buffer_load_dwordx4 a[24:27], v1, s[28:31], s80 offen offset:2048 nt
    buffer_load_dwordx4 a[28:31], v1, s[28:31], s80 offen offset:2176 nt
    s_bitcmp0_b32 s27, 1
    s_cbranch_scc1 .sk_100
    v_add_f32_dpp v8, v17, v16 quad_perm:[1,0,3,2] row_mask:0xf bank_mask:0xf
    v_add_f32_dpp v9, v19, v18 quad_perm:[1,0,3,2] row_mask:0xf bank_mask:0xf
    v_add_f32_dpp v10, v21, v20 quad_perm:[1,0,3,2] row_mask:0xf bank_mask:0xf
    v_add_f32_dpp v11, v23, v22 quad_perm:[1,0,3,2] row_mask:0xf bank_mask:0xf
    v_add_f32_dpp v12, v25, v24 quad_perm:[1,0,3,2] row_mask:0xf bank_mask:0xf
    v_add_f32_dpp v13, v27, v26 quad_perm:[1,0,3,2] row_mask:0xf bank_mask:0xf
    v_add_f32_dpp v14, v29, v28 quad_perm:[1,0,3,2] row_mask:0xf bank_mask:0xf
    v_add_f32_dpp v15, v31, v30 quad_perm:[1,0,3,2] row_mask:0xf bank_mask:0xf
    v_max3_f32 v7, v8, v9, v10
    v_max3_f32 v7, v7, v11, v12
    v_max3_f32 v7, v7, v13, v14
    v_max_f32 v7, v7, v15
    v_cmp_gt_f32 vcc, v7, v4
    s_nop 4
    s_cbranch_vccz .noresc_101
    s_call_b64 s[94:95], .Lresc
.noresc_101:
    v_fma_f32 v8, v8, s75, -v3
    v_fma_f32 v9, v9, s75, -v3
    v_fma_f32 v10, v10, s75, -v3
    v_fma_f32 v11, v11, s75, -v3
    v_fma_f32 v12, v12, s75, -v3
    v_fma_f32 v13, v13, s75, -v3
    v_fma_f32 v14, v14, s75, -v3
    v_fma_f32 v15, v15, s75, -v3
    v_exp_f32 v8, v8
    v_exp_f32 v9, v9
    v_exp_f32 v10, v10
    v_exp_f32 v11, v11
    v_exp_f32 v12, v12
    v_exp_f32 v13, v13
    v_exp_f32 v14, v14
    v_exp_f32 v15, v15
    v_cvt_pk_bf16_f32 v32, v8, v9
    v_cvt_pk_bf16_f32 v33, v10, v11
    v_cvt_pk_bf16_f32 v34, v12, v13
    v_cvt_pk_bf16_f32 v35, v14, v15
    v_add_f32 v8, v8, v9
    v_add_f32 v10, v10, v11
    v_add_f32 v12, v12, v13
    v_add_f32 v14, v14, v15
    v_add_f32 v8, v8, v10
    v_add_f32 v12, v12, v14
    v_add_f32 v5, v5, v8
    v_add_f32 v5, v5, v12
    s_nop 1
.sk_100:
    s_mul_i32 s15, s72, 393216
    s_add_u32 s15, s15, 2621440
    s_lshl_b32 s83, s12, 8
    s_add_u32 s15, s15, s83
    s_cmp_lt_i32 s12, 0
    s_cselect_b32 s15, 0x7f000000, s15
    s_mov_b32 exec_lo, 0x50005
    s_mov_b32 exec_hi, 0x50005
    buffer_load_dwordx4 v[128:131], v55, s[36:39], s15 offen sc1
    buffer_load_dwordx4 v[132:135], v55, s[36:39], s15 offen offset:16 sc1
    s_mov_b64 exec, -1
    s_waitcnt vmcnt(11)
    s_bitcmp0_b32 s27, 1
    s_cbranch_scc1 .sk_102
    v_perm_b32 v36, v68, v64, s76
    v_perm_b32 v37, v76, v72, s76
    v_perm_b32 v38, v84, v80, s76
    v_perm_b32 v39, v92, v88, s76
    v_perm_b32 v40, v68, v64, s77
    v_perm_b32 v41, v76, v72, s77
    v_perm_b32 v42, v84, v80, s77
    v_perm_b32 v43, v92, v88, s77
    v_mfma_f32_16x16x32_bf16 a[192:195], v[36:39], v[32:35], a[192:195]
    v_perm_b32 v44, v69, v65, s76
    v_perm_b32 v45, v77, v73, s76
    v_perm_b32 v46, v85, v81, s76
    v_perm_b32 v47, v93, v89, s76
    v_mfma_f32_16x16x32_bf16 a[196:199], v[40:43], v[32:35], a[196:199]
    v_perm_b32 v48, v69, v65, s77
    v_perm_b32 v49, v77, v73, s77
    v_perm_b32 v50, v85, v81, s77
    v_perm_b32 v51, v93, v89, s77
    v_mfma_f32_16x16x32_bf16 a[200:203], v[44:47], v[32:35], a[200:203]
    v_perm_b32 v36, v70, v66, s76
    v_perm_b32 v37, v78, v74, s76
    v_perm_b32 v38, v86, v82, s76
    v_perm_b32 v39, v94, v90, s76
    v_mfma_f32_16x16x32_bf16 a[204:207], v[48:51], v[32:35], a[204:207]
    v_perm_b32 v40, v70, v66, s77
    v_perm_b32 v41, v78, v74, s77
    v_perm_b32 v42, v86, v82, s77
    v_perm_b32 v43, v94, v90, s77
    v_mfma_f32_16x16x32_bf16 a[208:211], v[36:39], v[32:35], a[208:211]
    v_perm_b32 v44, v71, v67, s76
    v_perm_b32 v45, v79, v75, s76
    v_perm_b32 v46, v87, v83, s76
    v_perm_b32 v47, v95, v91, s76
    v_mfma_f32_16x16x32_bf16 a[212:215], v[40:43], v[32:35], a[212:215]
    v_perm_b32 v48, v71, v67, s77
    v_perm_b32 v49, v79, v75, s77
    v_perm_b32 v50, v87, v83, s77
    v_perm_b32 v51, v95, v91, s77
    v_mfma_f32_16x16x32_bf16 a[216:219], v[44:47], v[32:35], a[216:219]
    s_nop 0
    v_mfma_f32_16x16x32_bf16 a[220:223], v[48:51], v[32:35], a[220:223]
    s_nop 7
.sk_102:
    s_lshl_b32 s79, s12, 13
    s_cmp_lt_i32 s12, 0
    s_cselect_b32 s79, 0x7f000000, s79
    s_add_u32 s80, s79, 4096
    buffer_load_dwordx4 v[64:67], v2, s[32:35], s79 offen offset:0 nt
    buffer_load_dwordx4 v[68:71], v2, s[32:35], s79 offen offset:256 nt
    buffer_load_dwordx4 v[72:75], v2, s[32:35], s79 offen offset:2048 nt
    buffer_load_dwordx4 v[76:79], v2, s[32:35], s79 offen offset:2304 nt
    buffer_load_dwordx4 v[80:83], v2, s[32:35], s80 offen offset:0 nt
    buffer_load_dwordx4 v[84:87], v2, s[32:35], s80 offen offset:256 nt
    buffer_load_dwordx4 v[88:91], v2, s[32:35], s80 offen offset:2048 nt
    buffer_load_dwordx4 v[92:95], v2, s[32:35], s80 offen offset:2304 nt
.sloop_89:
    s_mul_i32 s9, s72, 393216
    s_add_u32 s9, s9, 2621440
    s_lshl_b32 s83, s11, 8
    s_add_u32 s9, s9, s83
    s_cmp_lt_i32 s11, 0
    s_cselect_b32 s9, 0x7f000000, s9
    s_mov_b32 s10, s12
    s_waitcnt vmcnt(10)
    v_readfirstlane_b32 s79, v60
    v_readfirstlane_b32 s13, v61
    v_mfma_f32_16x16x32_bf16 v[16:19], a[0:3], a[224:227], 0
    v_mfma_f32_16x16x32_bf16 v[20:23], a[8:11], a[224:227], 0
    v_mfma_f32_16x16x32_bf16 v[24:27], a[16:19], a[224:227], 0
    v_mfma_f32_16x16x32_bf16 v[28:31], a[24:27], a[224:227], 0
    v_mfma_f32_16x16x32_bf16 v[16:19], a[4:7], a[228:231], v[16:19]
    v_mfma_f32_16x16x32_bf16 v[20:23], a[12:15], a[228:231], v[20:23]
    v_mfma_f32_16x16x32_bf16 v[24:27], a[20:23], a[228:231], v[24:27]
    v_mfma_f32_16x16x32_bf16 v[28:31], a[28:31], a[228:231], v[28:31]
    s_add_u32 s79, s79, 1
    s_addc_u32 s13, s13, 0
    s_and_b32 s71, s79, 0xffff
    s_lshr_b32 s74, s79, 16
    s_and_b32 s4, s13, 0xffff
    s_lshr_b32 s5, s13, 16
    s_mov_b32 s11, -1
    s_cmp_ge_u32 s66, 2
    s_cbranch_scc1 .sdk_103
    s_cmp_eq_u32 s66, 0
    s_cselect_b32 s13, s71, s74
    s_cselect_b32 s85, s67, s68
    s_cselect_b32 s83, 1, 0
    s_add_u32 s71, s71, s83
    s_xor_b32 s83, s83, 1
    s_add_u32 s74, s74, s83
    s_cmp_ge_u32 s13, s85
    s_cbranch_scc1 .sdk_103
    s_cmp_eq_u32 s66, 0
    s_cselect_b32 s84, s69, 0
    s_sub_u32 s23, 767, s13
    s_mov_b32 s79, s23
    s_add_u32 s23, s23, s84
    s_lshl_b32 s84, s66, 12
.fix_104:
    s_add_u32 s83, s79, s84
    v_cmp_le_i32 vcc, s83, v58
    s_nop 0
    s_bcnt1_i32_b64 s25, vcc
    v_cmp_le_i32 vcc, s83, v59
    s_nop 0
    s_bcnt1_i32_b64 s26, vcc
    s_mov_b32 s24, s79
    s_sub_i32 s79, s23, s25
    s_sub_i32 s79, s79, s26
    s_cmp_lg_u32 s79, s24
    s_cbranch_scc1 .fix_104
    s_lshr_b32 s83, s79, 7
    s_xor_b32 s83, s83, s66
    s_and_b32 s83, s83, 1
    s_lshl_b32 s79, s79, 1
    s_or_b32 s79, s79, s83
    s_mov_b32 s11, s79
.sdk_103:
    s_cmp_ge_u32 s6, 2
    s_cbranch_scc1 .sdv_105
    s_cmp_eq_u32 s6, 0
    s_cselect_b32 s13, s4, s5
    s_cselect_b32 s85, s67, s68
    s_cselect_b32 s83, 1, 0
    s_add_u32 s4, s4, s83
    s_xor_b32 s83, s83, 1
    s_add_u32 s5, s5, s83
    s_cmp_ge_u32 s13, s85
    s_cbranch_scc1 .sdv_105
    s_mov_b32 s7, s13
    s_mov_b32 s8, s6
.sdv_105:
    s_mov_b32 s12, -1
    s_cmp_lt_i32 s7, 0
    s_cbranch_scc1 .sdp_106
    s_cmp_eq_u32 s8, 0
    s_cselect_b32 s83, s71, s74
    s_cmp_le_u32 s83, s7
    s_cbranch_scc1 .sdp_106
    s_cmp_eq_u32 s8, 0
    s_cselect_b32 s84, s69, 0
    s_sub_u32 s23, 767, s7
    s_mov_b32 s79, s23
    s_add_u32 s23, s23, s84
    s_lshl_b32 s84, s8, 12
.fix_107:
    s_add_u32 s83, s79, s84
    v_cmp_le_i32 vcc, s83, v58
    s_nop 0
    s_bcnt1_i32_b64 s25, vcc
    v_cmp_le_i32 vcc, s83, v59
    s_nop 0
    s_bcnt1_i32_b64 s26, vcc
    s_mov_b32 s24, s79
    s_sub_i32 s79, s23, s25
    s_sub_i32 s79, s79, s26
    s_cmp_lg_u32 s79, s24
    s_cbranch_scc1 .fix_107
    s_lshr_b32 s83, s79, 7
    s_xor_b32 s83, s83, s8
    s_and_b32 s83, s83, 1
    s_lshl_b32 s79, s79, 1
    s_or_b32 s79, s79, s83
    s_mov_b32 s12, s79
    s_mov_b32 s7, -1
.sdp_106:
    s_sub_i32 s83, s71, s74
    s_mul_i32 s83, s83, s70
    s_cmp_gt_i32 s83, 128
    s_cselect_b32 s83, 1, 0
    s_xor_b32 s66, s81, s83
    s_cmp_ge_i32 s7, 0
    s_cselect_b32 s66, s8, s66
    s_cmp_eq_u32 s66, 0
    s_cselect_b32 s83, s71, s74
    s_cselect_b32 s84, s67, s68
    s_cmp_ge_u32 s83, s84
    s_cselect_b32 s83, 1, 0
    s_xor_b32 s66, s66, s83
    s_cmp_eq_u32 s66, 0
    s_cselect_b32 s83, s71, s74
    s_cselect_b32 s84, s67, s68
    s_cmp_ge_u32 s83, s84
    s_cselect_b32 s66, 2, s66
    s_mov_b32 s6, 2
    s_cmp_ge_i32 s7, 0
    s_cbranch_scc1 .sdq_108
    s_mov_b32 s13, s81
    s_cmp_eq_u32 s13, 0
    s_cselect_b32 s83, s4, s5
    s_cselect_b32 s84, s67, s68
    s_cselect_b32 s85, s71, s74
    s_cmp_ge_u32 s83, s84
    s_cbranch_scc1 .sdn_109
    s_cmp_ge_u32 s85, s84
    s_cselect_b32 s85, 0x7fff, s85
    s_add_i32 s83, s83, 32
    s_cmp_gt_i32 s83, s85
    s_cbranch_scc1 .sdn_109
    s_mov_b32 s6, s13
.sdn_109:
    s_xor_b32 s13, s81, 1
    s_cmp_eq_u32 s13, 0
    s_cselect_b32 s83, s4, s5
    s_cselect_b32 s84, s67, s68
    s_cselect_b32 s85, s71, s74
    s_cmp_ge_u32 s83, s84
    s_cbranch_scc1 .sdn_110
    s_cmp_ge_u32 s85, s84
    s_cselect_b32 s85, 0x7fff, s85
    s_add_i32 s83, s83, 32
    s_cmp_gt_i32 s83, s85
    s_cbranch_scc1 .sdn_110
    s_mov_b32 s6, s13
.sdn_110:
.sdq_108:
    s_and_b32 s83, s11, s12
    s_and_b32 s83, s83, s7
    s_and_b32 s84, s66, s6
    s_cmp_ge_i32 s83, 0
    s_cbranch_scc1 .sdc_111
    s_cmp_eq_u32 s84, 2
    s_cbranch_scc1 .sx_88
.sdc_111:
    s_sub_u32 s14, s14, 1
    s_cmp_eq_u32 s14, 0
    s_cbranch_scc1 .sx_88
    v_add_f32_dpp v8, v17, v16 quad_perm:[1,0,3,2] row_mask:0xf bank_mask:0xf
    v_add_f32_dpp v9, v19, v18 quad_perm:[1,0,3,2] row_mask:0xf bank_mask:0xf
    v_add_f32_dpp v10, v21, v20 quad_perm:[1,0,3,2] row_mask:0xf bank_mask:0xf
    v_add_f32_dpp v11, v23, v22 quad_perm:[1,0,3,2] row_mask:0xf bank_mask:0xf
    v_add_f32_dpp v12, v25, v24 quad_perm:[1,0,3,2] row_mask:0xf bank_mask:0xf
    v_add_f32_dpp v13, v27, v26 quad_perm:[1,0,3,2] row_mask:0xf bank_mask:0xf
    v_add_f32_dpp v14, v29, v28 quad_perm:[1,0,3,2] row_mask:0xf bank_mask:0xf
    v_add_f32_dpp v15, v31, v30 quad_perm:[1,0,3,2] row_mask:0xf bank_mask:0xf
    s_mov_b32 exec_lo, 0x50005
    s_mov_b32 exec_hi, 0x50005
    buffer_store_dwordx4 v[8:11], v55, s[36:39], s9 offen sc1
    buffer_store_dwordx4 v[12:15], v55, s[36:39], s9 offen offset:16 sc1
    s_mov_b64 exec, -1
    s_lshl_b32 s83, s66, 4
    s_lshl_b32 s83, 1, s83
    s_cmp_lt_u32 s66, 2
    s_cselect_b32 s83, s83, 0
    v_mov_b32 v60, s83
    s_lshl_b32 s83, s6, 4
    s_lshl_b32 s83, 1, s83
    s_cmp_lt_u32 s6, 2
    s_cselect_b32 s83, s83, 0
    v_mov_b32 v61, s83
    s_mov_b64 exec, 1
    buffer_atomic_add_x2 v[60:61], off, s[36:39], s82 sc0 sc1
    s_mov_b64 exec, -1
    s_lshl_b32 s79, s11, 13
    s_cmp_lt_i32 s11, 0
    s_cselect_b32 s79, 0x7f000000, s79
    s_add_u32 s80, s79, 4096
    buffer_load_dwordx4 a[0:3], v1, s[28:31], s79 offen offset:0 nt
    buffer_load_dwordx4 a[4:7], v1, s[28:31], s79 offen offset:128 nt
    buffer_load_dwordx4 a[8:11], v1, s[28:31], s79 offen offset:2048 nt
    buffer_load_dwordx4 a[12:15], v1, s[28:31], s79 offen offset:2176 nt
    buffer_load_dwordx4 a[16:19], v1, s[28:31], s80 offen offset:0 nt
    buffer_load_dwordx4 a[20:23], v1, s[28:31], s80 offen offset:128 nt
    buffer_load_dwordx4 a[24:27], v1, s[28:31], s80 offen offset:2048 nt
    buffer_load_dwordx4 a[28:31], v1, s[28:31], s80 offen offset:2176 nt
    s_cmp_lt_i32 s10, 0
    s_cbranch_scc1 .snb_112
    s_waitcnt vmcnt(19)
    s_mov_b32 s88, 200000
.spp_113:
    v_max3_u32 v7, v128, v129, v130
    v_max3_u32 v7, v7, v131, v132
    v_max3_u32 v7, v7, v133, v134
    v_max_u32 v7, v7, v135
    v_cmp_eq_u32 vcc, -1, v7
    s_nop 4
    s_cbranch_vccz .sppd_114
    s_mov_b32 exec_lo, 0x50005
    s_mov_b32 exec_hi, 0x50005
    buffer_load_dwordx4 v[128:131], v55, s[36:39], s15 offen sc1
    buffer_load_dwordx4 v[132:135], v55, s[36:39], s15 offen offset:16 sc1
    s_mov_b64 exec, -1
    s_waitcnt vmcnt(0)
    s_sub_u32 s88, s88, 1
    s_cmp_lg_u32 s88, 0
    s_cbranch_scc1 .spp_113
.sppd_114:
    v_max3_f32 v7, v128, v129, v130
    v_max3_f32 v7, v7, v131, v132
    v_max3_f32 v7, v7, v133, v134
    v_max_f32 v7, v7, v135
    v_cmp_gt_f32 vcc, v7, v4
    s_nop 4
    s_cbranch_vccz .noresc_115
    s_call_b64 s[94:95], .Lresc
.noresc_115:
    v_fma_f32 v8, v128, s75, -v3
    v_fma_f32 v9, v129, s75, -v3
    v_fma_f32 v10, v130, s75, -v3
    v_fma_f32 v11, v131, s75, -v3
    v_fma_f32 v12, v132, s75, -v3
    v_fma_f32 v13, v133, s75, -v3
    v_fma_f32 v14, v134, s75, -v3
    v_fma_f32 v15, v135, s75, -v3
    v_exp_f32 v8, v8
    v_exp_f32 v9, v9
    v_exp_f32 v10, v10
    v_exp_f32 v11, v11
    v_exp_f32 v12, v12
    v_exp_f32 v13, v13
    v_exp_f32 v14, v14
    v_exp_f32 v15, v15
    v_cvt_pk_bf16_f32 v32, v8, v9
    v_cvt_pk_bf16_f32 v33, v10, v11
    v_cvt_pk_bf16_f32 v34, v12, v13
    v_cvt_pk_bf16_f32 v35, v14, v15
    v_add_f32 v8, v8, v9
    v_add_f32 v10, v10, v11
    v_add_f32 v12, v12, v13
    v_add_f32 v14, v14, v15
    v_add_f32 v8, v8, v10
    v_add_f32 v12, v12, v14
    v_add_f32 v5, v5, v8
    v_add_f32 v5, v5, v12
    s_nop 1
.snb_112:
    s_mul_i32 s15, s72, 393216
    s_add_u32 s15, s15, 2621440
    s_lshl_b32 s83, s12, 8
    s_add_u32 s15, s15, s83
    s_cmp_lt_i32 s12, 0
    s_cselect_b32 s15, 0x7f000000, s15
    s_mov_b32 exec_lo, 0x50005
    s_mov_b32 exec_hi, 0x50005
    buffer_load_dwordx4 v[128:131], v55, s[36:39], s15 offen sc1
    buffer_load_dwordx4 v[132:135], v55, s[36:39], s15 offen offset:16 sc1
    s_mov_b64 exec, -1
    s_waitcnt vmcnt(13)
    s_cmp_lt_i32 s10, 0
    s_cbranch_scc1 .snb_116
    v_perm_b32 v36, v68, v64, s76
    v_perm_b32 v37, v76, v72, s76
    v_perm_b32 v38, v84, v80, s76
    v_perm_b32 v39, v92, v88, s76
    v_perm_b32 v40, v68, v64, s77
    v_perm_b32 v41, v76, v72, s77
    v_perm_b32 v42, v84, v80, s77
    v_perm_b32 v43, v92, v88, s77
    v_mfma_f32_16x16x32_bf16 a[192:195], v[36:39], v[32:35], a[192:195]
    v_perm_b32 v44, v69, v65, s76
    v_perm_b32 v45, v77, v73, s76
    v_perm_b32 v46, v85, v81, s76
    v_perm_b32 v47, v93, v89, s76
    v_mfma_f32_16x16x32_bf16 a[196:199], v[40:43], v[32:35], a[196:199]
    v_perm_b32 v48, v69, v65, s77
    v_perm_b32 v49, v77, v73, s77
    v_perm_b32 v50, v85, v81, s77
    v_perm_b32 v51, v93, v89, s77
    v_mfma_f32_16x16x32_bf16 a[200:203], v[44:47], v[32:35], a[200:203]
    v_perm_b32 v36, v70, v66, s76
    v_perm_b32 v37, v78, v74, s76
    v_perm_b32 v38, v86, v82, s76
    v_perm_b32 v39, v94, v90, s76
    v_mfma_f32_16x16x32_bf16 a[204:207], v[48:51], v[32:35], a[204:207]
    v_perm_b32 v40, v70, v66, s77
    v_perm_b32 v41, v78, v74, s77
    v_perm_b32 v42, v86, v82, s77
    v_perm_b32 v43, v94, v90, s77
    v_mfma_f32_16x16x32_bf16 a[208:211], v[36:39], v[32:35], a[208:211]
    v_perm_b32 v44, v71, v67, s76
    v_perm_b32 v45, v79, v75, s76
    v_perm_b32 v46, v87, v83, s76
    v_perm_b32 v47, v95, v91, s76
    v_mfma_f32_16x16x32_bf16 a[212:215], v[40:43], v[32:35], a[212:215]
    v_perm_b32 v48, v71, v67, s77
    v_perm_b32 v49, v79, v75, s77
    v_perm_b32 v50, v87, v83, s77
    v_perm_b32 v51, v95, v91, s77
    v_mfma_f32_16x16x32_bf16 a[216:219], v[44:47], v[32:35], a[216:219]
    s_nop 0
    v_mfma_f32_16x16x32_bf16 a[220:223], v[48:51], v[32:35], a[220:223]
    s_nop 7
.snb_116:
    s_lshl_b32 s79, s12, 13
    s_cmp_lt_i32 s12, 0
    s_cselect_b32 s79, 0x7f000000, s79
    s_add_u32 s80, s79, 4096
    buffer_load_dwordx4 v[64:67], v2, s[32:35], s79 offen offset:0 nt
    buffer_load_dwordx4 v[68:71], v2, s[32:35], s79 offen offset:256 nt
    buffer_load_dwordx4 v[72:75], v2, s[32:35], s79 offen offset:2048 nt
    buffer_load_dwordx4 v[76:79], v2, s[32:35], s79 offen offset:2304 nt
    buffer_load_dwordx4 v[80:83], v2, s[32:35], s80 offen offset:0 nt
    buffer_load_dwordx4 v[84:87], v2, s[32:35], s80 offen offset:256 nt
    buffer_load_dwordx4 v[88:91], v2, s[32:35], s80 offen offset:2048 nt
    buffer_load_dwordx4 v[92:95], v2, s[32:35], s80 offen offset:2304 nt
    s_branch .sloop_89
.sx0_87:
    s_bitcmp0_b32 s27, 1
    s_cbranch_scc1 .sk_117
    v_add_f32_dpp v8, v17, v16 quad_perm:[1,0,3,2] row_mask:0xf bank_mask:0xf
    v_add_f32_dpp v9, v19, v18 quad_perm:[1,0,3,2] row_mask:0xf bank_mask:0xf
    v_add_f32_dpp v10, v21, v20 quad_perm:[1,0,3,2] row_mask:0xf bank_mask:0xf
    v_add_f32_dpp v11, v23, v22 quad_perm:[1,0,3,2] row_mask:0xf bank_mask:0xf
    v_add_f32_dpp v12, v25, v24 quad_perm:[1,0,3,2] row_mask:0xf bank_mask:0xf
    v_add_f32_dpp v13, v27, v26 quad_perm:[1,0,3,2] row_mask:0xf bank_mask:0xf
    v_add_f32_dpp v14, v29, v28 quad_perm:[1,0,3,2] row_mask:0xf bank_mask:0xf
    v_add_f32_dpp v15, v31, v30 quad_perm:[1,0,3,2] row_mask:0xf bank_mask:0xf
    v_max3_f32 v7, v8, v9, v10
    v_max3_f32 v7, v7, v11, v12
    v_max3_f32 v7, v7, v13, v14
    v_max_f32 v7, v7, v15
    v_cmp_gt_f32 vcc, v7, v4
    s_nop 4
    s_cbranch_vccz .noresc_118
    s_call_b64 s[94:95], .Lresc
.noresc_118:
    v_fma_f32 v8, v8, s75, -v3
    v_fma_f32 v9, v9, s75, -v3
    v_fma_f32 v10, v10, s75, -v3
    v_fma_f32 v11, v11, s75, -v3
    v_fma_f32 v12, v12, s75, -v3
    v_fma_f32 v13, v13, s75, -v3
    v_fma_f32 v14, v14, s75, -v3
    v_fma_f32 v15, v15, s75, -v3
    v_exp_f32 v8, v8
    v_exp_f32 v9, v9
    v_exp_f32 v10, v10
    v_exp_f32 v11, v11
    v_exp_f32 v12, v12
    v_exp_f32 v13, v13
    v_exp_f32 v14, v14
    v_exp_f32 v15, v15
    v_cvt_pk_bf16_f32 v32, v8, v9
    v_cvt_pk_bf16_f32 v33, v10, v11
    v_cvt_pk_bf16_f32 v34, v12, v13
    v_cvt_pk_bf16_f32 v35, v14, v15
    v_add_f32 v8, v8, v9
    v_add_f32 v10, v10, v11
    v_add_f32 v12, v12, v13
    v_add_f32 v14, v14, v15
    v_add_f32 v8, v8, v10
    v_add_f32 v12, v12, v14
    v_add_f32 v5, v5, v8
    v_add_f32 v5, v5, v12
    s_nop 1
.sk_117:
    s_waitcnt vmcnt(0)
    s_bitcmp0_b32 s27, 1
    s_cbranch_scc1 .sk_119
    v_perm_b32 v36, v68, v64, s76
    v_perm_b32 v37, v76, v72, s76
    v_perm_b32 v38, v84, v80, s76
    v_perm_b32 v39, v92, v88, s76
    v_perm_b32 v40, v68, v64, s77
    v_perm_b32 v41, v76, v72, s77
    v_perm_b32 v42, v84, v80, s77
    v_perm_b32 v43, v92, v88, s77
    v_mfma_f32_16x16x32_bf16 a[192:195], v[36:39], v[32:35], a[192:195]
    v_perm_b32 v44, v69, v65, s76
    v_perm_b32 v45, v77, v73, s76
    v_perm_b32 v46, v85, v81, s76
    v_perm_b32 v47, v93, v89, s76
    v_mfma_f32_16x16x32_bf16 a[196:199], v[40:43], v[32:35], a[196:199]
    v_perm_b32 v48, v69, v65, s77
    v_perm_b32 v49, v77, v73, s77
    v_perm_b32 v50, v85, v81, s77
    v_perm_b32 v51, v93, v89, s77
    v_mfma_f32_16x16x32_bf16 a[200:203], v[44:47], v[32:35], a[200:203]
    v_perm_b32 v36, v70, v66, s76
    v_perm_b32 v37, v78, v74, s76
    v_perm_b32 v38, v86, v82, s76
    v_perm_b32 v39, v94, v90, s76
    v_mfma_f32_16x16x32_bf16 a[204:207], v[48:51], v[32:35], a[204:207]
    v_perm_b32 v40, v70, v66, s77
    v_perm_b32 v41, v78, v74, s77
    v_perm_b32 v42, v86, v82, s77
    v_perm_b32 v43, v94, v90, s77
    v_mfma_f32_16x16x32_bf16 a[208:211], v[36:39], v[32:35], a[208:211]
    v_perm_b32 v44, v71, v67, s76
    v_perm_b32 v45, v79, v75, s76
    v_perm_b32 v46, v87, v83, s76
    v_perm_b32 v47, v95, v91, s76
    v_mfma_f32_16x16x32_bf16 a[212:215], v[40:43], v[32:35], a[212:215]
    v_perm_b32 v48, v71, v67, s77
    v_perm_b32 v49, v79, v75, s77
    v_perm_b32 v50, v87, v83, s77
    v_perm_b32 v51, v95, v91, s77
    v_mfma_f32_16x16x32_bf16 a[216:219], v[44:47], v[32:35], a[216:219]
    s_nop 0
    v_mfma_f32_16x16x32_bf16 a[220:223], v[48:51], v[32:35], a[220:223]
    s_nop 7
.sk_119:
    s_branch .sxe_120
.sx_88:
    v_add_f32_dpp v8, v17, v16 quad_perm:[1,0,3,2] row_mask:0xf bank_mask:0xf
    v_add_f32_dpp v9, v19, v18 quad_perm:[1,0,3,2] row_mask:0xf bank_mask:0xf
    v_add_f32_dpp v10, v21, v20 quad_perm:[1,0,3,2] row_mask:0xf bank_mask:0xf
    v_add_f32_dpp v11, v23, v22 quad_perm:[1,0,3,2] row_mask:0xf bank_mask:0xf
    v_add_f32_dpp v12, v25, v24 quad_perm:[1,0,3,2] row_mask:0xf bank_mask:0xf
    v_add_f32_dpp v13, v27, v26 quad_perm:[1,0,3,2] row_mask:0xf bank_mask:0xf
    v_add_f32_dpp v14, v29, v28 quad_perm:[1,0,3,2] row_mask:0xf bank_mask:0xf
    v_add_f32_dpp v15, v31, v30 quad_perm:[1,0,3,2] row_mask:0xf bank_mask:0xf
    s_mov_b32 exec_lo, 0x50005
    s_mov_b32 exec_hi, 0x50005
    buffer_store_dwordx4 v[8:11], v55, s[36:39], s9 offen sc1
    buffer_store_dwordx4 v[12:15], v55, s[36:39], s9 offen offset:16 sc1
    s_mov_b64 exec, -1
    s_waitcnt vmcnt(0)
    s_cmp_lt_i32 s10, 0
    s_cbranch_scc1 .sxe_120
    s_mov_b32 s88, 200000
.spp_121:
    v_max3_u32 v7, v128, v129, v130
    v_max3_u32 v7, v7, v131, v132
    v_max3_u32 v7, v7, v133, v134
    v_max_u32 v7, v7, v135
    v_cmp_eq_u32 vcc, -1, v7
    s_nop 4
    s_cbranch_vccz .sppd_122
    s_mov_b32 exec_lo, 0x50005
    s_mov_b32 exec_hi, 0x50005
    buffer_load_dwordx4 v[128:131], v55, s[36:39], s15 offen sc1
    buffer_load_dwordx4 v[132:135], v55, s[36:39], s15 offen offset:16 sc1
    s_mov_b64 exec, -1
    s_waitcnt vmcnt(0)
    s_sub_u32 s88, s88, 1
    s_cmp_lg_u32 s88, 0
    s_cbranch_scc1 .spp_121
.sppd_122:
    v_max3_f32 v7, v128, v129, v130
    v_max3_f32 v7, v7, v131, v132
    v_max3_f32 v7, v7, v133, v134
    v_max_f32 v7, v7, v135
    v_cmp_gt_f32 vcc, v7, v4
    s_nop 4
    s_cbranch_vccz .noresc_123
    s_call_b64 s[94:95], .Lresc
.noresc_123:
    v_fma_f32 v8, v128, s75, -v3
    v_fma_f32 v9, v129, s75, -v3
    v_fma_f32 v10, v130, s75, -v3
    v_fma_f32 v11, v131, s75, -v3
    v_fma_f32 v12, v132, s75, -v3
    v_fma_f32 v13, v133, s75, -v3
    v_fma_f32 v14, v134, s75, -v3
    v_fma_f32 v15, v135, s75, -v3
    v_exp_f32 v8, v8
    v_exp_f32 v9, v9
    v_exp_f32 v10, v10
    v_exp_f32 v11, v11
    v_exp_f32 v12, v12
    v_exp_f32 v13, v13
    v_exp_f32 v14, v14
    v_exp_f32 v15, v15
    v_cvt_pk_bf16_f32 v32, v8, v9
    v_cvt_pk_bf16_f32 v33, v10, v11
    v_cvt_pk_bf16_f32 v34, v12, v13
    v_cvt_pk_bf16_f32 v35, v14, v15
    v_add_f32 v8, v8, v9
    v_add_f32 v10, v10, v11
    v_add_f32 v12, v12, v13
    v_add_f32 v14, v14, v15
    v_add_f32 v8, v8, v10
    v_add_f32 v12, v12, v14
    v_add_f32 v5, v5, v8
    v_add_f32 v5, v5, v12
    v_perm_b32 v36, v68, v64, s76
    v_perm_b32 v37, v76, v72, s76
    v_perm_b32 v38, v84, v80, s76
    v_perm_b32 v39, v92, v88, s76
    v_perm_b32 v40, v68, v64, s77
    v_perm_b32 v41, v76, v72, s77
    v_perm_b32 v42, v84, v80, s77
    v_perm_b32 v43, v92, v88, s77
    v_mfma_f32_16x16x32_bf16 a[192:195], v[36:39], v[32:35], a[192:195]
    v_perm_b32 v44, v69, v65, s76
    v_perm_b32 v45, v77, v73, s76
    v_perm_b32 v46, v85, v81, s76
    v_perm_b32 v47, v93, v89, s76
    v_mfma_f32_16x16x32_bf16 a[196:199], v[40:43], v[32:35], a[196:199]
    v_perm_b32 v48, v69, v65, s77
    v_perm_b32 v49, v77, v73, s77
    v_perm_b32 v50, v85, v81, s77
    v_perm_b32 v51, v93, v89, s77
    v_mfma_f32_16x16x32_bf16 a[200:203], v[44:47], v[32:35], a[200:203]
    v_perm_b32 v36, v70, v66, s76
    v_perm_b32 v37, v78, v74, s76
    v_perm_b32 v38, v86, v82, s76
    v_perm_b32 v39, v94, v90, s76
    v_mfma_f32_16x16x32_bf16 a[204:207], v[48:51], v[32:35], a[204:207]
    v_perm_b32 v40, v70, v66, s77
    v_perm_b32 v41, v78, v74, s77
    v_perm_b32 v42, v86, v82, s77
    v_perm_b32 v43, v94, v90, s77
    v_mfma_f32_16x16x32_bf16 a[208:211], v[36:39], v[32:35], a[208:211]
    v_perm_b32 v44, v71, v67, s76
    v_perm_b32 v45, v79, v75, s76
    v_perm_b32 v46, v87, v83, s76
    v_perm_b32 v47, v95, v91, s76
    v_mfma_f32_16x16x32_bf16 a[212:215], v[40:43], v[32:35], a[212:215]
    v_perm_b32 v48, v71, v67, s77
    v_perm_b32 v49, v79, v75, s77
    v_perm_b32 v50, v87, v83, s77
    v_perm_b32 v51, v95, v91, s77
    v_mfma_f32_16x16x32_bf16 a[216:219], v[44:47], v[32:35], a[216:219]
    s_nop 0
    v_mfma_f32_16x16x32_bf16 a[220:223], v[48:51], v[32:35], a[220:223]
    s_nop 7
.sxe_120:
    s_branch .p2j_67
.p2n_66:
    v_accvgpr_write_b32 a192, 0
    v_accvgpr_write_b32 a193, 0
    v_accvgpr_write_b32 a194, 0
    v_accvgpr_write_b32 a195, 0
    v_accvgpr_write_b32 a196, 0
    v_accvgpr_write_b32 a197, 0
    v_accvgpr_write_b32 a198, 0
    v_accvgpr_write_b32 a199, 0
    v_accvgpr_write_b32 a200, 0
    v_accvgpr_write_b32 a201, 0
    v_accvgpr_write_b32 a202, 0
    v_accvgpr_write_b32 a203, 0
    v_accvgpr_write_b32 a204, 0
    v_accvgpr_write_b32 a205, 0
    v_accvgpr_write_b32 a206, 0
    v_accvgpr_write_b32 a207, 0
    v_accvgpr_write_b32 a208, 0
    v_accvgpr_write_b32 a209, 0
    v_accvgpr_write_b32 a210, 0
    v_accvgpr_write_b32 a211, 0
    v_accvgpr_write_b32 a212, 0
    v_accvgpr_write_b32 a213, 0
    v_accvgpr_write_b32 a214, 0
    v_accvgpr_write_b32 a215, 0
    v_accvgpr_write_b32 a216, 0
    v_accvgpr_write_b32 a217, 0
    v_accvgpr_write_b32 a218, 0
    v_accvgpr_write_b32 a219, 0
    v_accvgpr_write_b32 a220, 0
    v_accvgpr_write_b32 a221, 0
    v_accvgpr_write_b32 a222, 0
    v_accvgpr_write_b32 a223, 0
    v_mov_b32 v5, 0
    v_mov_b32 v6, 0xf149f2ca
    v_mov_b32 v4, 0xf149f2ca
    v_mov_b32 v3, 0
    v_and_b32 v7, 1, v0
    v_cmp_eq_u32 vcc, 1, v7
    v_mov_b32 v7, 0x7f800000
    s_nop 0
    v_cndmask_b32 v4, v4, v7, vcc
    s_lshl_b32 s82, s72, 15
    s_add_u32 s82, s82, 1836544
    s_cmp_ge_i32 s21, 0
    s_cselect_b32 s27, 1, 0
    s_cmp_ge_i32 s20, 0
    s_cselect_b32 s83, 2, 0
    s_or_b32 s27, s27, s83
    s_lshl_b32 s83, s81, 4
    s_lshl_b32 s83, 6, s83
    v_mov_b32 v56, s83
    s_mov_b64 exec, 1
    buffer_atomic_add v56, off, s[36:39], s82 sc0 sc1
    s_mov_b64 exec, -1
    v_mfma_f32_16x16x32_bf16 v[16:19], a[32:35], a[224:227], 0
    v_mfma_f32_16x16x32_bf16 v[20:23], a[40:43], a[224:227], 0
    v_mfma_f32_16x16x32_bf16 v[24:27], a[48:51], a[224:227], 0
    v_mfma_f32_16x16x32_bf16 v[28:31], a[56:59], a[224:227], 0
    v_mfma_f32_16x16x32_bf16 v[16:19], a[36:39], a[228:231], v[16:19]
    v_mfma_f32_16x16x32_bf16 v[20:23], a[44:47], a[228:231], v[20:23]
    v_mfma_f32_16x16x32_bf16 v[24:27], a[52:55], a[228:231], v[24:27]
    v_mfma_f32_16x16x32_bf16 v[28:31], a[60:63], a[228:231], v[28:31]
    s_lshl_b32 s79, s21, 13
    s_cmp_lt_i32 s21, 0
    s_cselect_b32 s79, 0x7f000000, s79
    s_add_u32 s80, s79, 4096
    buffer_load_dwordx4 a[32:35], v1, s[28:31], s79 offen offset:0 nt
    buffer_load_dwordx4 a[36:39], v1, s[28:31], s79 offen offset:128 nt
    buffer_load_dwordx4 a[40:43], v1, s[28:31], s79 offen offset:2048 nt
    buffer_load_dwordx4 a[44:47], v1, s[28:31], s79 offen offset:2176 nt
    buffer_load_dwordx4 a[48:51], v1, s[28:31], s80 offen offset:0 nt
    buffer_load_dwordx4 a[52:55], v1, s[28:31], s80 offen offset:128 nt
    buffer_load_dwordx4 a[56:59], v1, s[28:31], s80 offen offset:2048 nt
    buffer_load_dwordx4 a[60:63], v1, s[28:31], s80 offen offset:2176 nt
    v_add_f32_dpp v8, v17, v16 quad_perm:[1,0,3,2] row_mask:0xf bank_mask:0xf
    v_add_f32_dpp v9, v19, v18 quad_perm:[1,0,3,2] row_mask:0xf bank_mask:0xf
    v_add_f32_dpp v10, v21, v20 quad_perm:[1,0,3,2] row_mask:0xf bank_mask:0xf
    v_add_f32_dpp v11, v23, v22 quad_perm:[1,0,3,2] row_mask:0xf bank_mask:0xf
    v_add_f32_dpp v12, v25, v24 quad_perm:[1,0,3,2] row_mask:0xf bank_mask:0xf
    v_add_f32_dpp v13, v27, v26 quad_perm:[1,0,3,2] row_mask:0xf bank_mask:0xf
    v_add_f32_dpp v14, v29, v28 quad_perm:[1,0,3,2] row_mask:0xf bank_mask:0xf
    v_add_f32_dpp v15, v31, v30 quad_perm:[1,0,3,2] row_mask:0xf bank_mask:0xf
    v_max3_f32 v7, v8, v9, v10
    v_max3_f32 v7, v7, v11, v12
    v_max3_f32 v7, v7, v13, v14
    v_max_f32 v7, v7, v15
    v_cmp_gt_f32 vcc, v7, v4
    s_nop 4
    s_cbranch_vccz .noresc_124
    s_call_b64 s[94:95], .Lresc
.noresc_124:
    v_fma_f32 v8, v8, s75, -v3
    v_fma_f32 v9, v9, s75, -v3
    v_fma_f32 v10, v10, s75, -v3
    v_fma_f32 v11, v11, s75, -v3
    v_fma_f32 v12, v12, s75, -v3
    v_fma_f32 v13, v13, s75, -v3
    v_fma_f32 v14, v14, s75, -v3
    v_fma_f32 v15, v15, s75, -v3
    v_exp_f32 v8, v8
    v_exp_f32 v9, v9
    v_exp_f32 v10, v10
    v_exp_f32 v11, v11
    v_exp_f32 v12, v12
    v_exp_f32 v13, v13
    v_exp_f32 v14, v14
    v_exp_f32 v15, v15
    v_cvt_pk_bf16_f32 v32, v8, v9
    v_cvt_pk_bf16_f32 v33, v10, v11
    v_cvt_pk_bf16_f32 v34, v12, v13
    v_cvt_pk_bf16_f32 v35, v14, v15
    v_add_f32 v8, v8, v9
    v_add_f32 v10, v10, v11
    v_add_f32 v12, v12, v13
    v_add_f32 v14, v14, v15
    v_add_f32 v8, v8, v10
    v_add_f32 v12, v12, v14
    v_add_f32 v5, v5, v8
    v_add_f32 v5, v5, v12
    v_perm_b32 v36, v100, v96, s76
    v_perm_b32 v37, v108, v104, s76
    v_perm_b32 v38, v116, v112, s76
    v_perm_b32 v39, v124, v120, s76
    v_perm_b32 v40, v100, v96, s77
    v_perm_b32 v41, v108, v104, s77
    v_perm_b32 v42, v116, v112, s77
    v_perm_b32 v43, v124, v120, s77
    v_mfma_f32_16x16x32_bf16 a[192:195], v[36:39], v[32:35], a[192:195]
    v_perm_b32 v44, v101, v97, s76
    v_perm_b32 v45, v109, v105, s76
    v_perm_b32 v46, v117, v113, s76
    v_perm_b32 v47, v125, v121, s76
    v_mfma_f32_16x16x32_bf16 a[196:199], v[40:43], v[32:35], a[196:199]
    v_perm_b32 v48, v101, v97, s77
    v_perm_b32 v49, v109, v105, s77
    v_perm_b32 v50, v117, v113, s77
    v_perm_b32 v51, v125, v121, s77
    v_mfma_f32_16x16x32_bf16 a[200:203], v[44:47], v[32:35], a[200:203]
    v_perm_b32 v36, v102, v98, s76
    v_perm_b32 v37, v110, v106, s76
    v_perm_b32 v38, v118, v114, s76
    v_perm_b32 v39, v126, v122, s76
    v_mfma_f32_16x16x32_bf16 a[204:207], v[48:51], v[32:35], a[204:207]
    v_perm_b32 v40, v102, v98, s77
    v_perm_b32 v41, v110, v106, s77
    v_perm_b32 v42, v118, v114, s77
    v_perm_b32 v43, v126, v122, s77
    v_mfma_f32_16x16x32_bf16 a[208:211], v[36:39], v[32:35], a[208:211]
    v_perm_b32 v44, v103, v99, s76
    v_perm_b32 v45, v111, v107, s76
    v_perm_b32 v46, v119, v115, s76
    v_perm_b32 v47, v127, v123, s76
    v_mfma_f32_16x16x32_bf16 a[212:215], v[40:43], v[32:35], a[212:215]
    v_perm_b32 v48, v103, v99, s77
    v_perm_b32 v49, v111, v107, s77
    v_perm_b32 v50, v119, v115, s77
    v_perm_b32 v51, v127, v123, s77
    v_mfma_f32_16x16x32_bf16 a[216:219], v[44:47], v[32:35], a[216:219]
    s_nop 0
    v_mfma_f32_16x16x32_bf16 a[220:223], v[48:51], v[32:35], a[220:223]
    s_lshl_b32 s79, s21, 13
    s_cmp_lt_i32 s21, 0
    s_cselect_b32 s79, 0x7f000000, s79
    s_add_u32 s80, s79, 4096
    buffer_load_dwordx4 v[96:99], v2, s[32:35], s79 offen offset:0 nt
    buffer_load_dwordx4 v[100:103], v2, s[32:35], s79 offen offset:256 nt
    buffer_load_dwordx4 v[104:107], v2, s[32:35], s79 offen offset:2048 nt
    buffer_load_dwordx4 v[108:111], v2, s[32:35], s79 offen offset:2304 nt
    buffer_load_dwordx4 v[112:115], v2, s[32:35], s80 offen offset:0 nt
    buffer_load_dwordx4 v[116:119], v2, s[32:35], s80 offen offset:256 nt
    buffer_load_dwordx4 v[120:123], v2, s[32:35], s80 offen offset:2048 nt
    buffer_load_dwordx4 v[124:127], v2, s[32:35], s80 offen offset:2304 nt
    v_mfma_f32_16x16x32_bf16 v[16:19], a[0:3], a[224:227], 0
    v_mfma_f32_16x16x32_bf16 v[20:23], a[8:11], a[224:227], 0
    v_mfma_f32_16x16x32_bf16 v[24:27], a[16:19], a[224:227], 0
    v_mfma_f32_16x16x32_bf16 v[28:31], a[24:27], a[224:227], 0
    v_mfma_f32_16x16x32_bf16 v[16:19], a[4:7], a[228:231], v[16:19]
    v_mfma_f32_16x16x32_bf16 v[20:23], a[12:15], a[228:231], v[20:23]
    v_mfma_f32_16x16x32_bf16 v[24:27], a[20:23], a[228:231], v[24:27]
    v_mfma_f32_16x16x32_bf16 v[28:31], a[28:31], a[228:231], v[28:31]
    s_waitcnt vmcnt(16)
    v_readfirstlane_b32 s17, v56
    s_nop 0
    s_add_u32 s17, s17, 1
    s_lshl_b32 s83, s81, 4
    s_lshr_b32 s17, s17, s83
    s_and_b32 s17, s17, 0xffff
    s_add_u32 s14, s17, 0
    s_mov_b32 s4, -1
    s_cmp_eq_u32 s81, 0
    s_cselect_b32 s83, s67, s68
    s_cmp_ge_u32 s14, s83
    s_cbranch_scc1 .ed_125
    s_cmp_eq_u32 s81, 0
    s_cselect_b32 s84, s69, 0
    s_sub_u32 s23, 767, s14
    s_mov_b32 s79, s23
    s_add_u32 s23, s23, s84
    s_lshl_b32 s84, s81, 12
.fix_126:
    s_add_u32 s83, s79, s84
    v_cmp_le_i32 vcc, s83, v58
    s_nop 0
    s_bcnt1_i32_b64 s25, vcc
    v_cmp_le_i32 vcc, s83, v59
    s_nop 0
    s_bcnt1_i32_b64 s26, vcc
    s_mov_b32 s24, s79
    s_sub_i32 s79, s23, s25
    s_sub_i32 s79, s79, s26
    s_cmp_lg_u32 s79, s24
    s_cbranch_scc1 .fix_126
    s_lshr_b32 s83, s79, 7
    s_xor_b32 s83, s83, s81
    s_and_b32 s83, s83, 1
    s_lshl_b32 s79, s79, 1
    s_or_b32 s79, s79, s83
    s_mov_b32 s4, s79
    s_bitset1_b32 s27, 2
.ed_125:
    s_lshl_b32 s79, s4, 13
    s_cmp_lt_i32 s4, 0
    s_cselect_b32 s79, 0x7f000000, s79
    s_add_u32 s80, s79, 4096
    buffer_load_dwordx4 a[0:3], v1, s[28:31], s79 offen offset:0 nt
    buffer_load_dwordx4 a[4:7], v1, s[28:31], s79 offen offset:128 nt
    buffer_load_dwordx4 a[8:11], v1, s[28:31], s79 offen offset:2048 nt
    buffer_load_dwordx4 a[12:15], v1, s[28:31], s79 offen offset:2176 nt
    buffer_load_dwordx4 a[16:19], v1, s[28:31], s80 offen offset:0 nt
    buffer_load_dwordx4 a[20:23], v1, s[28:31], s80 offen offset:128 nt
    buffer_load_dwordx4 a[24:27], v1, s[28:31], s80 offen offset:2048 nt
    buffer_load_dwordx4 a[28:31], v1, s[28:31], s80 offen offset:2176 nt
    v_add_f32_dpp v8, v17, v16 quad_perm:[1,0,3,2] row_mask:0xf bank_mask:0xf
    v_add_f32_dpp v9, v19, v18 quad_perm:[1,0,3,2] row_mask:0xf bank_mask:0xf
    v_add_f32_dpp v10, v21, v20 quad_perm:[1,0,3,2] row_mask:0xf bank_mask:0xf
    v_add_f32_dpp v11, v23, v22 quad_perm:[1,0,3,2] row_mask:0xf bank_mask:0xf
    v_add_f32_dpp v12, v25, v24 quad_perm:[1,0,3,2] row_mask:0xf bank_mask:0xf
    v_add_f32_dpp v13, v27, v26 quad_perm:[1,0,3,2] row_mask:0xf bank_mask:0xf
    v_add_f32_dpp v14, v29, v28 quad_perm:[1,0,3,2] row_mask:0xf bank_mask:0xf
    v_add_f32_dpp v15, v31, v30 quad_perm:[1,0,3,2] row_mask:0xf bank_mask:0xf
    v_max3_f32 v7, v8, v9, v10
    v_max3_f32 v7, v7, v11, v12
    v_max3_f32 v7, v7, v13, v14
    v_max_f32 v7, v7, v15
    v_cmp_gt_f32 vcc, v7, v4
    s_nop 4
    s_cbranch_vccz .noresc_127
    s_call_b64 s[94:95], .Lresc
.noresc_127:
    v_fma_f32 v8, v8, s75, -v3
    v_fma_f32 v9, v9, s75, -v3
    v_fma_f32 v10, v10, s75, -v3
    v_fma_f32 v11, v11, s75, -v3
    v_fma_f32 v12, v12, s75, -v3
    v_fma_f32 v13, v13, s75, -v3
    v_fma_f32 v14, v14, s75, -v3
    v_fma_f32 v15, v15, s75, -v3
    v_exp_f32 v8, v8
    v_exp_f32 v9, v9
    v_exp_f32 v10, v10
    v_exp_f32 v11, v11
    v_exp_f32 v12, v12
    v_exp_f32 v13, v13
    v_exp_f32 v14, v14
    v_exp_f32 v15, v15
    v_cvt_pk_bf16_f32 v32, v8, v9
    v_cvt_pk_bf16_f32 v33, v10, v11
    v_cvt_pk_bf16_f32 v34, v12, v13
    v_cvt_pk_bf16_f32 v35, v14, v15
    v_add_f32 v8, v8, v9
    v_add_f32 v10, v10, v11
    v_add_f32 v12, v12, v13
    v_add_f32 v14, v14, v15
    v_add_f32 v8, v8, v10
    v_add_f32 v12, v12, v14
    v_add_f32 v5, v5, v8
    v_add_f32 v5, v5, v12
    v_perm_b32 v36, v68, v64, s76
    v_perm_b32 v37, v76, v72, s76
    v_perm_b32 v38, v84, v80, s76
    v_perm_b32 v39, v92, v88, s76
    v_perm_b32 v40, v68, v64, s77
    v_perm_b32 v41, v76, v72, s77
    v_perm_b32 v42, v84, v80, s77
    v_perm_b32 v43, v92, v88, s77
    v_mfma_f32_16x16x32_bf16 a[192:195], v[36:39], v[32:35], a[192:195]
    v_perm_b32 v44, v69, v65, s76
    v_perm_b32 v45, v77, v73, s76
    v_perm_b32 v46, v85, v81, s76
    v_perm_b32 v47, v93, v89, s76
    v_mfma_f32_16x16x32_bf16 a[196:199], v[40:43], v[32:35], a[196:199]
    v_perm_b32 v48, v69, v65, s77
    v_perm_b32 v49, v77, v73, s77
    v_perm_b32 v50, v85, v81, s77
    v_perm_b32 v51, v93, v89, s77
    v_mfma_f32_16x16x32_bf16 a[200:203], v[44:47], v[32:35], a[200:203]
    v_perm_b32 v36, v70, v66, s76
    v_perm_b32 v37, v78, v74, s76
    v_perm_b32 v38, v86, v82, s76
    v_perm_b32 v39, v94, v90, s76
    v_mfma_f32_16x16x32_bf16 a[204:207], v[48:51], v[32:35], a[204:207]
    v_perm_b32 v40, v70, v66, s77
    v_perm_b32 v41, v78, v74, s77
    v_perm_b32 v42, v86, v82, s77
    v_perm_b32 v43, v94, v90, s77
    v_mfma_f32_16x16x32_bf16 a[208:211], v[36:39], v[32:35], a[208:211]
    v_perm_b32 v44, v71, v67, s76
    v_perm_b32 v45, v79, v75, s76
    v_perm_b32 v46, v87, v83, s76
    v_perm_b32 v47, v95, v91, s76
    v_mfma_f32_16x16x32_bf16 a[212:215], v[40:43], v[32:35], a[212:215]
    v_perm_b32 v48, v71, v67, s77
    v_perm_b32 v49, v79, v75, s77
    v_perm_b32 v50, v87, v83, s77
    v_perm_b32 v51, v95, v91, s77
    v_mfma_f32_16x16x32_bf16 a[216:219], v[44:47], v[32:35], a[216:219]
    s_nop 0
    v_mfma_f32_16x16x32_bf16 a[220:223], v[48:51], v[32:35], a[220:223]
    s_lshl_b32 s79, s4, 13
    s_cmp_lt_i32 s4, 0
    s_cselect_b32 s79, 0x7f000000, s79
    s_add_u32 s80, s79, 4096
    buffer_load_dwordx4 v[64:67], v2, s[32:35], s79 offen offset:0 nt
    buffer_load_dwordx4 v[68:71], v2, s[32:35], s79 offen offset:256 nt
    buffer_load_dwordx4 v[72:75], v2, s[32:35], s79 offen offset:2048 nt
    buffer_load_dwordx4 v[76:79], v2, s[32:35], s79 offen offset:2304 nt
    buffer_load_dwordx4 v[80:83], v2, s[32:35], s80 offen offset:0 nt
    buffer_load_dwordx4 v[84:87], v2, s[32:35], s80 offen offset:256 nt
    buffer_load_dwordx4 v[88:91], v2, s[32:35], s80 offen offset:2048 nt
    buffer_load_dwordx4 v[92:95], v2, s[32:35], s80 offen offset:2304 nt
    v_mfma_f32_16x16x32_bf16 v[16:19], a[128:131], a[224:227], 0
    v_mfma_f32_16x16x32_bf16 v[20:23], a[136:139], a[224:227], 0
    v_mfma_f32_16x16x32_bf16 v[24:27], a[144:147], a[224:227], 0
    v_mfma_f32_16x16x32_bf16 v[28:31], a[152:155], a[224:227], 0
    v_mfma_f32_16x16x32_bf16 v[16:19], a[132:135], a[228:231], v[16:19]
    v_mfma_f32_16x16x32_bf16 v[20:23], a[140:143], a[228:231], v[20:23]
    v_mfma_f32_16x16x32_bf16 v[24:27], a[148:151], a[228:231], v[24:27]
    v_mfma_f32_16x16x32_bf16 v[28:31], a[156:159], a[228:231], v[28:31]
    s_add_u32 s14, s17, 1
    s_mov_b32 s5, -1
    s_cmp_eq_u32 s81, 0
    s_cselect_b32 s83, s67, s68
    s_cmp_ge_u32 s14, s83
    s_nop 2
    s_cbranch_scc1 .ed_128
    s_cmp_eq_u32 s81, 0
    s_cselect_b32 s84, s69, 0
    s_sub_u32 s23, 767, s14
    s_mov_b32 s79, s23
    s_add_u32 s23, s23, s84
    s_lshl_b32 s84, s81, 12
.fix_129:
    s_add_u32 s83, s79, s84
    v_cmp_le_i32 vcc, s83, v58
    s_nop 0
    s_bcnt1_i32_b64 s25, vcc
    v_cmp_le_i32 vcc, s83, v59
    s_nop 0
    s_bcnt1_i32_b64 s26, vcc
    s_mov_b32 s24, s79
    s_sub_i32 s79, s23, s25
    s_sub_i32 s79, s79, s26
    s_cmp_lg_u32 s79, s24
    s_cbranch_scc1 .fix_129
    s_lshr_b32 s83, s79, 7
    s_xor_b32 s83, s83, s81
    s_and_b32 s83, s83, 1
    s_lshl_b32 s79, s79, 1
    s_or_b32 s79, s79, s83
    s_mov_b32 s5, s79
    s_bitset1_b32 s27, 3
.ed_128:
    s_lshl_b32 s79, s5, 13
    s_cmp_lt_i32 s5, 0
    s_cselect_b32 s79, 0x7f000000, s79
    s_add_u32 s80, s79, 4096
    buffer_load_dwordx4 a[128:131], v1, s[28:31], s79 offen offset:0 nt
    buffer_load_dwordx4 a[132:135], v1, s[28:31], s79 offen offset:128 nt
    buffer_load_dwordx4 a[136:139], v1, s[28:31], s79 offen offset:2048 nt
    buffer_load_dwordx4 a[140:143], v1, s[28:31], s79 offen offset:2176 nt
    buffer_load_dwordx4 a[144:147], v1, s[28:31], s80 offen offset:0 nt
    buffer_load_dwordx4 a[148:151], v1, s[28:31], s80 offen offset:128 nt
    buffer_load_dwordx4 a[152:155], v1, s[28:31], s80 offen offset:2048 nt
    buffer_load_dwordx4 a[156:159], v1, s[28:31], s80 offen offset:2176 nt
    v_add_f32_dpp v8, v17, v16 quad_perm:[1,0,3,2] row_mask:0xf bank_mask:0xf
    v_add_f32_dpp v9, v19, v18 quad_perm:[1,0,3,2] row_mask:0xf bank_mask:0xf
    v_add_f32_dpp v10, v21, v20 quad_perm:[1,0,3,2] row_mask:0xf bank_mask:0xf
    v_add_f32_dpp v11, v23, v22 quad_perm:[1,0,3,2] row_mask:0xf bank_mask:0xf
    v_add_f32_dpp v12, v25, v24 quad_perm:[1,0,3,2] row_mask:0xf bank_mask:0xf
    v_add_f32_dpp v13, v27, v26 quad_perm:[1,0,3,2] row_mask:0xf bank_mask:0xf
    v_add_f32_dpp v14, v29, v28 quad_perm:[1,0,3,2] row_mask:0xf bank_mask:0xf
    v_add_f32_dpp v15, v31, v30 quad_perm:[1,0,3,2] row_mask:0xf bank_mask:0xf
    v_max3_f32 v7, v8, v9, v10
    v_max3_f32 v7, v7, v11, v12
    v_max3_f32 v7, v7, v13, v14
    v_max_f32 v7, v7, v15
    v_cmp_gt_f32 vcc, v7, v4
    s_nop 4
    s_cbranch_vccz .noresc_130
    s_call_b64 s[94:95], .Lresc
.noresc_130:
    v_fma_f32 v8, v8, s75, -v3
    v_fma_f32 v9, v9, s75, -v3
    v_fma_f32 v10, v10, s75, -v3
    v_fma_f32 v11, v11, s75, -v3
    v_fma_f32 v12, v12, s75, -v3
    v_fma_f32 v13, v13, s75, -v3
    v_fma_f32 v14, v14, s75, -v3
    v_fma_f32 v15, v15, s75, -v3
    v_exp_f32 v8, v8
    v_exp_f32 v9, v9
    v_exp_f32 v10, v10
    v_exp_f32 v11, v11
    v_exp_f32 v12, v12
    v_exp_f32 v13, v13
    v_exp_f32 v14, v14
    v_exp_f32 v15, v15
    v_cvt_pk_bf16_f32 v32, v8, v9
    v_cvt_pk_bf16_f32 v33, v10, v11
    v_cvt_pk_bf16_f32 v34, v12, v13
    v_cvt_pk_bf16_f32 v35, v14, v15
    v_add_f32 v8, v8, v9
    v_add_f32 v10, v10, v11
    v_add_f32 v12, v12, v13
    v_add_f32 v14, v14, v15
    v_add_f32 v8, v8, v10
    v_add_f32 v12, v12, v14
    v_add_f32 v5, v5, v8
    v_add_f32 v5, v5, v12
    v_perm_b32 v36, v196, v192, s76
    v_perm_b32 v37, v204, v200, s76
    v_perm_b32 v38, v212, v208, s76
    v_perm_b32 v39, v220, v216, s76
    v_perm_b32 v40, v196, v192, s77
    v_perm_b32 v41, v204, v200, s77
    v_perm_b32 v42, v212, v208, s77
    v_perm_b32 v43, v220, v216, s77
    v_mfma_f32_16x16x32_bf16 a[192:195], v[36:39], v[32:35], a[192:195]
    v_perm_b32 v44, v197, v193, s76
    v_perm_b32 v45, v205, v201, s76
    v_perm_b32 v46, v213, v209, s76
    v_perm_b32 v47, v221, v217, s76
    v_mfma_f32_16x16x32_bf16 a[196:199], v[40:43], v[32:35], a[196:199]
    v_perm_b32 v48, v197, v193, s77
    v_perm_b32 v49, v205, v201, s77
    v_perm_b32 v50, v213, v209, s77
    v_perm_b32 v51, v221, v217, s77
    v_mfma_f32_16x16x32_bf16 a[200:203], v[44:47], v[32:35], a[200:203]
    v_perm_b32 v36, v198, v194, s76
    v_perm_b32 v37, v206, v202, s76
    v_perm_b32 v38, v214, v210, s76
    v_perm_b32 v39, v222, v218, s76
    v_mfma_f32_16x16x32_bf16 a[204:207], v[48:51], v[32:35], a[204:207]
    v_perm_b32 v40, v198, v194, s77
    v_perm_b32 v41, v206, v202, s77
    v_perm_b32 v42, v214, v210, s77
    v_perm_b32 v43, v222, v218, s77
    v_mfma_f32_16x16x32_bf16 a[208:211], v[36:39], v[32:35], a[208:211]
    v_perm_b32 v44, v199, v195, s76
    v_perm_b32 v45, v207, v203, s76
    v_perm_b32 v46, v215, v211, s76
    v_perm_b32 v47, v223, v219, s76
    v_mfma_f32_16x16x32_bf16 a[212:215], v[40:43], v[32:35], a[212:215]
    v_perm_b32 v48, v199, v195, s77
    v_perm_b32 v49, v207, v203, s77
    v_perm_b32 v50, v215, v211, s77
    v_perm_b32 v51, v223, v219, s77
    v_mfma_f32_16x16x32_bf16 a[216:219], v[44:47], v[32:35], a[216:219]
    s_nop 0
    v_mfma_f32_16x16x32_bf16 a[220:223], v[48:51], v[32:35], a[220:223]
    s_lshl_b32 s79, s5, 13
    s_cmp_lt_i32 s5, 0
    s_cselect_b32 s79, 0x7f000000, s79
    s_add_u32 s80, s79, 4096
    buffer_load_dwordx4 v[192:195], v2, s[32:35], s79 offen offset:0 nt
    buffer_load_dwordx4 v[196:199], v2, s[32:35], s79 offen offset:256 nt
    buffer_load_dwordx4 v[200:203], v2, s[32:35], s79 offen offset:2048 nt
    buffer_load_dwordx4 v[204:207], v2, s[32:35], s79 offen offset:2304 nt
    buffer_load_dwordx4 v[208:211], v2, s[32:35], s80 offen offset:0 nt
    buffer_load_dwordx4 v[212:215], v2, s[32:35], s80 offen offset:256 nt
    buffer_load_dwordx4 v[216:219], v2, s[32:35], s80 offen offset:2048 nt
    buffer_load_dwordx4 v[220:223], v2, s[32:35], s80 offen offset:2304 nt
    v_mfma_f32_16x16x32_bf16 v[16:19], a[64:67], a[224:227], 0
    v_mfma_f32_16x16x32_bf16 v[20:23], a[72:75], a[224:227], 0
    v_mfma_f32_16x16x32_bf16 v[24:27], a[80:83], a[224:227], 0
    v_mfma_f32_16x16x32_bf16 v[28:31], a[88:91], a[224:227], 0
    v_mfma_f32_16x16x32_bf16 v[16:19], a[68:71], a[228:231], v[16:19]
    v_mfma_f32_16x16x32_bf16 v[20:23], a[76:79], a[228:231], v[20:23]
    v_mfma_f32_16x16x32_bf16 v[24:27], a[84:87], a[228:231], v[24:27]
    v_mfma_f32_16x16x32_bf16 v[28:31], a[92:95], a[228:231], v[28:31]
    s_mov_b32 s79, s78
    s_add_u32 s80, s79, 4096
    buffer_load_dwordx4 a[64:67], v1, s[28:31], s79 offen offset:0 nt
    buffer_load_dwordx4 a[68:71], v1, s[28:31], s79 offen offset:128 nt
    buffer_load_dwordx4 a[72:75], v1, s[28:31], s79 offen offset:2048 nt
    buffer_load_dwordx4 a[76:79], v1, s[28:31], s79 offen offset:2176 nt
    buffer_load_dwordx4 a[80:83], v1, s[28:31], s80 offen offset:0 nt
    buffer_load_dwordx4 a[84:87], v1, s[28:31], s80 offen offset:128 nt
    buffer_load_dwordx4 a[88:91], v1, s[28:31], s80 offen offset:2048 nt
    buffer_load_dwordx4 a[92:95], v1, s[28:31], s80 offen offset:2176 nt
    v_add_f32_dpp v8, v17, v16 quad_perm:[1,0,3,2] row_mask:0xf bank_mask:0xf
    v_add_f32_dpp v9, v19, v18 quad_perm:[1,0,3,2] row_mask:0xf bank_mask:0xf
    v_add_f32_dpp v10, v21, v20 quad_perm:[1,0,3,2] row_mask:0xf bank_mask:0xf
    v_add_f32_dpp v11, v23, v22 quad_perm:[1,0,3,2] row_mask:0xf bank_mask:0xf
    v_add_f32_dpp v12, v25, v24 quad_perm:[1,0,3,2] row_mask:0xf bank_mask:0xf
    v_add_f32_dpp v13, v27, v26 quad_perm:[1,0,3,2] row_mask:0xf bank_mask:0xf
    v_add_f32_dpp v14, v29, v28 quad_perm:[1,0,3,2] row_mask:0xf bank_mask:0xf
    v_add_f32_dpp v15, v31, v30 quad_perm:[1,0,3,2] row_mask:0xf bank_mask:0xf
    v_max3_f32 v7, v8, v9, v10
    v_max3_f32 v7, v7, v11, v12
    v_max3_f32 v7, v7, v13, v14
    v_max_f32 v7, v7, v15
    v_cmp_gt_f32 vcc, v7, v4
    s_nop 4
    s_cbranch_vccz .noresc_131
    s_call_b64 s[94:95], .Lresc
.noresc_131:
    v_fma_f32 v8, v8, s75, -v3
    v_fma_f32 v9, v9, s75, -v3
    v_fma_f32 v10, v10, s75, -v3
    v_fma_f32 v11, v11, s75, -v3
    v_fma_f32 v12, v12, s75, -v3
    v_fma_f32 v13, v13, s75, -v3
    v_fma_f32 v14, v14, s75, -v3
    v_fma_f32 v15, v15, s75, -v3
    v_exp_f32 v8, v8
    v_exp_f32 v9, v9
    v_exp_f32 v10, v10
    v_exp_f32 v11, v11
    v_exp_f32 v12, v12
    v_exp_f32 v13, v13
    v_exp_f32 v14, v14
    v_exp_f32 v15, v15
    v_cvt_pk_bf16_f32 v32, v8, v9
    v_cvt_pk_bf16_f32 v33, v10, v11
    v_cvt_pk_bf16_f32 v34, v12, v13
    v_cvt_pk_bf16_f32 v35, v14, v15
    v_add_f32 v8, v8, v9
    v_add_f32 v10, v10, v11
    v_add_f32 v12, v12, v13
    v_add_f32 v14, v14, v15
    v_add_f32 v8, v8, v10
    v_add_f32 v12, v12, v14
    v_add_f32 v5, v5, v8
    v_add_f32 v5, v5, v12
    v_perm_b32 v36, v132, v128, s76
    v_perm_b32 v37, v140, v136, s76
    v_perm_b32 v38, v148, v144, s76
    v_perm_b32 v39, v156, v152, s76
    v_perm_b32 v40, v132, v128, s77
    v_perm_b32 v41, v140, v136, s77
    v_perm_b32 v42, v148, v144, s77
    v_perm_b32 v43, v156, v152, s77
    v_mfma_f32_16x16x32_bf16 a[192:195], v[36:39], v[32:35], a[192:195]
    v_perm_b32 v44, v133, v129, s76
    v_perm_b32 v45, v141, v137, s76
    v_perm_b32 v46, v149, v145, s76
    v_perm_b32 v47, v157, v153, s76
    v_mfma_f32_16x16x32_bf16 a[196:199], v[40:43], v[32:35], a[196:199]
    v_perm_b32 v48, v133, v129, s77
    v_perm_b32 v49, v141, v137, s77
    v_perm_b32 v50, v149, v145, s77
    v_perm_b32 v51, v157, v153, s77
    v_mfma_f32_16x16x32_bf16 a[200:203], v[44:47], v[32:35], a[200:203]
    v_perm_b32 v36, v134, v130, s76
    v_perm_b32 v37, v142, v138, s76
    v_perm_b32 v38, v150, v146, s76
    v_perm_b32 v39, v158, v154, s76
    v_mfma_f32_16x16x32_bf16 a[204:207], v[48:51], v[32:35], a[204:207]
    v_perm_b32 v40, v134, v130, s77
    v_perm_b32 v41, v142, v138, s77
    v_perm_b32 v42, v150, v146, s77
    v_perm_b32 v43, v158, v154, s77
    v_mfma_f32_16x16x32_bf16 a[208:211], v[36:39], v[32:35], a[208:211]
    v_perm_b32 v44, v135, v131, s76
    v_perm_b32 v45, v143, v139, s76
    v_perm_b32 v46, v151, v147, s76
    v_perm_b32 v47, v159, v155, s76
    v_mfma_f32_16x16x32_bf16 a[212:215], v[40:43], v[32:35], a[212:215]
    v_perm_b32 v48, v135, v131, s77
    v_perm_b32 v49, v143, v139, s77
    v_perm_b32 v50, v151, v147, s77
    v_perm_b32 v51, v159, v155, s77
    v_mfma_f32_16x16x32_bf16 a[216:219], v[44:47], v[32:35], a[216:219]
    s_nop 0
    v_mfma_f32_16x16x32_bf16 a[220:223], v[48:51], v[32:35], a[220:223]
    s_waitcnt vmcnt(54)
    s_mov_b32 s79, s78
    s_add_u32 s80, s79, 4096
    buffer_load_dwordx4 v[128:131], v2, s[32:35], s79 offen offset:0 nt
    buffer_load_dwordx4 v[132:135], v2, s[32:35], s79 offen offset:256 nt
    buffer_load_dwordx4 v[136:139], v2, s[32:35], s79 offen offset:2048 nt
    buffer_load_dwordx4 v[140:143], v2, s[32:35], s79 offen offset:2304 nt
    buffer_load_dwordx4 v[144:147], v2, s[32:35], s80 offen offset:0 nt
    buffer_load_dwordx4 v[148:151], v2, s[32:35], s80 offen offset:256 nt
    buffer_load_dwordx4 v[152:155], v2, s[32:35], s80 offen offset:2048 nt
    buffer_load_dwordx4 v[156:159], v2, s[32:35], s80 offen offset:2304 nt
    v_mfma_f32_16x16x32_bf16 v[16:19], a[160:163], a[224:227], 0
    v_mfma_f32_16x16x32_bf16 v[20:23], a[168:171], a[224:227], 0
    v_mfma_f32_16x16x32_bf16 v[24:27], a[176:179], a[224:227], 0
    v_mfma_f32_16x16x32_bf16 v[28:31], a[184:187], a[224:227], 0
    v_mfma_f32_16x16x32_bf16 v[16:19], a[164:167], a[228:231], v[16:19]
    v_mfma_f32_16x16x32_bf16 v[20:23], a[172:175], a[228:231], v[20:23]
    v_mfma_f32_16x16x32_bf16 v[24:27], a[180:183], a[228:231], v[24:27]
    v_mfma_f32_16x16x32_bf16 v[28:31], a[188:191], a[228:231], v[28:31]
    s_add_u32 s14, s17, 2
    s_mov_b32 s6, -1
    s_cmp_eq_u32 s81, 0
    s_cselect_b32 s83, s67, s68
    s_cmp_ge_u32 s14, s83
    s_nop 2
    s_cbranch_scc1 .ed_132
    s_cmp_eq_u32 s81, 0
    s_cselect_b32 s84, s69, 0
    s_sub_u32 s23, 767, s14
    s_mov_b32 s79, s23
    s_add_u32 s23, s23, s84
    s_lshl_b32 s84, s81, 12
.fix_133:
    s_add_u32 s83, s79, s84
    v_cmp_le_i32 vcc, s83, v58
    s_nop 0
    s_bcnt1_i32_b64 s25, vcc
    v_cmp_le_i32 vcc, s83, v59
    s_nop 0
    s_bcnt1_i32_b64 s26, vcc
    s_mov_b32 s24, s79
    s_sub_i32 s79, s23, s25
    s_sub_i32 s79, s79, s26
    s_cmp_lg_u32 s79, s24
    s_cbranch_scc1 .fix_133
    s_lshr_b32 s83, s79, 7
    s_xor_b32 s83, s83, s81
    s_and_b32 s83, s83, 1
    s_lshl_b32 s79, s79, 1
    s_or_b32 s79, s79, s83
    s_mov_b32 s6, s79
    s_bitset1_b32 s27, 4
.ed_132:
    s_waitcnt vmcnt(54)
    s_lshl_b32 s79, s6, 13
    s_cmp_lt_i32 s6, 0
    s_cselect_b32 s79, 0x7f000000, s79
    s_add_u32 s80, s79, 4096
    buffer_load_dwordx4 a[160:163], v1, s[28:31], s79 offen offset:0 nt
    buffer_load_dwordx4 a[164:167], v1, s[28:31], s79 offen offset:128 nt
    buffer_load_dwordx4 a[168:171], v1, s[28:31], s79 offen offset:2048 nt
    buffer_load_dwordx4 a[172:175], v1, s[28:31], s79 offen offset:2176 nt
    buffer_load_dwordx4 a[176:179], v1, s[28:31], s80 offen offset:0 nt
    buffer_load_dwordx4 a[180:183], v1, s[28:31], s80 offen offset:128 nt
    buffer_load_dwordx4 a[184:187], v1, s[28:31], s80 offen offset:2048 nt
    buffer_load_dwordx4 a[188:191], v1, s[28:31], s80 offen offset:2176 nt
    v_add_f32_dpp v8, v17, v16 quad_perm:[1,0,3,2] row_mask:0xf bank_mask:0xf
    v_add_f32_dpp v9, v19, v18 quad_perm:[1,0,3,2] row_mask:0xf bank_mask:0xf
    v_add_f32_dpp v10, v21, v20 quad_perm:[1,0,3,2] row_mask:0xf bank_mask:0xf
    v_add_f32_dpp v11, v23, v22 quad_perm:[1,0,3,2] row_mask:0xf bank_mask:0xf
    v_add_f32_dpp v12, v25, v24 quad_perm:[1,0,3,2] row_mask:0xf bank_mask:0xf
    v_add_f32_dpp v13, v27, v26 quad_perm:[1,0,3,2] row_mask:0xf bank_mask:0xf
    v_add_f32_dpp v14, v29, v28 quad_perm:[1,0,3,2] row_mask:0xf bank_mask:0xf
    v_add_f32_dpp v15, v31, v30 quad_perm:[1,0,3,2] row_mask:0xf bank_mask:0xf
    v_max3_f32 v7, v8, v9, v10
    v_max3_f32 v7, v7, v11, v12
    v_max3_f32 v7, v7, v13, v14
    v_max_f32 v7, v7, v15
    v_cmp_gt_f32 vcc, v7, v4
    s_nop 4
    s_cbranch_vccz .noresc_134
    s_call_b64 s[94:95], .Lresc
.noresc_134:
    v_fma_f32 v8, v8, s75, -v3
    v_fma_f32 v9, v9, s75, -v3
    v_fma_f32 v10, v10, s75, -v3
    v_fma_f32 v11, v11, s75, -v3
    v_fma_f32 v12, v12, s75, -v3
    v_fma_f32 v13, v13, s75, -v3
    v_fma_f32 v14, v14, s75, -v3
    v_fma_f32 v15, v15, s75, -v3
    v_exp_f32 v8, v8
    v_exp_f32 v9, v9
    v_exp_f32 v10, v10
    v_exp_f32 v11, v11
    v_exp_f32 v12, v12
    v_exp_f32 v13, v13
    v_exp_f32 v14, v14
    v_exp_f32 v15, v15
    v_cvt_pk_bf16_f32 v32, v8, v9
    v_cvt_pk_bf16_f32 v33, v10, v11
    v_cvt_pk_bf16_f32 v34, v12, v13
    v_cvt_pk_bf16_f32 v35, v14, v15
    v_add_f32 v8, v8, v9
    v_add_f32 v10, v10, v11
    v_add_f32 v12, v12, v13
    v_add_f32 v14, v14, v15
    v_add_f32 v8, v8, v10
    v_add_f32 v12, v12, v14
    v_add_f32 v5, v5, v8
    v_add_f32 v5, v5, v12
    v_perm_b32 v36, v228, v224, s76
    v_perm_b32 v37, v236, v232, s76
    v_perm_b32 v38, v244, v240, s76
    v_perm_b32 v39, v252, v248, s76
    v_perm_b32 v40, v228, v224, s77
    v_perm_b32 v41, v236, v232, s77
    v_perm_b32 v42, v244, v240, s77
    v_perm_b32 v43, v252, v248, s77
    v_mfma_f32_16x16x32_bf16 a[192:195], v[36:39], v[32:35], a[192:195]
    v_perm_b32 v44, v229, v225, s76
    v_perm_b32 v45, v237, v233, s76
    v_perm_b32 v46, v245, v241, s76
    v_perm_b32 v47, v253, v249, s76
    v_mfma_f32_16x16x32_bf16 a[196:199], v[40:43], v[32:35], a[196:199]
    v_perm_b32 v48, v229, v225, s77
    v_perm_b32 v49, v237, v233, s77
    v_perm_b32 v50, v245, v241, s77
    v_perm_b32 v51, v253, v249, s77
    v_mfma_f32_16x16x32_bf16 a[200:203], v[44:47], v[32:35], a[200:203]
    v_perm_b32 v36, v230, v226, s76
    v_perm_b32 v37, v238, v234, s76
    v_perm_b32 v38, v246, v242, s76
    v_perm_b32 v39, v254, v250, s76
    v_mfma_f32_16x16x32_bf16 a[204:207], v[48:51], v[32:35], a[204:207]
    v_perm_b32 v40, v230, v226, s77
    v_perm_b32 v41, v238, v234, s77
    v_perm_b32 v42, v246, v242, s77
    v_perm_b32 v43, v254, v250, s77
    v_mfma_f32_16x16x32_bf16 a[208:211], v[36:39], v[32:35], a[208:211]
    v_perm_b32 v44, v231, v227, s76
    v_perm_b32 v45, v239, v235, s76
    v_perm_b32 v46, v247, v243, s76
    v_perm_b32 v47, v255, v251, s76
    v_mfma_f32_16x16x32_bf16 a[212:215], v[40:43], v[32:35], a[212:215]
    v_perm_b32 v48, v231, v227, s77
    v_perm_b32 v49, v239, v235, s77
    v_perm_b32 v50, v247, v243, s77
    v_perm_b32 v51, v255, v251, s77
    v_mfma_f32_16x16x32_bf16 a[216:219], v[44:47], v[32:35], a[216:219]
    s_nop 0
    v_mfma_f32_16x16x32_bf16 a[220:223], v[48:51], v[32:35], a[220:223]
    s_waitcnt vmcnt(54)
    s_lshl_b32 s79, s6, 13
    s_cmp_lt_i32 s6, 0
    s_cselect_b32 s79, 0x7f000000, s79
    s_add_u32 s80, s79, 4096
    buffer_load_dwordx4 v[224:227], v2, s[32:35], s79 offen offset:0 nt
    buffer_load_dwordx4 v[228:231], v2, s[32:35], s79 offen offset:256 nt
    buffer_load_dwordx4 v[232:235], v2, s[32:35], s79 offen offset:2048 nt
    buffer_load_dwordx4 v[236:239], v2, s[32:35], s79 offen offset:2304 nt
    buffer_load_dwordx4 v[240:243], v2, s[32:35], s80 offen offset:0 nt
    buffer_load_dwordx4 v[244:247], v2, s[32:35], s80 offen offset:256 nt
    buffer_load_dwordx4 v[248:251], v2, s[32:35], s80 offen offset:2048 nt
    buffer_load_dwordx4 v[252:255], v2, s[32:35], s80 offen offset:2304 nt
    v_mfma_f32_16x16x32_bf16 v[16:19], a[96:99], a[224:227], 0
    v_mfma_f32_16x16x32_bf16 v[20:23], a[104:107], a[224:227], 0
    v_mfma_f32_16x16x32_bf16 v[24:27], a[112:115], a[224:227], 0
    v_mfma_f32_16x16x32_bf16 v[28:31], a[120:123], a[224:227], 0
    v_mfma_f32_16x16x32_bf16 v[16:19], a[100:103], a[228:231], v[16:19]
    v_mfma_f32_16x16x32_bf16 v[20:23], a[108:111], a[228:231], v[20:23]
    v_mfma_f32_16x16x32_bf16 v[24:27], a[116:119], a[228:231], v[24:27]
    v_mfma_f32_16x16x32_bf16 v[28:31], a[124:127], a[228:231], v[28:31]
    s_waitcnt vmcnt(60)
    s_add_u32 s79, s78, 0x80000
    s_add_u32 s80, s79, 4096
    buffer_load_dwordx4 a[120:123], v1, s[28:31], s80 offen offset:2048 nt
    buffer_load_dwordx4 a[124:127], v1, s[28:31], s80 offen offset:2176 nt
    v_add_f32_dpp v8, v17, v16 quad_perm:[1,0,3,2] row_mask:0xf bank_mask:0xf
    v_add_f32_dpp v9, v19, v18 quad_perm:[1,0,3,2] row_mask:0xf bank_mask:0xf
    v_add_f32_dpp v10, v21, v20 quad_perm:[1,0,3,2] row_mask:0xf bank_mask:0xf
    v_add_f32_dpp v11, v23, v22 quad_perm:[1,0,3,2] row_mask:0xf bank_mask:0xf
    v_add_f32_dpp v12, v25, v24 quad_perm:[1,0,3,2] row_mask:0xf bank_mask:0xf
    v_add_f32_dpp v13, v27, v26 quad_perm:[1,0,3,2] row_mask:0xf bank_mask:0xf
    v_add_f32_dpp v14, v29, v28 quad_perm:[1,0,3,2] row_mask:0xf bank_mask:0xf
    v_add_f32_dpp v15, v31, v30 quad_perm:[1,0,3,2] row_mask:0xf bank_mask:0xf
    v_max3_f32 v7, v8, v9, v10
    v_max3_f32 v7, v7, v11, v12
    v_max3_f32 v7, v7, v13, v14
    v_max_f32 v7, v7, v15
    v_cmp_gt_f32 vcc, v7, v4
    s_nop 4
    s_cbranch_vccz .noresc_135
    s_call_b64 s[94:95], .Lresc
.noresc_135:
    v_fma_f32 v8, v8, s75, -v3
    v_fma_f32 v9, v9, s75, -v3
    v_fma_f32 v10, v10, s75, -v3
    v_fma_f32 v11, v11, s75, -v3
    v_fma_f32 v12, v12, s75, -v3
    v_fma_f32 v13, v13, s75, -v3
    v_fma_f32 v14, v14, s75, -v3
    v_fma_f32 v15, v15, s75, -v3
    v_exp_f32 v8, v8
    v_exp_f32 v9, v9
    v_exp_f32 v10, v10
    v_exp_f32 v11, v11
    v_exp_f32 v12, v12
    v_exp_f32 v13, v13
    v_exp_f32 v14, v14
    v_exp_f32 v15, v15
    v_cvt_pk_bf16_f32 v32, v8, v9
    v_cvt_pk_bf16_f32 v33, v10, v11
    v_cvt_pk_bf16_f32 v34, v12, v13
    v_cvt_pk_bf16_f32 v35, v14, v15
    v_add_f32 v8, v8, v9
    v_add_f32 v10, v10, v11
    v_add_f32 v12, v12, v13
    v_add_f32 v14, v14, v15
    v_add_f32 v8, v8, v10
    v_add_f32 v12, v12, v14
    v_add_f32 v5, v5, v8
    v_add_f32 v5, v5, v12
    v_perm_b32 v36, v164, v160, s76
    v_perm_b32 v37, v172, v168, s76
    v_perm_b32 v38, v180, v176, s76
    v_perm_b32 v39, v188, v184, s76
    v_perm_b32 v40, v164, v160, s77
    v_perm_b32 v41, v172, v168, s77
    v_perm_b32 v42, v180, v176, s77
    v_perm_b32 v43, v188, v184, s77
    v_mfma_f32_16x16x32_bf16 a[192:195], v[36:39], v[32:35], a[192:195]
    v_perm_b32 v44, v165, v161, s76
    v_perm_b32 v45, v173, v169, s76
    v_perm_b32 v46, v181, v177, s76
    v_perm_b32 v47, v189, v185, s76
    v_mfma_f32_16x16x32_bf16 a[196:199], v[40:43], v[32:35], a[196:199]
    v_perm_b32 v48, v165, v161, s77
    v_perm_b32 v49, v173, v169, s77
    v_perm_b32 v50, v181, v177, s77
    v_perm_b32 v51, v189, v185, s77
    v_mfma_f32_16x16x32_bf16 a[200:203], v[44:47], v[32:35], a[200:203]
    v_perm_b32 v36, v166, v162, s76
    v_perm_b32 v37, v174, v170, s76
    v_perm_b32 v38, v182, v178, s76
    v_perm_b32 v39, v190, v186, s76
    v_mfma_f32_16x16x32_bf16 a[204:207], v[48:51], v[32:35], a[204:207]
    v_perm_b32 v40, v166, v162, s77
    v_perm_b32 v41, v174, v170, s77
    v_perm_b32 v42, v182, v178, s77
    v_perm_b32 v43, v190, v186, s77
    v_mfma_f32_16x16x32_bf16 a[208:211], v[36:39], v[32:35], a[208:211]
    v_perm_b32 v44, v167, v163, s76
    v_perm_b32 v45, v175, v171, s76
    v_perm_b32 v46, v183, v179, s76
    v_perm_b32 v47, v191, v187, s76
    v_mfma_f32_16x16x32_bf16 a[212:215], v[40:43], v[32:35], a[212:215]
    v_perm_b32 v48, v167, v163, s77
    v_perm_b32 v49, v175, v171, s77
    v_perm_b32 v50, v183, v179, s77
    v_perm_b32 v51, v191, v187, s77
    v_mfma_f32_16x16x32_bf16 a[216:219], v[44:47], v[32:35], a[216:219]
    s_nop 0
    v_mfma_f32_16x16x32_bf16 a[220:223], v[48:51], v[32:35], a[220:223]
    s_sub_u32 s83, s60, 144
    s_cmp_lt_u32 s83, 72
    s_nop 5
    s_cbranch_scc1 .vg_136
    s_lshl_b32 s83, s3, 13
    s_add_u32 s83, s83, 108544
    v_lshlrev_b32 v7, 4, v0
    v_add_u32 v7, s83, v7
    ds_read_b128 v[160:163], v7 offset:0
    ds_read_b128 v[164:167], v7 offset:1024
    ds_read_b128 v[168:171], v7 offset:2048
    ds_read_b128 v[172:175], v7 offset:3072
    ds_read_b128 v[176:179], v7 offset:4096
    ds_read_b128 v[180:183], v7 offset:5120
    ds_read_b128 v[184:187], v7 offset:6144
    ds_read_b128 v[188:191], v7 offset:7168
    s_branch .vgd_137
.vg_136:
    s_waitcnt vmcnt(54)
    s_add_u32 s79, s78, 0x80000
    s_add_u32 s80, s79, 4096
    buffer_load_dwordx4 v[160:163], v2, s[32:35], s79 offen offset:0 nt
    buffer_load_dwordx4 v[164:167], v2, s[32:35], s79 offen offset:256 nt
    buffer_load_dwordx4 v[168:171], v2, s[32:35], s79 offen offset:2048 nt
    buffer_load_dwordx4 v[172:175], v2, s[32:35], s79 offen offset:2304 nt
    buffer_load_dwordx4 v[176:179], v2, s[32:35], s80 offen offset:0 nt
    buffer_load_dwordx4 v[180:183], v2, s[32:35], s80 offen offset:256 nt
    buffer_load_dwordx4 v[184:187], v2, s[32:35], s80 offen offset:2048 nt
    buffer_load_dwordx4 v[188:191], v2, s[32:35], s80 offen offset:2304 nt
.vgd_137:
    s_bitcmp0_b32 s27, 0
    s_cbranch_scc1 .sk_139
    v_mfma_f32_16x16x32_bf16 v[16:19], a[32:35], a[224:227], 0
    v_mfma_f32_16x16x32_bf16 v[20:23], a[40:43], a[224:227], 0
    v_mfma_f32_16x16x32_bf16 v[24:27], a[48:51], a[224:227], 0
    v_mfma_f32_16x16x32_bf16 v[28:31], a[56:59], a[224:227], 0
    v_mfma_f32_16x16x32_bf16 v[16:19], a[36:39], a[228:231], v[16:19]
    v_mfma_f32_16x16x32_bf16 v[20:23], a[44:47], a[228:231], v[20:23]
    v_mfma_f32_16x16x32_bf16 v[24:27], a[52:55], a[228:231], v[24:27]
    v_mfma_f32_16x16x32_bf16 v[28:31], a[60:63], a[228:231], v[28:31]
    s_nop 7
.sk_139:
    s_add_u32 s14, s17, 3
    s_mov_b32 s7, -1
    s_cmp_eq_u32 s81, 0
    s_cselect_b32 s83, s67, s68
    s_cmp_ge_u32 s14, s83
    s_cbranch_scc1 .ed_140
    s_cmp_eq_u32 s81, 0
    s_cselect_b32 s84, s69, 0
    s_sub_u32 s23, 767, s14
    s_mov_b32 s79, s23
    s_add_u32 s23, s23, s84
    s_lshl_b32 s84, s81, 12
.fix_141:
    s_add_u32 s83, s79, s84
    v_cmp_le_i32 vcc, s83, v58
    s_nop 0
    s_bcnt1_i32_b64 s25, vcc
    v_cmp_le_i32 vcc, s83, v59
    s_nop 0
    s_bcnt1_i32_b64 s26, vcc
    s_mov_b32 s24, s79
    s_sub_i32 s79, s23, s25
    s_sub_i32 s79, s79, s26
    s_cmp_lg_u32 s79, s24
    s_cbranch_scc1 .fix_141
    s_lshr_b32 s83, s79, 7
    s_xor_b32 s83, s83, s81
    s_and_b32 s83, s83, 1
    s_lshl_b32 s79, s79, 1
    s_or_b32 s79, s79, s83
    s_mov_b32 s7, s79
    s_bitset1_b32 s27, 5
.ed_140:
    s_waitcnt vmcnt(46)
    s_lshl_b32 s79, s7, 13
    s_cmp_lt_i32 s7, 0
    s_cselect_b32 s79, 0x7f000000, s79
    s_add_u32 s80, s79, 4096
    buffer_load_dwordx4 a[32:35], v1, s[28:31], s79 offen offset:0 nt
    buffer_load_dwordx4 a[36:39], v1, s[28:31], s79 offen offset:128 nt
    buffer_load_dwordx4 a[40:43], v1, s[28:31], s79 offen offset:2048 nt
    buffer_load_dwordx4 a[44:47], v1, s[28:31], s79 offen offset:2176 nt
    buffer_load_dwordx4 a[48:51], v1, s[28:31], s80 offen offset:0 nt
    buffer_load_dwordx4 a[52:55], v1, s[28:31], s80 offen offset:128 nt
    buffer_load_dwordx4 a[56:59], v1, s[28:31], s80 offen offset:2048 nt
    buffer_load_dwordx4 a[60:63], v1, s[28:31], s80 offen offset:2176 nt
    s_bitcmp0_b32 s27, 0
    s_cbranch_scc1 .sk_142
    v_add_f32_dpp v8, v17, v16 quad_perm:[1,0,3,2] row_mask:0xf bank_mask:0xf
    v_add_f32_dpp v9, v19, v18 quad_perm:[1,0,3,2] row_mask:0xf bank_mask:0xf
    v_add_f32_dpp v10, v21, v20 quad_perm:[1,0,3,2] row_mask:0xf bank_mask:0xf
    v_add_f32_dpp v11, v23, v22 quad_perm:[1,0,3,2] row_mask:0xf bank_mask:0xf
    v_add_f32_dpp v12, v25, v24 quad_perm:[1,0,3,2] row_mask:0xf bank_mask:0xf
    v_add_f32_dpp v13, v27, v26 quad_perm:[1,0,3,2] row_mask:0xf bank_mask:0xf
    v_add_f32_dpp v14, v29, v28 quad_perm:[1,0,3,2] row_mask:0xf bank_mask:0xf
    v_add_f32_dpp v15, v31, v30 quad_perm:[1,0,3,2] row_mask:0xf bank_mask:0xf
    v_max3_f32 v7, v8, v9, v10
    v_max3_f32 v7, v7, v11, v12
    v_max3_f32 v7, v7, v13, v14
    v_max_f32 v7, v7, v15
    v_cmp_gt_f32 vcc, v7, v4
    s_nop 4
    s_cbranch_vccz .noresc_143
    s_call_b64 s[94:95], .Lresc
.noresc_143:
    v_fma_f32 v8, v8, s75, -v3
    v_fma_f32 v9, v9, s75, -v3
    v_fma_f32 v10, v10, s75, -v3
    v_fma_f32 v11, v11, s75, -v3
    v_fma_f32 v12, v12, s75, -v3
    v_fma_f32 v13, v13, s75, -v3
    v_fma_f32 v14, v14, s75, -v3
    v_fma_f32 v15, v15, s75, -v3
    v_exp_f32 v8, v8
    v_exp_f32 v9, v9
    v_exp_f32 v10, v10
    v_exp_f32 v11, v11
    v_exp_f32 v12, v12
    v_exp_f32 v13, v13
    v_exp_f32 v14, v14
    v_exp_f32 v15, v15
    v_cvt_pk_bf16_f32 v32, v8, v9
    v_cvt_pk_bf16_f32 v33, v10, v11
    v_cvt_pk_bf16_f32 v34, v12, v13
    v_cvt_pk_bf16_f32 v35, v14, v15
    v_add_f32 v8, v8, v9
    v_add_f32 v10, v10, v11
    v_add_f32 v12, v12, v13
    v_add_f32 v14, v14, v15
    v_add_f32 v8, v8, v10
    v_add_f32 v12, v12, v14
    v_add_f32 v5, v5, v8
    v_add_f32 v5, v5, v12
    s_nop 1
.sk_142:
    s_bitcmp0_b32 s27, 0
    s_cbranch_scc1 .sk_144
    v_perm_b32 v36, v100, v96, s76
    v_perm_b32 v37, v108, v104, s76
    v_perm_b32 v38, v116, v112, s76
    v_perm_b32 v39, v124, v120, s76
    v_perm_b32 v40, v100, v96, s77
    v_perm_b32 v41, v108, v104, s77
    v_perm_b32 v42, v116, v112, s77
    v_perm_b32 v43, v124, v120, s77
    v_mfma_f32_16x16x32_bf16 a[192:195], v[36:39], v[32:35], a[192:195]
    v_perm_b32 v44, v101, v97, s76
    v_perm_b32 v45, v109, v105, s76
    v_perm_b32 v46, v117, v113, s76
    v_perm_b32 v47, v125, v121, s76
    v_mfma_f32_16x16x32_bf16 a[196:199], v[40:43], v[32:35], a[196:199]
    v_perm_b32 v48, v101, v97, s77
    v_perm_b32 v49, v109, v105, s77
    v_perm_b32 v50, v117, v113, s77
    v_perm_b32 v51, v125, v121, s77
    v_mfma_f32_16x16x32_bf16 a[200:203], v[44:47], v[32:35], a[200:203]
    v_perm_b32 v36, v102, v98, s76
    v_perm_b32 v37, v110, v106, s76
    v_perm_b32 v38, v118, v114, s76
    v_perm_b32 v39, v126, v122, s76
    v_mfma_f32_16x16x32_bf16 a[204:207], v[48:51], v[32:35], a[204:207]
    v_perm_b32 v40, v102, v98, s77
    v_perm_b32 v41, v110, v106, s77
    v_perm_b32 v42, v118, v114, s77
    v_perm_b32 v43, v126, v122, s77
    v_mfma_f32_16x16x32_bf16 a[208:211], v[36:39], v[32:35], a[208:211]
    v_perm_b32 v44, v103, v99, s76
    v_perm_b32 v45, v111, v107, s76
    v_perm_b32 v46, v119, v115, s76
    v_perm_b32 v47, v127, v123, s76
    v_mfma_f32_16x16x32_bf16 a[212:215], v[40:43], v[32:35], a[212:215]
    v_perm_b32 v48, v103, v99, s77
    v_perm_b32 v49, v111, v107, s77
    v_perm_b32 v50, v119, v115, s77
    v_perm_b32 v51, v127, v123, s77
    v_mfma_f32_16x16x32_bf16 a[216:219], v[44:47], v[32:35], a[216:219]
    s_nop 0
    v_mfma_f32_16x16x32_bf16 a[220:223], v[48:51], v[32:35], a[220:223]
    s_nop 7
.sk_144:
    s_waitcnt vmcnt(46)
    s_lshl_b32 s79, s7, 13
    s_cmp_lt_i32 s7, 0
    s_cselect_b32 s79, 0x7f000000, s79
    s_add_u32 s80, s79, 4096
    buffer_load_dwordx4 v[96:99], v2, s[32:35], s79 offen offset:0 nt
    buffer_load_dwordx4 v[100:103], v2, s[32:35], s79 offen offset:256 nt
    buffer_load_dwordx4 v[104:107], v2, s[32:35], s79 offen offset:2048 nt
    buffer_load_dwordx4 v[108:111], v2, s[32:35], s79 offen offset:2304 nt
    buffer_load_dwordx4 v[112:115], v2, s[32:35], s80 offen offset:0 nt
    buffer_load_dwordx4 v[116:119], v2, s[32:35], s80 offen offset:256 nt
    buffer_load_dwordx4 v[120:123], v2, s[32:35], s80 offen offset:2048 nt
    buffer_load_dwordx4 v[124:127], v2, s[32:35], s80 offen offset:2304 nt
    s_bitcmp0_b32 s27, 2
    s_cbranch_scc1 .sk_145
    v_mfma_f32_16x16x32_bf16 v[16:19], a[0:3], a[224:227], 0
    v_mfma_f32_16x16x32_bf16 v[20:23], a[8:11], a[224:227], 0
    v_mfma_f32_16x16x32_bf16 v[24:27], a[16:19], a[224:227], 0
    v_mfma_f32_16x16x32_bf16 v[28:31], a[24:27], a[224:227], 0
    v_mfma_f32_16x16x32_bf16 v[16:19], a[4:7], a[228:231], v[16:19]
    v_mfma_f32_16x16x32_bf16 v[20:23], a[12:15], a[228:231], v[20:23]
    v_mfma_f32_16x16x32_bf16 v[24:27], a[20:23], a[228:231], v[24:27]
    v_mfma_f32_16x16x32_bf16 v[28:31], a[28:31], a[228:231], v[28:31]
    s_nop 7
.sk_145:
    s_add_u32 s14, s17, 4
    s_mov_b32 s8, -1
    s_cmp_eq_u32 s81, 0
    s_cselect_b32 s83, s67, s68
    s_cmp_ge_u32 s14, s83
    s_cbranch_scc1 .ed_146
    s_cmp_eq_u32 s81, 0
    s_cselect_b32 s84, s69, 0
    s_sub_u32 s23, 767, s14
    s_mov_b32 s79, s23
    s_add_u32 s23, s23, s84
    s_lshl_b32 s84, s81, 12
.fix_147:
    s_add_u32 s83, s79, s84
    v_cmp_le_i32 vcc, s83, v58
    s_nop 0
    s_bcnt1_i32_b64 s25, vcc
    v_cmp_le_i32 vcc, s83, v59
    s_nop 0
    s_bcnt1_i32_b64 s26, vcc
    s_mov_b32 s24, s79
    s_sub_i32 s79, s23, s25
    s_sub_i32 s79, s79, s26
    s_cmp_lg_u32 s79, s24
    s_cbranch_scc1 .fix_147
    s_lshr_b32 s83, s79, 7
    s_xor_b32 s83, s83, s81
    s_and_b32 s83, s83, 1
    s_lshl_b32 s79, s79, 1
    s_or_b32 s79, s79, s83
    s_mov_b32 s8, s79
    s_bitset1_b32 s27, 6
.ed_146:
    s_waitcnt vmcnt(46)
    s_lshl_b32 s79, s8, 13
    s_cmp_lt_i32 s8, 0
    s_cselect_b32 s79, 0x7f000000, s79
    s_add_u32 s80, s79, 4096
    buffer_load_dwordx4 a[0:3], v1, s[28:31], s79 offen offset:0 nt
    buffer_load_dwordx4 a[4:7], v1, s[28:31], s79 offen offset:128 nt
    buffer_load_dwordx4 a[8:11], v1, s[28:31], s79 offen offset:2048 nt
    buffer_load_dwordx4 a[12:15], v1, s[28:31], s79 offen offset:2176 nt
    buffer_load_dwordx4 a[16:19], v1, s[28:31], s80 offen offset:0 nt
    buffer_load_dwordx4 a[20:23], v1, s[28:31], s80 offen offset:128 nt
    buffer_load_dwordx4 a[24:27], v1, s[28:31], s80 offen offset:2048 nt
    buffer_load_dwordx4 a[28:31], v1, s[28:31], s80 offen offset:2176 nt
    s_bitcmp0_b32 s27, 2
    s_cbranch_scc1 .sk_148
    v_add_f32_dpp v8, v17, v16 quad_perm:[1,0,3,2] row_mask:0xf bank_mask:0xf
    v_add_f32_dpp v9, v19, v18 quad_perm:[1,0,3,2] row_mask:0xf bank_mask:0xf
    v_add_f32_dpp v10, v21, v20 quad_perm:[1,0,3,2] row_mask:0xf bank_mask:0xf
    v_add_f32_dpp v11, v23, v22 quad_perm:[1,0,3,2] row_mask:0xf bank_mask:0xf
    v_add_f32_dpp v12, v25, v24 quad_perm:[1,0,3,2] row_mask:0xf bank_mask:0xf
    v_add_f32_dpp v13, v27, v26 quad_perm:[1,0,3,2] row_mask:0xf bank_mask:0xf
    v_add_f32_dpp v14, v29, v28 quad_perm:[1,0,3,2] row_mask:0xf bank_mask:0xf
    v_add_f32_dpp v15, v31, v30 quad_perm:[1,0,3,2] row_mask:0xf bank_mask:0xf
    v_max3_f32 v7, v8, v9, v10
    v_max3_f32 v7, v7, v11, v12
    v_max3_f32 v7, v7, v13, v14
    v_max_f32 v7, v7, v15
    v_cmp_gt_f32 vcc, v7, v4
    s_nop 4
    s_cbranch_vccz .noresc_149
    s_call_b64 s[94:95], .Lresc
.noresc_149:
    v_fma_f32 v8, v8, s75, -v3
    v_fma_f32 v9, v9, s75, -v3
    v_fma_f32 v10, v10, s75, -v3
    v_fma_f32 v11, v11, s75, -v3
    v_fma_f32 v12, v12, s75, -v3
    v_fma_f32 v13, v13, s75, -v3
    v_fma_f32 v14, v14, s75, -v3
    v_fma_f32 v15, v15, s75, -v3
    v_exp_f32 v8, v8
    v_exp_f32 v9, v9
    v_exp_f32 v10, v10
    v_exp_f32 v11, v11
    v_exp_f32 v12, v12
    v_exp_f32 v13, v13
    v_exp_f32 v14, v14
    v_exp_f32 v15, v15
    v_cvt_pk_bf16_f32 v32, v8, v9
    v_cvt_pk_bf16_f32 v33, v10, v11
    v_cvt_pk_bf16_f32 v34, v12, v13
    v_cvt_pk_bf16_f32 v35, v14, v15
    v_add_f32 v8, v8, v9
    v_add_f32 v10, v10, v11
    v_add_f32 v12, v12, v13
    v_add_f32 v14, v14, v15
    v_add_f32 v8, v8, v10
    v_add_f32 v12, v12, v14
    v_add_f32 v5, v5, v8
    v_add_f32 v5, v5, v12
    s_nop 1
.sk_148:
    s_bitcmp0_b32 s27, 2
    s_cbranch_scc1 .sk_150
    v_perm_b32 v36, v68, v64, s76
    v_perm_b32 v37, v76, v72, s76
    v_perm_b32 v38, v84, v80, s76
    v_perm_b32 v39, v92, v88, s76
    v_perm_b32 v40, v68, v64, s77
    v_perm_b32 v41, v76, v72, s77
    v_perm_b32 v42, v84, v80, s77
    v_perm_b32 v43, v92, v88, s77
    v_mfma_f32_16x16x32_bf16 a[192:195], v[36:39], v[32:35], a[192:195]
    v_perm_b32 v44, v69, v65, s76
    v_perm_b32 v45, v77, v73, s76
    v_perm_b32 v46, v85, v81, s76
    v_perm_b32 v47, v93, v89, s76
    v_mfma_f32_16x16x32_bf16 a[196:199], v[40:43], v[32:35], a[196:199]
    v_perm_b32 v48, v69, v65, s77
    v_perm_b32 v49, v77, v73, s77
    v_perm_b32 v50, v85, v81, s77
    v_perm_b32 v51, v93, v89, s77
    v_mfma_f32_16x16x32_bf16 a[200:203], v[44:47], v[32:35], a[200:203]
    v_perm_b32 v36, v70, v66, s76
    v_perm_b32 v37, v78, v74, s76
    v_perm_b32 v38, v86, v82, s76
    v_perm_b32 v39, v94, v90, s76
    v_mfma_f32_16x16x32_bf16 a[204:207], v[48:51], v[32:35], a[204:207]
    v_perm_b32 v40, v70, v66, s77
    v_perm_b32 v41, v78, v74, s77
    v_perm_b32 v42, v86, v82, s77
    v_perm_b32 v43, v94, v90, s77
    v_mfma_f32_16x16x32_bf16 a[208:211], v[36:39], v[32:35], a[208:211]
    v_perm_b32 v44, v71, v67, s76
    v_perm_b32 v45, v79, v75, s76
    v_perm_b32 v46, v87, v83, s76
    v_perm_b32 v47, v95, v91, s76
    v_mfma_f32_16x16x32_bf16 a[212:215], v[40:43], v[32:35], a[212:215]
    v_perm_b32 v48, v71, v67, s77
    v_perm_b32 v49, v79, v75, s77
    v_perm_b32 v50, v87, v83, s77
    v_perm_b32 v51, v95, v91, s77
    v_mfma_f32_16x16x32_bf16 a[216:219], v[44:47], v[32:35], a[216:219]
    s_nop 0
    v_mfma_f32_16x16x32_bf16 a[220:223], v[48:51], v[32:35], a[220:223]
    s_nop 7
.sk_150:
    s_waitcnt vmcnt(46)
    s_lshl_b32 s79, s8, 13
    s_cmp_lt_i32 s8, 0
    s_cselect_b32 s79, 0x7f000000, s79
    s_add_u32 s80, s79, 4096
    buffer_load_dwordx4 v[64:67], v2, s[32:35], s79 offen offset:0 nt
    buffer_load_dwordx4 v[68:71], v2, s[32:35], s79 offen offset:256 nt
    buffer_load_dwordx4 v[72:75], v2, s[32:35], s79 offen offset:2048 nt
    buffer_load_dwordx4 v[76:79], v2, s[32:35], s79 offen offset:2304 nt
    buffer_load_dwordx4 v[80:83], v2, s[32:35], s80 offen offset:0 nt
    buffer_load_dwordx4 v[84:87], v2, s[32:35], s80 offen offset:256 nt
    buffer_load_dwordx4 v[88:91], v2, s[32:35], s80 offen offset:2048 nt
    buffer_load_dwordx4 v[92:95], v2, s[32:35], s80 offen offset:2304 nt
    v_mfma_f32_16x16x32_bf16 v[16:19], a[64:67], a[224:227], 0
    v_mfma_f32_16x16x32_bf16 v[20:23], a[72:75], a[224:227], 0
    v_mfma_f32_16x16x32_bf16 v[24:27], a[80:83], a[224:227], 0
    v_mfma_f32_16x16x32_bf16 v[28:31], a[88:91], a[224:227], 0
    v_mfma_f32_16x16x32_bf16 v[16:19], a[68:71], a[228:231], v[16:19]
    v_mfma_f32_16x16x32_bf16 v[20:23], a[76:79], a[228:231], v[20:23]
    v_mfma_f32_16x16x32_bf16 v[24:27], a[84:87], a[228:231], v[24:27]
    v_mfma_f32_16x16x32_bf16 v[28:31], a[92:95], a[228:231], v[28:31]
    s_add_u32 s14, s17, 5
    s_mov_b32 s9, -1
    s_cmp_eq_u32 s81, 0
    s_cselect_b32 s83, s67, s68
    s_cmp_ge_u32 s14, s83
    s_nop 2
    s_cbranch_scc1 .ed_151
    s_cmp_eq_u32 s81, 0
    s_cselect_b32 s84, s69, 0
    s_sub_u32 s23, 767, s14
    s_mov_b32 s79, s23
    s_add_u32 s23, s23, s84
    s_lshl_b32 s84, s81, 12
.fix_152:
    s_add_u32 s83, s79, s84
    v_cmp_le_i32 vcc, s83, v58
    s_nop 0
    s_bcnt1_i32_b64 s25, vcc
    v_cmp_le_i32 vcc, s83, v59
    s_nop 0
    s_bcnt1_i32_b64 s26, vcc
    s_mov_b32 s24, s79
    s_sub_i32 s79, s23, s25
    s_sub_i32 s79, s79, s26
    s_cmp_lg_u32 s79, s24
    s_cbranch_scc1 .fix_152
    s_lshr_b32 s83, s79, 7
    s_xor_b32 s83, s83, s81
    s_and_b32 s83, s83, 1
    s_lshl_b32 s79, s79, 1
    s_or_b32 s79, s79, s83
    s_mov_b32 s9, s79
    s_bitset1_b32 s27, 7
.ed_151:
    s_waitcnt vmcnt(46)
    s_lshl_b32 s79, s9, 13
    s_cmp_lt_i32 s9, 0
    s_cselect_b32 s79, 0x7f000000, s79
    s_add_u32 s80, s79, 4096
    buffer_load_dwordx4 a[64:67], v1, s[28:31], s79 offen offset:0 nt
    buffer_load_dwordx4 a[68:71], v1, s[28:31], s79 offen offset:128 nt
    buffer_load_dwordx4 a[72:75], v1, s[28:31], s79 offen offset:2048 nt
    buffer_load_dwordx4 a[76:79], v1, s[28:31], s79 offen offset:2176 nt
    buffer_load_dwordx4 a[80:83], v1, s[28:31], s80 offen offset:0 nt
    buffer_load_dwordx4 a[84:87], v1, s[28:31], s80 offen offset:128 nt
    buffer_load_dwordx4 a[88:91], v1, s[28:31], s80 offen offset:2048 nt
    buffer_load_dwordx4 a[92:95], v1, s[28:31], s80 offen offset:2176 nt
    v_add_f32_dpp v8, v17, v16 quad_perm:[1,0,3,2] row_mask:0xf bank_mask:0xf
    v_add_f32_dpp v9, v19, v18 quad_perm:[1,0,3,2] row_mask:0xf bank_mask:0xf
    v_add_f32_dpp v10, v21, v20 quad_perm:[1,0,3,2] row_mask:0xf bank_mask:0xf
    v_add_f32_dpp v11, v23, v22 quad_perm:[1,0,3,2] row_mask:0xf bank_mask:0xf
    v_add_f32_dpp v12, v25, v24 quad_perm:[1,0,3,2] row_mask:0xf bank_mask:0xf
    v_add_f32_dpp v13, v27, v26 quad_perm:[1,0,3,2] row_mask:0xf bank_mask:0xf
    v_add_f32_dpp v14, v29, v28 quad_perm:[1,0,3,2] row_mask:0xf bank_mask:0xf
    v_add_f32_dpp v15, v31, v30 quad_perm:[1,0,3,2] row_mask:0xf bank_mask:0xf
    v_max3_f32 v7, v8, v9, v10
    v_max3_f32 v7, v7, v11, v12
    v_max3_f32 v7, v7, v13, v14
    v_max_f32 v7, v7, v15
    v_cmp_gt_f32 vcc, v7, v4
    s_nop 4
    s_cbranch_vccz .noresc_153
    s_call_b64 s[94:95], .Lresc
.noresc_153:
    v_fma_f32 v8, v8, s75, -v3
    v_fma_f32 v9, v9, s75, -v3
    v_fma_f32 v10, v10, s75, -v3
    v_fma_f32 v11, v11, s75, -v3
    v_fma_f32 v12, v12, s75, -v3
    v_fma_f32 v13, v13, s75, -v3
    v_fma_f32 v14, v14, s75, -v3
    v_fma_f32 v15, v15, s75, -v3
    v_exp_f32 v8, v8
    v_exp_f32 v9, v9
    v_exp_f32 v10, v10
    v_exp_f32 v11, v11
    v_exp_f32 v12, v12
    v_exp_f32 v13, v13
    v_exp_f32 v14, v14
    v_exp_f32 v15, v15
    v_cvt_pk_bf16_f32 v32, v8, v9
    v_cvt_pk_bf16_f32 v33, v10, v11
    v_cvt_pk_bf16_f32 v34, v12, v13
    v_cvt_pk_bf16_f32 v35, v14, v15
    v_add_f32 v8, v8, v9
    v_add_f32 v10, v10, v11
    v_add_f32 v12, v12, v13
    v_add_f32 v14, v14, v15
    v_add_f32 v8, v8, v10
    v_add_f32 v12, v12, v14
    v_add_f32 v5, v5, v8
    v_add_f32 v5, v5, v12
    v_perm_b32 v36, v132, v128, s76
    v_perm_b32 v37, v140, v136, s76
    v_perm_b32 v38, v148, v144, s76
    v_perm_b32 v39, v156, v152, s76
    v_perm_b32 v40, v132, v128, s77
    v_perm_b32 v41, v140, v136, s77
    v_perm_b32 v42, v148, v144, s77
    v_perm_b32 v43, v156, v152, s77
    v_mfma_f32_16x16x32_bf16 a[192:195], v[36:39], v[32:35], a[192:195]
    v_perm_b32 v44, v133, v129, s76
    v_perm_b32 v45, v141, v137, s76
    v_perm_b32 v46, v149, v145, s76
    v_perm_b32 v47, v157, v153, s76
    v_mfma_f32_16x16x32_bf16 a[196:199], v[40:43], v[32:35], a[196:199]
    v_perm_b32 v48, v133, v129, s77
    v_perm_b32 v49, v141, v137, s77
    v_perm_b32 v50, v149, v145, s77
    v_perm_b32 v51, v157, v153, s77
    v_mfma_f32_16x16x32_bf16 a[200:203], v[44:47], v[32:35], a[200:203]
    v_perm_b32 v36, v134, v130, s76
    v_perm_b32 v37, v142, v138, s76
    v_perm_b32 v38, v150, v146, s76
    v_perm_b32 v39, v158, v154, s76
    v_mfma_f32_16x16x32_bf16 a[204:207], v[48:51], v[32:35], a[204:207]
    v_perm_b32 v40, v134, v130, s77
    v_perm_b32 v41, v142, v138, s77
    v_perm_b32 v42, v150, v146, s77
    v_perm_b32 v43, v158, v154, s77
    v_mfma_f32_16x16x32_bf16 a[208:211], v[36:39], v[32:35], a[208:211]
    v_perm_b32 v44, v135, v131, s76
    v_perm_b32 v45, v143, v139, s76
    v_perm_b32 v46, v151, v147, s76
    v_perm_b32 v47, v159, v155, s76
    v_mfma_f32_16x16x32_bf16 a[212:215], v[40:43], v[32:35], a[212:215]
    v_perm_b32 v48, v135, v131, s77
    v_perm_b32 v49, v143, v139, s77
    v_perm_b32 v50, v151, v147, s77
    v_perm_b32 v51, v159, v155, s77
    v_mfma_f32_16x16x32_bf16 a[216:219], v[44:47], v[32:35], a[216:219]
    s_nop 0
    v_mfma_f32_16x16x32_bf16 a[220:223], v[48:51], v[32:35], a[220:223]
    s_waitcnt vmcnt(46)
    s_lshl_b32 s79, s9, 13
    s_cmp_lt_i32 s9, 0
    s_cselect_b32 s79, 0x7f000000, s79
    s_add_u32 s80, s79, 4096
    buffer_load_dwordx4 v[128:131], v2, s[32:35], s79 offen offset:0 nt
    buffer_load_dwordx4 v[132:135], v2, s[32:35], s79 offen offset:256 nt
    buffer_load_dwordx4 v[136:139], v2, s[32:35], s79 offen offset:2048 nt
    buffer_load_dwordx4 v[140:143], v2, s[32:35], s79 offen offset:2304 nt
    buffer_load_dwordx4 v[144:147], v2, s[32:35], s80 offen offset:0 nt
    buffer_load_dwordx4 v[148:151], v2, s[32:35], s80 offen offset:256 nt
    buffer_load_dwordx4 v[152:155], v2, s[32:35], s80 offen offset:2048 nt
    buffer_load_dwordx4 v[156:159], v2, s[32:35], s80 offen offset:2304 nt
    s_bitcmp0_b32 s27, 3
    s_cbranch_scc1 .sk_154
    v_mfma_f32_16x16x32_bf16 v[16:19], a[128:131], a[224:227], 0
    v_mfma_f32_16x16x32_bf16 v[20:23], a[136:139], a[224:227], 0
    v_mfma_f32_16x16x32_bf16 v[24:27], a[144:147], a[224:227], 0
    v_mfma_f32_16x16x32_bf16 v[28:31], a[152:155], a[224:227], 0
    v_mfma_f32_16x16x32_bf16 v[16:19], a[132:135], a[228:231], v[16:19]
    v_mfma_f32_16x16x32_bf16 v[20:23], a[140:143], a[228:231], v[20:23]
    v_mfma_f32_16x16x32_bf16 v[24:27], a[148:151], a[228:231], v[24:27]
    v_mfma_f32_16x16x32_bf16 v[28:31], a[156:159], a[228:231], v[28:31]
    s_nop 7
.sk_154:
    s_bitcmp0_b32 s27, 3
    s_cbranch_scc1 .sk_155
    v_add_f32_dpp v8, v17, v16 quad_perm:[1,0,3,2] row_mask:0xf bank_mask:0xf
    v_add_f32_dpp v9, v19, v18 quad_perm:[1,0,3,2] row_mask:0xf bank_mask:0xf
    v_add_f32_dpp v10, v21, v20 quad_perm:[1,0,3,2] row_mask:0xf bank_mask:0xf
    v_add_f32_dpp v11, v23, v22 quad_perm:[1,0,3,2] row_mask:0xf bank_mask:0xf
    v_add_f32_dpp v12, v25, v24 quad_perm:[1,0,3,2] row_mask:0xf bank_mask:0xf
    v_add_f32_dpp v13, v27, v26 quad_perm:[1,0,3,2] row_mask:0xf bank_mask:0xf
    v_add_f32_dpp v14, v29, v28 quad_perm:[1,0,3,2] row_mask:0xf bank_mask:0xf
    v_add_f32_dpp v15, v31, v30 quad_perm:[1,0,3,2] row_mask:0xf bank_mask:0xf
    v_max3_f32 v7, v8, v9, v10
    v_max3_f32 v7, v7, v11, v12
    v_max3_f32 v7, v7, v13, v14
    v_max_f32 v7, v7, v15
    v_cmp_gt_f32 vcc, v7, v4
    s_nop 4
    s_cbranch_vccz .noresc_156
    s_call_b64 s[94:95], .Lresc
.noresc_156:
    v_fma_f32 v8, v8, s75, -v3
    v_fma_f32 v9, v9, s75, -v3
    v_fma_f32 v10, v10, s75, -v3
    v_fma_f32 v11, v11, s75, -v3
    v_fma_f32 v12, v12, s75, -v3
    v_fma_f32 v13, v13, s75, -v3
    v_fma_f32 v14, v14, s75, -v3
    v_fma_f32 v15, v15, s75, -v3
    v_exp_f32 v8, v8
    v_exp_f32 v9, v9
    v_exp_f32 v10, v10
    v_exp_f32 v11, v11
    v_exp_f32 v12, v12
    v_exp_f32 v13, v13
    v_exp_f32 v14, v14
    v_exp_f32 v15, v15
    v_cvt_pk_bf16_f32 v32, v8, v9
    v_cvt_pk_bf16_f32 v33, v10, v11
    v_cvt_pk_bf16_f32 v34, v12, v13
    v_cvt_pk_bf16_f32 v35, v14, v15
    v_add_f32 v8, v8, v9
    v_add_f32 v10, v10, v11
    v_add_f32 v12, v12, v13
    v_add_f32 v14, v14, v15
    v_add_f32 v8, v8, v10
    v_add_f32 v12, v12, v14
    v_add_f32 v5, v5, v8
    v_add_f32 v5, v5, v12
    s_nop 1
.sk_155:
    s_bitcmp0_b32 s27, 3
    s_cbranch_scc1 .sk_157
    v_perm_b32 v36, v196, v192, s76
    v_perm_b32 v37, v204, v200, s76
    v_perm_b32 v38, v212, v208, s76
    v_perm_b32 v39, v220, v216, s76
    v_perm_b32 v40, v196, v192, s77
    v_perm_b32 v41, v204, v200, s77
    v_perm_b32 v42, v212, v208, s77
    v_perm_b32 v43, v220, v216, s77
    v_mfma_f32_16x16x32_bf16 a[192:195], v[36:39], v[32:35], a[192:195]
    v_perm_b32 v44, v197, v193, s76
    v_perm_b32 v45, v205, v201, s76
    v_perm_b32 v46, v213, v209, s76
    v_perm_b32 v47, v221, v217, s76
    v_mfma_f32_16x16x32_bf16 a[196:199], v[40:43], v[32:35], a[196:199]
    v_perm_b32 v48, v197, v193, s77
    v_perm_b32 v49, v205, v201, s77
    v_perm_b32 v50, v213, v209, s77
    v_perm_b32 v51, v221, v217, s77
    v_mfma_f32_16x16x32_bf16 a[200:203], v[44:47], v[32:35], a[200:203]
    v_perm_b32 v36, v198, v194, s76
    v_perm_b32 v37, v206, v202, s76
    v_perm_b32 v38, v214, v210, s76
    v_perm_b32 v39, v222, v218, s76
    v_mfma_f32_16x16x32_bf16 a[204:207], v[48:51], v[32:35], a[204:207]
    v_perm_b32 v40, v198, v194, s77
    v_perm_b32 v41, v206, v202, s77
    v_perm_b32 v42, v214, v210, s77
    v_perm_b32 v43, v222, v218, s77
    v_mfma_f32_16x16x32_bf16 a[208:211], v[36:39], v[32:35], a[208:211]
    v_perm_b32 v44, v199, v195, s76
    v_perm_b32 v45, v207, v203, s76
    v_perm_b32 v46, v215, v211, s76
    v_perm_b32 v47, v223, v219, s76
    v_mfma_f32_16x16x32_bf16 a[212:215], v[40:43], v[32:35], a[212:215]
    v_perm_b32 v48, v199, v195, s77
    v_perm_b32 v49, v207, v203, s77
    v_perm_b32 v50, v215, v211, s77
    v_perm_b32 v51, v223, v219, s77
    v_mfma_f32_16x16x32_bf16 a[216:219], v[44:47], v[32:35], a[216:219]
    s_nop 0
    v_mfma_f32_16x16x32_bf16 a[220:223], v[48:51], v[32:35], a[220:223]
    s_nop 7
.sk_157:
    s_waitcnt vmcnt(48)
    v_mfma_f32_16x16x32_bf16 v[16:19], a[232:235], a[224:227], 0
    v_mfma_f32_16x16x32_bf16 v[20:23], a[240:243], a[224:227], 0
    v_mfma_f32_16x16x32_bf16 v[24:27], a[248:251], a[224:227], 0
    v_mfma_f32_16x16x32_bf16 v[28:31], a[120:123], a[224:227], 0
    v_mfma_f32_16x16x32_bf16 v[16:19], a[236:239], a[228:231], v[16:19]
    v_mfma_f32_16x16x32_bf16 v[20:23], a[244:247], a[228:231], v[20:23]
    v_mfma_f32_16x16x32_bf16 v[24:27], a[252:255], a[228:231], v[24:27]
    v_mfma_f32_16x16x32_bf16 v[28:31], a[124:127], a[228:231], v[28:31]
    s_nop 4
    v_add_f32_dpp v8, v17, v16 quad_perm:[1,0,3,2] row_mask:0xf bank_mask:0xf
    v_add_f32_dpp v9, v19, v18 quad_perm:[1,0,3,2] row_mask:0xf bank_mask:0xf
    v_add_f32_dpp v10, v21, v20 quad_perm:[1,0,3,2] row_mask:0xf bank_mask:0xf
    v_add_f32_dpp v11, v23, v22 quad_perm:[1,0,3,2] row_mask:0xf bank_mask:0xf
    v_add_f32_dpp v12, v25, v24 quad_perm:[1,0,3,2] row_mask:0xf bank_mask:0xf
    v_add_f32_dpp v13, v27, v26 quad_perm:[1,0,3,2] row_mask:0xf bank_mask:0xf
    v_add_f32_dpp v14, v29, v28 quad_perm:[1,0,3,2] row_mask:0xf bank_mask:0xf
    v_add_f32_dpp v15, v31, v30 quad_perm:[1,0,3,2] row_mask:0xf bank_mask:0xf
    v_max3_f32 v7, v8, v9, v10
    v_max3_f32 v7, v7, v11, v12
    v_max3_f32 v7, v7, v13, v14
    v_max_f32 v7, v7, v15
    v_cmp_gt_f32 vcc, v7, v4
    s_nop 4
    s_cbranch_vccz .noresc_158
    s_call_b64 s[94:95], .Lresc
.noresc_158:
    v_fma_f32 v8, v8, s75, -v3
    v_fma_f32 v9, v9, s75, -v3
    v_fma_f32 v10, v10, s75, -v3
    v_fma_f32 v11, v11, s75, -v3
    v_fma_f32 v12, v12, s75, -v3
    v_fma_f32 v13, v13, s75, -v3
    v_fma_f32 v14, v14, s75, -v3
    v_fma_f32 v15, v15, s75, -v3
    v_exp_f32 v8, v8
    v_exp_f32 v9, v9
    v_exp_f32 v10, v10
    v_exp_f32 v11, v11
    v_exp_f32 v12, v12
    v_exp_f32 v13, v13
    v_exp_f32 v14, v14
    v_exp_f32 v15, v15
    v_cvt_pk_bf16_f32 v32, v8, v9
    v_cvt_pk_bf16_f32 v33, v10, v11
    v_cvt_pk_bf16_f32 v34, v12, v13
    v_cvt_pk_bf16_f32 v35, v14, v15
    v_add_f32 v8, v8, v9
    v_add_f32 v10, v10, v11
    v_add_f32 v12, v12, v13
    v_add_f32 v14, v14, v15
    v_add_f32 v8, v8, v10
    v_add_f32 v12, v12, v14
    v_add_f32 v5, v5, v8
    v_add_f32 v5, v5, v12
    s_waitcnt vmcnt(48)
    s_waitcnt lgkmcnt(0)
    v_perm_b32 v36, v164, v160, s76
    v_perm_b32 v37, v172, v168, s76
    v_perm_b32 v38, v180, v176, s76
    v_perm_b32 v39, v188, v184, s76
    v_perm_b32 v40, v164, v160, s77
    v_perm_b32 v41, v172, v168, s77
    v_perm_b32 v42, v180, v176, s77
    v_perm_b32 v43, v188, v184, s77
    v_mfma_f32_16x16x32_bf16 a[192:195], v[36:39], v[32:35], a[192:195]
    v_perm_b32 v44, v165, v161, s76
    v_perm_b32 v45, v173, v169, s76
    v_perm_b32 v46, v181, v177, s76
    v_perm_b32 v47, v189, v185, s76
    v_mfma_f32_16x16x32_bf16 a[196:199], v[40:43], v[32:35], a[196:199]
    v_perm_b32 v48, v165, v161, s77
    v_perm_b32 v49, v173, v169, s77
    v_perm_b32 v50, v181, v177, s77
    v_perm_b32 v51, v189, v185, s77
    v_mfma_f32_16x16x32_bf16 a[200:203], v[44:47], v[32:35], a[200:203]
    v_perm_b32 v36, v166, v162, s76
    v_perm_b32 v37, v174, v170, s76
    v_perm_b32 v38, v182, v178, s76
    v_perm_b32 v39, v190, v186, s76
    v_mfma_f32_16x16x32_bf16 a[204:207], v[48:51], v[32:35], a[204:207]
    v_perm_b32 v40, v166, v162, s77
    v_perm_b32 v41, v174, v170, s77
    v_perm_b32 v42, v182, v178, s77
    v_perm_b32 v43, v190, v186, s77
    v_mfma_f32_16x16x32_bf16 a[208:211], v[36:39], v[32:35], a[208:211]
    v_perm_b32 v44, v167, v163, s76
    v_perm_b32 v45, v175, v171, s76
    v_perm_b32 v46, v183, v179, s76
    v_perm_b32 v47, v191, v187, s76
    v_mfma_f32_16x16x32_bf16 a[212:215], v[40:43], v[32:35], a[212:215]
    v_perm_b32 v48, v167, v163, s77
    v_perm_b32 v49, v175, v171, s77
    v_perm_b32 v50, v183, v179, s77
    v_perm_b32 v51, v191, v187, s77
    v_mfma_f32_16x16x32_bf16 a[216:219], v[44:47], v[32:35], a[216:219]
    s_nop 0
    v_mfma_f32_16x16x32_bf16 a[220:223], v[48:51], v[32:35], a[220:223]
    s_waitcnt vmcnt(24)
    s_bitcmp0_b32 s27, 6
    s_nop 5
    s_cbranch_scc1 .sk_159
    v_mfma_f32_16x16x32_bf16 v[16:19], a[0:3], a[224:227], 0
    v_mfma_f32_16x16x32_bf16 v[20:23], a[8:11], a[224:227], 0
    v_mfma_f32_16x16x32_bf16 v[24:27], a[16:19], a[224:227], 0
    v_mfma_f32_16x16x32_bf16 v[28:31], a[24:27], a[224:227], 0
    v_mfma_f32_16x16x32_bf16 v[16:19], a[4:7], a[228:231], v[16:19]
    v_mfma_f32_16x16x32_bf16 v[20:23], a[12:15], a[228:231], v[20:23]
    v_mfma_f32_16x16x32_bf16 v[24:27], a[20:23], a[228:231], v[24:27]
    v_mfma_f32_16x16x32_bf16 v[28:31], a[28:31], a[228:231], v[28:31]
    s_nop 7
.sk_159:
    s_lshl_b32 s83, s66, 4
    s_lshl_b32 s83, 1, s83
    v_mov_b32 v61, s83
    s_mov_b64 exec, 1
    buffer_atomic_add v61, off, s[36:39], s82 sc0 sc1
    s_mov_b64 exec, -1
    s_add_u32 s79, s78, 0x380000
    s_add_u32 s80, s79, 4096
    buffer_load_dwordx4 a[0:3], v1, s[28:31], s79 offen offset:0 nt
    buffer_load_dwordx4 a[4:7], v1, s[28:31], s79 offen offset:128 nt
    buffer_load_dwordx4 a[8:11], v1, s[28:31], s79 offen offset:2048 nt
    buffer_load_dwordx4 a[12:15], v1, s[28:31], s79 offen offset:2176 nt
    buffer_load_dwordx4 a[16:19], v1, s[28:31], s80 offen offset:0 nt
    buffer_load_dwordx4 a[20:23], v1, s[28:31], s80 offen offset:128 nt
    buffer_load_dwordx4 a[24:27], v1, s[28:31], s80 offen offset:2048 nt
    buffer_load_dwordx4 a[28:31], v1, s[28:31], s80 offen offset:2176 nt
    s_bitcmp0_b32 s27, 6
    s_cbranch_scc1 .sk_160
    v_add_f32_dpp v8, v17, v16 quad_perm:[1,0,3,2] row_mask:0xf bank_mask:0xf
    v_add_f32_dpp v9, v19, v18 quad_perm:[1,0,3,2] row_mask:0xf bank_mask:0xf
    v_add_f32_dpp v10, v21, v20 quad_perm:[1,0,3,2] row_mask:0xf bank_mask:0xf
    v_add_f32_dpp v11, v23, v22 quad_perm:[1,0,3,2] row_mask:0xf bank_mask:0xf
    v_add_f32_dpp v12, v25, v24 quad_perm:[1,0,3,2] row_mask:0xf bank_mask:0xf
    v_add_f32_dpp v13, v27, v26 quad_perm:[1,0,3,2] row_mask:0xf bank_mask:0xf
    v_add_f32_dpp v14, v29, v28 quad_perm:[1,0,3,2] row_mask:0xf bank_mask:0xf
    v_add_f32_dpp v15, v31, v30 quad_perm:[1,0,3,2] row_mask:0xf bank_mask:0xf
    v_max3_f32 v7, v8, v9, v10
    v_max3_f32 v7, v7, v11, v12
    v_max3_f32 v7, v7, v13, v14
    v_max_f32 v7, v7, v15
    v_cmp_gt_f32 vcc, v7, v4
    s_nop 4
    s_cbranch_vccz .noresc_161
    s_call_b64 s[94:95], .Lresc
.noresc_161:
    v_fma_f32 v8, v8, s75, -v3
    v_fma_f32 v9, v9, s75, -v3
    v_fma_f32 v10, v10, s75, -v3
    v_fma_f32 v11, v11, s75, -v3
    v_fma_f32 v12, v12, s75, -v3
    v_fma_f32 v13, v13, s75, -v3
    v_fma_f32 v14, v14, s75, -v3
    v_fma_f32 v15, v15, s75, -v3
    v_exp_f32 v8, v8
    v_exp_f32 v9, v9
    v_exp_f32 v10, v10
    v_exp_f32 v11, v11
    v_exp_f32 v12, v12
    v_exp_f32 v13, v13
    v_exp_f32 v14, v14
    v_exp_f32 v15, v15
    v_cvt_pk_bf16_f32 v32, v8, v9
    v_cvt_pk_bf16_f32 v33, v10, v11
    v_cvt_pk_bf16_f32 v34, v12, v13
    v_cvt_pk_bf16_f32 v35, v14, v15
    v_add_f32 v8, v8, v9
    v_add_f32 v10, v10, v11
    v_add_f32 v12, v12, v13
    v_add_f32 v14, v14, v15
    v_add_f32 v8, v8, v10
    v_add_f32 v12, v12, v14
    v_add_f32 v5, v5, v8
    v_add_f32 v5, v5, v12
    s_nop 1
.sk_160:
    s_waitcnt vmcnt(25)
    s_bitcmp0_b32 s27, 6
    s_cbranch_scc1 .sk_162
    v_perm_b32 v36, v68, v64, s76
    v_perm_b32 v37, v76, v72, s76
    v_perm_b32 v38, v84, v80, s76
    v_perm_b32 v39, v92, v88, s76
    v_perm_b32 v40, v68, v64, s77
    v_perm_b32 v41, v76, v72, s77
    v_perm_b32 v42, v84, v80, s77
    v_perm_b32 v43, v92, v88, s77
    v_mfma_f32_16x16x32_bf16 a[192:195], v[36:39], v[32:35], a[192:195]
    v_perm_b32 v44, v69, v65, s76
    v_perm_b32 v45, v77, v73, s76
    v_perm_b32 v46, v85, v81, s76
    v_perm_b32 v47, v93, v89, s76
    v_mfma_f32_16x16x32_bf16 a[196:199], v[40:43], v[32:35], a[196:199]
    v_perm_b32 v48, v69, v65, s77
    v_perm_b32 v49, v77, v73, s77
    v_perm_b32 v50, v85, v81, s77
    v_perm_b32 v51, v93, v89, s77
    v_mfma_f32_16x16x32_bf16 a[200:203], v[44:47], v[32:35], a[200:203]
    v_perm_b32 v36, v70, v66, s76
    v_perm_b32 v37, v78, v74, s76
    v_perm_b32 v38, v86, v82, s76
    v_perm_b32 v39, v94, v90, s76
    v_mfma_f32_16x16x32_bf16 a[204:207], v[48:51], v[32:35], a[204:207]
    v_perm_b32 v40, v70, v66, s77
    v_perm_b32 v41, v78, v74, s77
    v_perm_b32 v42, v86, v82, s77
    v_perm_b32 v43, v94, v90, s77
    v_mfma_f32_16x16x32_bf16 a[208:211], v[36:39], v[32:35], a[208:211]
    v_perm_b32 v44, v71, v67, s76
    v_perm_b32 v45, v79, v75, s76
    v_perm_b32 v46, v87, v83, s76
    v_perm_b32 v47, v95, v91, s76
    v_mfma_f32_16x16x32_bf16 a[212:215], v[40:43], v[32:35], a[212:215]
    v_perm_b32 v48, v71, v67, s77
    v_perm_b32 v49, v79, v75, s77
    v_perm_b32 v50, v87, v83, s77
    v_perm_b32 v51, v95, v91, s77
    v_mfma_f32_16x16x32_bf16 a[216:219], v[44:47], v[32:35], a[216:219]
    s_nop 0
    v_mfma_f32_16x16x32_bf16 a[220:223], v[48:51], v[32:35], a[220:223]
    s_nop 7
.sk_162:
    s_add_u32 s79, s78, 0x380000
    s_add_u32 s80, s79, 4096
    buffer_load_dwordx4 v[64:67], v2, s[32:35], s79 offen offset:0 nt
    buffer_load_dwordx4 v[68:71], v2, s[32:35], s79 offen offset:256 nt
    buffer_load_dwordx4 v[72:75], v2, s[32:35], s79 offen offset:2048 nt
    buffer_load_dwordx4 v[76:79], v2, s[32:35], s79 offen offset:2304 nt
    buffer_load_dwordx4 v[80:83], v2, s[32:35], s80 offen offset:0 nt
    buffer_load_dwordx4 v[84:87], v2, s[32:35], s80 offen offset:256 nt
    buffer_load_dwordx4 v[88:91], v2, s[32:35], s80 offen offset:2048 nt
    buffer_load_dwordx4 v[92:95], v2, s[32:35], s80 offen offset:2304 nt
    s_bitcmp0_b32 s27, 4
    s_cbranch_scc1 .sk_163
    v_mfma_f32_16x16x32_bf16 v[16:19], a[160:163], a[224:227], 0
    v_mfma_f32_16x16x32_bf16 v[20:23], a[168:171], a[224:227], 0
    v_mfma_f32_16x16x32_bf16 v[24:27], a[176:179], a[224:227], 0
    v_mfma_f32_16x16x32_bf16 v[28:31], a[184:187], a[224:227], 0
    v_mfma_f32_16x16x32_bf16 v[16:19], a[164:167], a[228:231], v[16:19]
    v_mfma_f32_16x16x32_bf16 v[20:23], a[172:175], a[228:231], v[20:23]
    v_mfma_f32_16x16x32_bf16 v[24:27], a[180:183], a[228:231], v[24:27]
    v_mfma_f32_16x16x32_bf16 v[28:31], a[188:191], a[228:231], v[28:31]
    s_nop 7
.sk_163:
    s_bitcmp0_b32 s27, 4
    s_cbranch_scc1 .sk_164
    v_add_f32_dpp v8, v17, v16 quad_perm:[1,0,3,2] row_mask:0xf bank_mask:0xf
    v_add_f32_dpp v9, v19, v18 quad_perm:[1,0,3,2] row_mask:0xf bank_mask:0xf
    v_add_f32_dpp v10, v21, v20 quad_perm:[1,0,3,2] row_mask:0xf bank_mask:0xf
    v_add_f32_dpp v11, v23, v22 quad_perm:[1,0,3,2] row_mask:0xf bank_mask:0xf
    v_add_f32_dpp v12, v25, v24 quad_perm:[1,0,3,2] row_mask:0xf bank_mask:0xf
    v_add_f32_dpp v13, v27, v26 quad_perm:[1,0,3,2] row_mask:0xf bank_mask:0xf
    v_add_f32_dpp v14, v29, v28 quad_perm:[1,0,3,2] row_mask:0xf bank_mask:0xf
    v_add_f32_dpp v15, v31, v30 quad_perm:[1,0,3,2] row_mask:0xf bank_mask:0xf
    v_max3_f32 v7, v8, v9, v10
    v_max3_f32 v7, v7, v11, v12
    v_max3_f32 v7, v7, v13, v14
    v_max_f32 v7, v7, v15
    v_cmp_gt_f32 vcc, v7, v4
    s_nop 4
    s_cbranch_vccz .noresc_165
    s_call_b64 s[94:95], .Lresc
.noresc_165:
    v_fma_f32 v8, v8, s75, -v3
    v_fma_f32 v9, v9, s75, -v3
    v_fma_f32 v10, v10, s75, -v3
    v_fma_f32 v11, v11, s75, -v3
    v_fma_f32 v12, v12, s75, -v3
    v_fma_f32 v13, v13, s75, -v3
    v_fma_f32 v14, v14, s75, -v3
    v_fma_f32 v15, v15, s75, -v3
    v_exp_f32 v8, v8
    v_exp_f32 v9, v9
    v_exp_f32 v10, v10
    v_exp_f32 v11, v11
    v_exp_f32 v12, v12
    v_exp_f32 v13, v13
    v_exp_f32 v14, v14
    v_exp_f32 v15, v15
    v_cvt_pk_bf16_f32 v32, v8, v9
    v_cvt_pk_bf16_f32 v33, v10, v11
    v_cvt_pk_bf16_f32 v34, v12, v13
    v_cvt_pk_bf16_f32 v35, v14, v15
    v_add_f32 v8, v8, v9
    v_add_f32 v10, v10, v11
    v_add_f32 v12, v12, v13
    v_add_f32 v14, v14, v15
    v_add_f32 v8, v8, v10
    v_add_f32 v12, v12, v14
    v_add_f32 v5, v5, v8
    v_add_f32 v5, v5, v12
    s_nop 1
.sk_164:
    s_bitcmp0_b32 s27, 4
    s_cbranch_scc1 .sk_166
    v_perm_b32 v36, v228, v224, s76
    v_perm_b32 v37, v236, v232, s76
    v_perm_b32 v38, v244, v240, s76
    v_perm_b32 v39, v252, v248, s76
    v_perm_b32 v40, v228, v224, s77
    v_perm_b32 v41, v236, v232, s77
    v_perm_b32 v42, v244, v240, s77
    v_perm_b32 v43, v252, v248, s77
    v_mfma_f32_16x16x32_bf16 a[192:195], v[36:39], v[32:35], a[192:195]
    v_perm_b32 v44, v229, v225, s76
    v_perm_b32 v45, v237, v233, s76
    v_perm_b32 v46, v245, v241, s76
    v_perm_b32 v47, v253, v249, s76
    v_mfma_f32_16x16x32_bf16 a[196:199], v[40:43], v[32:35], a[196:199]
    v_perm_b32 v48, v229, v225, s77
    v_perm_b32 v49, v237, v233, s77
    v_perm_b32 v50, v245, v241, s77
    v_perm_b32 v51, v253, v249, s77
    v_mfma_f32_16x16x32_bf16 a[200:203], v[44:47], v[32:35], a[200:203]
    v_perm_b32 v36, v230, v226, s76
    v_perm_b32 v37, v238, v234, s76
    v_perm_b32 v38, v246, v242, s76
    v_perm_b32 v39, v254, v250, s76
    v_mfma_f32_16x16x32_bf16 a[204:207], v[48:51], v[32:35], a[204:207]
    v_perm_b32 v40, v230, v226, s77
    v_perm_b32 v41, v238, v234, s77
    v_perm_b32 v42, v246, v242, s77
    v_perm_b32 v43, v254, v250, s77
    v_mfma_f32_16x16x32_bf16 a[208:211], v[36:39], v[32:35], a[208:211]
    v_perm_b32 v44, v231, v227, s76
    v_perm_b32 v45, v239, v235, s76
    v_perm_b32 v46, v247, v243, s76
    v_perm_b32 v47, v255, v251, s76
    v_mfma_f32_16x16x32_bf16 a[212:215], v[40:43], v[32:35], a[212:215]
    v_perm_b32 v48, v231, v227, s77
    v_perm_b32 v49, v239, v235, s77
    v_perm_b32 v50, v247, v243, s77
    v_perm_b32 v51, v255, v251, s77
    v_mfma_f32_16x16x32_bf16 a[216:219], v[44:47], v[32:35], a[216:219]
    s_nop 0
    v_mfma_f32_16x16x32_bf16 a[220:223], v[48:51], v[32:35], a[220:223]
    s_nop 7
.sk_166:
    s_bitcmp0_b32 s27, 5
    s_cbranch_scc1 .sk_167
    v_mfma_f32_16x16x32_bf16 v[16:19], a[32:35], a[224:227], 0
    v_mfma_f32_16x16x32_bf16 v[20:23], a[40:43], a[224:227], 0
    v_mfma_f32_16x16x32_bf16 v[24:27], a[48:51], a[224:227], 0
    v_mfma_f32_16x16x32_bf16 v[28:31], a[56:59], a[224:227], 0
    v_mfma_f32_16x16x32_bf16 v[16:19], a[36:39], a[228:231], v[16:19]
    v_mfma_f32_16x16x32_bf16 v[20:23], a[44:47], a[228:231], v[20:23]
    v_mfma_f32_16x16x32_bf16 v[24:27], a[52:55], a[228:231], v[24:27]
    v_mfma_f32_16x16x32_bf16 v[28:31], a[60:63], a[228:231], v[28:31]
    s_nop 7
.sk_167:
    s_bitcmp0_b32 s27, 5
    s_cbranch_scc1 .sk_168
    v_add_f32_dpp v8, v17, v16 quad_perm:[1,0,3,2] row_mask:0xf bank_mask:0xf
    v_add_f32_dpp v9, v19, v18 quad_perm:[1,0,3,2] row_mask:0xf bank_mask:0xf
    v_add_f32_dpp v10, v21, v20 quad_perm:[1,0,3,2] row_mask:0xf bank_mask:0xf
    v_add_f32_dpp v11, v23, v22 quad_perm:[1,0,3,2] row_mask:0xf bank_mask:0xf
    v_add_f32_dpp v12, v25, v24 quad_perm:[1,0,3,2] row_mask:0xf bank_mask:0xf
    v_add_f32_dpp v13, v27, v26 quad_perm:[1,0,3,2] row_mask:0xf bank_mask:0xf
    v_add_f32_dpp v14, v29, v28 quad_perm:[1,0,3,2] row_mask:0xf bank_mask:0xf
    v_add_f32_dpp v15, v31, v30 quad_perm:[1,0,3,2] row_mask:0xf bank_mask:0xf
    v_max3_f32 v7, v8, v9, v10
    v_max3_f32 v7, v7, v11, v12
    v_max3_f32 v7, v7, v13, v14
    v_max_f32 v7, v7, v15
    v_cmp_gt_f32 vcc, v7, v4
    s_nop 4
    s_cbranch_vccz .noresc_169
    s_call_b64 s[94:95], .Lresc
.noresc_169:
    v_fma_f32 v8, v8, s75, -v3
    v_fma_f32 v9, v9, s75, -v3
    v_fma_f32 v10, v10, s75, -v3
    v_fma_f32 v11, v11, s75, -v3
    v_fma_f32 v12, v12, s75, -v3
    v_fma_f32 v13, v13, s75, -v3
    v_fma_f32 v14, v14, s75, -v3
    v_fma_f32 v15, v15, s75, -v3
    v_exp_f32 v8, v8
    v_exp_f32 v9, v9
    v_exp_f32 v10, v10
    v_exp_f32 v11, v11
    v_exp_f32 v12, v12
    v_exp_f32 v13, v13
    v_exp_f32 v14, v14
    v_exp_f32 v15, v15
    v_cvt_pk_bf16_f32 v32, v8, v9
    v_cvt_pk_bf16_f32 v33, v10, v11
    v_cvt_pk_bf16_f32 v34, v12, v13
    v_cvt_pk_bf16_f32 v35, v14, v15
    v_add_f32 v8, v8, v9
    v_add_f32 v10, v10, v11
    v_add_f32 v12, v12, v13
    v_add_f32 v14, v14, v15
    v_add_f32 v8, v8, v10
    v_add_f32 v12, v12, v14
    v_add_f32 v5, v5, v8
    v_add_f32 v5, v5, v12
    s_nop 1
.sk_168:
    s_bitcmp0_b32 s27, 5
    s_cbranch_scc1 .sk_170
    v_perm_b32 v36, v100, v96, s76
    v_perm_b32 v37, v108, v104, s76
    v_perm_b32 v38, v116, v112, s76
    v_perm_b32 v39, v124, v120, s76
    v_perm_b32 v40, v100, v96, s77
    v_perm_b32 v41, v108, v104, s77
    v_perm_b32 v42, v116, v112, s77
    v_perm_b32 v43, v124, v120, s77
    v_mfma_f32_16x16x32_bf16 a[192:195], v[36:39], v[32:35], a[192:195]
    v_perm_b32 v44, v101, v97, s76
    v_perm_b32 v45, v109, v105, s76
    v_perm_b32 v46, v117, v113, s76
    v_perm_b32 v47, v125, v121, s76
    v_mfma_f32_16x16x32_bf16 a[196:199], v[40:43], v[32:35], a[196:199]
    v_perm_b32 v48, v101, v97, s77
    v_perm_b32 v49, v109, v105, s77
    v_perm_b32 v50, v117, v113, s77
    v_perm_b32 v51, v125, v121, s77
    v_mfma_f32_16x16x32_bf16 a[200:203], v[44:47], v[32:35], a[200:203]
    v_perm_b32 v36, v102, v98, s76
    v_perm_b32 v37, v110, v106, s76
    v_perm_b32 v38, v118, v114, s76
    v_perm_b32 v39, v126, v122, s76
    v_mfma_f32_16x16x32_bf16 a[204:207], v[48:51], v[32:35], a[204:207]
    v_perm_b32 v40, v102, v98, s77
    v_perm_b32 v41, v110, v106, s77
    v_perm_b32 v42, v118, v114, s77
    v_perm_b32 v43, v126, v122, s77
    v_mfma_f32_16x16x32_bf16 a[208:211], v[36:39], v[32:35], a[208:211]
    v_perm_b32 v44, v103, v99, s76
    v_perm_b32 v45, v111, v107, s76
    v_perm_b32 v46, v119, v115, s76
    v_perm_b32 v47, v127, v123, s76
    v_mfma_f32_16x16x32_bf16 a[212:215], v[40:43], v[32:35], a[212:215]
    v_perm_b32 v48, v103, v99, s77
    v_perm_b32 v49, v111, v107, s77
    v_perm_b32 v50, v119, v115, s77
    v_perm_b32 v51, v127, v123, s77
    v_mfma_f32_16x16x32_bf16 a[216:219], v[44:47], v[32:35], a[216:219]
    s_nop 0
    v_mfma_f32_16x16x32_bf16 a[220:223], v[48:51], v[32:35], a[220:223]
    s_nop 7
.sk_170:
    s_waitcnt vmcnt(25)
    s_bitcmp0_b32 s27, 7
    s_cbranch_scc1 .sk_171
    v_mfma_f32_16x16x32_bf16 v[16:19], a[64:67], a[224:227], 0
    v_mfma_f32_16x16x32_bf16 v[20:23], a[72:75], a[224:227], 0
    v_mfma_f32_16x16x32_bf16 v[24:27], a[80:83], a[224:227], 0
    v_mfma_f32_16x16x32_bf16 v[28:31], a[88:91], a[224:227], 0
    v_mfma_f32_16x16x32_bf16 v[16:19], a[68:71], a[228:231], v[16:19]
    v_mfma_f32_16x16x32_bf16 v[20:23], a[76:79], a[228:231], v[20:23]
    v_mfma_f32_16x16x32_bf16 v[24:27], a[84:87], a[228:231], v[24:27]
    v_mfma_f32_16x16x32_bf16 v[28:31], a[92:95], a[228:231], v[28:31]
    s_nop 7
.sk_171:
    s_bitcmp0_b32 s27, 7
    s_cbranch_scc1 .sk_172
    v_add_f32_dpp v8, v17, v16 quad_perm:[1,0,3,2] row_mask:0xf bank_mask:0xf
    v_add_f32_dpp v9, v19, v18 quad_perm:[1,0,3,2] row_mask:0xf bank_mask:0xf
    v_add_f32_dpp v10, v21, v20 quad_perm:[1,0,3,2] row_mask:0xf bank_mask:0xf
    v_add_f32_dpp v11, v23, v22 quad_perm:[1,0,3,2] row_mask:0xf bank_mask:0xf
    v_add_f32_dpp v12, v25, v24 quad_perm:[1,0,3,2] row_mask:0xf bank_mask:0xf
    v_add_f32_dpp v13, v27, v26 quad_perm:[1,0,3,2] row_mask:0xf bank_mask:0xf
    v_add_f32_dpp v14, v29, v28 quad_perm:[1,0,3,2] row_mask:0xf bank_mask:0xf
    v_add_f32_dpp v15, v31, v30 quad_perm:[1,0,3,2] row_mask:0xf bank_mask:0xf
    v_max3_f32 v7, v8, v9, v10
    v_max3_f32 v7, v7, v11, v12
    v_max3_f32 v7, v7, v13, v14
    v_max_f32 v7, v7, v15
    v_cmp_gt_f32 vcc, v7, v4
    s_nop 4
    s_cbranch_vccz .noresc_173
    s_call_b64 s[94:95], .Lresc
.noresc_173:
    v_fma_f32 v8, v8, s75, -v3
    v_fma_f32 v9, v9, s75, -v3
    v_fma_f32 v10, v10, s75, -v3
    v_fma_f32 v11, v11, s75, -v3
    v_fma_f32 v12, v12, s75, -v3
    v_fma_f32 v13, v13, s75, -v3
    v_fma_f32 v14, v14, s75, -v3
    v_fma_f32 v15, v15, s75, -v3
    v_exp_f32 v8, v8
    v_exp_f32 v9, v9
    v_exp_f32 v10, v10
    v_exp_f32 v11, v11
    v_exp_f32 v12, v12
    v_exp_f32 v13, v13
    v_exp_f32 v14, v14
    v_exp_f32 v15, v15
    v_cvt_pk_bf16_f32 v32, v8, v9
    v_cvt_pk_bf16_f32 v33, v10, v11
    v_cvt_pk_bf16_f32 v34, v12, v13
    v_cvt_pk_bf16_f32 v35, v14, v15
    v_add_f32 v8, v8, v9
    v_add_f32 v10, v10, v11
    v_add_f32 v12, v12, v13
    v_add_f32 v14, v14, v15
    v_add_f32 v8, v8, v10
    v_add_f32 v12, v12, v14
    v_add_f32 v5, v5, v8
    v_add_f32 v5, v5, v12
    s_nop 1
.sk_172:
    s_waitcnt vmcnt(17)
    s_bitcmp0_b32 s27, 7
    s_cbranch_scc1 .sk_174
    v_perm_b32 v36, v132, v128, s76
    v_perm_b32 v37, v140, v136, s76
    v_perm_b32 v38, v148, v144, s76
    v_perm_b32 v39, v156, v152, s76
    v_perm_b32 v40, v132, v128, s77
    v_perm_b32 v41, v140, v136, s77
    v_perm_b32 v42, v148, v144, s77
    v_perm_b32 v43, v156, v152, s77
    v_mfma_f32_16x16x32_bf16 a[192:195], v[36:39], v[32:35], a[192:195]
    v_perm_b32 v44, v133, v129, s76
    v_perm_b32 v45, v141, v137, s76
    v_perm_b32 v46, v149, v145, s76
    v_perm_b32 v47, v157, v153, s76
    v_mfma_f32_16x16x32_bf16 a[196:199], v[40:43], v[32:35], a[196:199]
    v_perm_b32 v48, v133, v129, s77
    v_perm_b32 v49, v141, v137, s77
    v_perm_b32 v50, v149, v145, s77
    v_perm_b32 v51, v157, v153, s77
    v_mfma_f32_16x16x32_bf16 a[200:203], v[44:47], v[32:35], a[200:203]
    v_perm_b32 v36, v134, v130, s76
    v_perm_b32 v37, v142, v138, s76
    v_perm_b32 v38, v150, v146, s76
    v_perm_b32 v39, v158, v154, s76
    v_mfma_f32_16x16x32_bf16 a[204:207], v[48:51], v[32:35], a[204:207]
    v_perm_b32 v40, v134, v130, s77
    v_perm_b32 v41, v142, v138, s77
    v_perm_b32 v42, v150, v146, s77
    v_perm_b32 v43, v158, v154, s77
    v_mfma_f32_16x16x32_bf16 a[208:211], v[36:39], v[32:35], a[208:211]
    v_perm_b32 v44, v135, v131, s76
    v_perm_b32 v45, v143, v139, s76
    v_perm_b32 v46, v151, v147, s76
    v_perm_b32 v47, v159, v155, s76
    v_mfma_f32_16x16x32_bf16 a[212:215], v[40:43], v[32:35], a[212:215]
    v_perm_b32 v48, v135, v131, s77
    v_perm_b32 v49, v143, v139, s77
    v_perm_b32 v50, v151, v147, s77
    v_perm_b32 v51, v159, v155, s77
    v_mfma_f32_16x16x32_bf16 a[216:219], v[44:47], v[32:35], a[216:219]
    s_nop 0
    v_mfma_f32_16x16x32_bf16 a[220:223], v[48:51], v[32:35], a[220:223]
    s_nop 7
.sk_174:
    s_bitcmp1_b32 s27, 1
    s_cbranch_scc1 .attn_176
.b0skip_177:
    s_waitcnt vmcnt(0)
    v_readfirstlane_b32 s79, v61
    s_nop 0
    s_add_u32 s79, s79, 1
    s_and_b32 s71, s79, 0xffff
    s_lshr_b32 s74, s79, 16
    s_cmp_eq_u32 s66, 0
    s_cselect_b32 s23, s71, s74
    s_cselect_b32 s83, s67, s68
    s_cselect_b32 s84, s69, 0
    s_cmp_ge_u32 s23, s83
    s_cbranch_scc1 .rb_179
    s_sub_u32 s23, 767, s23
    s_mov_b32 s79, s23
    s_add_u32 s23, s23, s84
    s_lshl_b32 s84, s66, 12
.fix_181:
    s_add_u32 s83, s79, s84
    v_cmp_le_i32 vcc, s83, v58
    s_nop 0
    s_bcnt1_i32_b64 s25, vcc
    v_cmp_le_i32 vcc, s83, v59
    s_nop 0
    s_bcnt1_i32_b64 s26, vcc
    s_mov_b32 s24, s79
    s_sub_i32 s79, s23, s25
    s_sub_i32 s79, s79, s26
    s_cmp_lg_u32 s79, s24
    s_cbranch_scc1 .fix_181
    s_lshr_b32 s83, s79, 7
    s_xor_b32 s83, s83, s66
    s_and_b32 s83, s83, 1
    s_lshl_b32 s79, s79, 1
    s_or_b32 s79, s79, s83
    s_sub_i32 s83, s71, s74
    s_mul_i32 s83, s83, s70
    s_cmp_gt_i32 s83, 128
    s_cselect_b32 s83, 1, 0
    s_xor_b32 s66, s81, s83
    s_cmp_eq_u32 s66, 0
    s_cselect_b32 s83, s71, s74
    s_cselect_b32 s84, s67, s68
    s_add_u32 s83, s83, 1
    s_cmp_ge_u32 s83, s84
    s_cselect_b32 s83, 1, 0
    s_xor_b32 s66, s66, s83
    s_branch .rok_180
.rb_179:
    s_cmp_eq_u32 s66, 0
    s_cselect_b32 s83, s74, s71
    s_cselect_b32 s84, s68, s67
    s_cmp_ge_u32 s83, s84
    s_cbranch_scc1 .tail2_178
    s_xor_b32 s66, s66, 1
    s_lshl_b32 s83, s66, 4
    s_lshl_b32 s83, 1, s83
    v_mov_b32 v61, s83
    s_mov_b64 exec, 1
    buffer_atomic_add v61, off, s[36:39], s82 sc0 sc1
    s_mov_b64 exec, -1
    s_branch .b0skip_177
.rok_180:
    s_lshl_b32 s79, s79, 13
    s_add_u32 s80, s79, 4096
    s_lshl_b32 s83, s66, 4
    s_lshl_b32 s83, 1, s83
    v_mov_b32 v61, s83
    s_mov_b64 exec, 1
    buffer_atomic_add v61, off, s[36:39], s82 sc0 sc1
    s_mov_b64 exec, -1
    buffer_load_dwordx4 a[0:3], v1, s[28:31], s79 offen offset:0 nt
    buffer_load_dwordx4 a[4:7], v1, s[28:31], s79 offen offset:128 nt
    buffer_load_dwordx4 a[8:11], v1, s[28:31], s79 offen offset:2048 nt
    buffer_load_dwordx4 a[12:15], v1, s[28:31], s79 offen offset:2176 nt
    buffer_load_dwordx4 a[16:19], v1, s[28:31], s80 offen offset:0 nt
    buffer_load_dwordx4 a[20:23], v1, s[28:31], s80 offen offset:128 nt
    buffer_load_dwordx4 a[24:27], v1, s[28:31], s80 offen offset:2048 nt
    buffer_load_dwordx4 a[28:31], v1, s[28:31], s80 offen offset:2176 nt
    buffer_load_dwordx4 v[64:67], v2, s[32:35], s79 offen offset:0 nt
    buffer_load_dwordx4 v[68:71], v2, s[32:35], s79 offen offset:256 nt
    buffer_load_dwordx4 v[72:75], v2, s[32:35], s79 offen offset:2048 nt
    buffer_load_dwordx4 v[76:79], v2, s[32:35], s79 offen offset:2304 nt
    buffer_load_dwordx4 v[80:83], v2, s[32:35], s80 offen offset:0 nt
    buffer_load_dwordx4 v[84:87], v2, s[32:35], s80 offen offset:256 nt
    buffer_load_dwordx4 v[88:91], v2, s[32:35], s80 offen offset:2048 nt
    buffer_load_dwordx4 v[92:95], v2, s[32:35], s80 offen offset:2304 nt
.attn_176:
    s_waitcnt vmcnt(8)
    v_readfirstlane_b32 s79, v61
    v_mfma_f32_16x16x32_bf16 v[16:19], a[0:3], a[224:227], 0
    v_mfma_f32_16x16x32_bf16 v[20:23], a[8:11], a[224:227], 0
    v_mfma_f32_16x16x32_bf16 v[24:27], a[16:19], a[224:227], 0
    v_mfma_f32_16x16x32_bf16 v[28:31], a[24:27], a[224:227], 0
    v_mfma_f32_16x16x32_bf16 v[16:19], a[4:7], a[228:231], v[16:19]
    v_mfma_f32_16x16x32_bf16 v[20:23], a[12:15], a[228:231], v[20:23]
    v_mfma_f32_16x16x32_bf16 v[24:27], a[20:23], a[228:231], v[24:27]
    v_mfma_f32_16x16x32_bf16 v[28:31], a[28:31], a[228:231], v[28:31]
    s_add_u32 s79, s79, 1
    s_and_b32 s71, s79, 0xffff
    s_lshr_b32 s74, s79, 16
    s_cmp_eq_u32 s66, 0
    s_cselect_b32 s23, s71, s74
    s_cselect_b32 s83, s67, s68
    s_cselect_b32 s84, s69, 0
    s_cmp_ge_u32 s23, s83
    s_cbranch_scc1 .tail_175
    s_sub_u32 s23, 767, s23
    s_mov_b32 s79, s23
    s_add_u32 s23, s23, s84
    s_lshl_b32 s84, s66, 12
.fix_182:
    s_add_u32 s83, s79, s84
    v_cmp_le_i32 vcc, s83, v58
    s_nop 0
    s_bcnt1_i32_b64 s25, vcc
    v_cmp_le_i32 vcc, s83, v59
    s_nop 0
    s_bcnt1_i32_b64 s26, vcc
    s_mov_b32 s24, s79
    s_sub_i32 s79, s23, s25
    s_sub_i32 s79, s79, s26
    s_cmp_lg_u32 s79, s24
    s_cbranch_scc1 .fix_182
    s_lshr_b32 s83, s79, 7
    s_xor_b32 s83, s83, s66
    s_and_b32 s83, s83, 1
    s_lshl_b32 s79, s79, 1
    s_or_b32 s79, s79, s83
    s_sub_i32 s83, s71, s74
    s_mul_i32 s83, s83, s70
    s_cmp_gt_i32 s83, 128
    s_cselect_b32 s83, 1, 0
    s_xor_b32 s66, s81, s83
    s_cmp_eq_u32 s66, 0
    s_cselect_b32 s83, s71, s74
    s_cselect_b32 s84, s67, s68
    s_add_u32 s83, s83, 1
    s_cmp_ge_u32 s83, s84
    s_cselect_b32 s83, 1, 0
    s_xor_b32 s66, s66, s83
    s_mov_b32 s21, s20
    s_mov_b32 s20, s79
    s_lshl_b32 s79, s79, 13
    s_add_u32 s80, s79, 4096
    s_lshl_b32 s83, s66, 4
    s_lshl_b32 s83, 1, s83
    v_mov_b32 v61, s83
    s_mov_b64 exec, 1
    buffer_atomic_add v61, off, s[36:39], s82 sc0 sc1
    s_mov_b64 exec, -1
    buffer_load_dwordx4 a[0:3], v1, s[28:31], s79 offen offset:0 nt
    buffer_load_dwordx4 a[4:7], v1, s[28:31], s79 offen offset:128 nt
    buffer_load_dwordx4 a[8:11], v1, s[28:31], s79 offen offset:2048 nt
    buffer_load_dwordx4 a[12:15], v1, s[28:31], s79 offen offset:2176 nt
    buffer_load_dwordx4 a[16:19], v1, s[28:31], s80 offen offset:0 nt
    buffer_load_dwordx4 a[20:23], v1, s[28:31], s80 offen offset:128 nt
    buffer_load_dwordx4 a[24:27], v1, s[28:31], s80 offen offset:2048 nt
    buffer_load_dwordx4 a[28:31], v1, s[28:31], s80 offen offset:2176 nt
    v_add_f32_dpp v8, v17, v16 quad_perm:[1,0,3,2] row_mask:0xf bank_mask:0xf
    v_add_f32_dpp v9, v19, v18 quad_perm:[1,0,3,2] row_mask:0xf bank_mask:0xf
    v_add_f32_dpp v10, v21, v20 quad_perm:[1,0,3,2] row_mask:0xf bank_mask:0xf
    v_add_f32_dpp v11, v23, v22 quad_perm:[1,0,3,2] row_mask:0xf bank_mask:0xf
    v_add_f32_dpp v12, v25, v24 quad_perm:[1,0,3,2] row_mask:0xf bank_mask:0xf
    v_add_f32_dpp v13, v27, v26 quad_perm:[1,0,3,2] row_mask:0xf bank_mask:0xf
    v_add_f32_dpp v14, v29, v28 quad_perm:[1,0,3,2] row_mask:0xf bank_mask:0xf
    v_add_f32_dpp v15, v31, v30 quad_perm:[1,0,3,2] row_mask:0xf bank_mask:0xf
    v_max3_f32 v7, v8, v9, v10
    v_max3_f32 v7, v7, v11, v12
    v_max3_f32 v7, v7, v13, v14
    v_max_f32 v7, v7, v15
    v_cmp_gt_f32 vcc, v7, v4
    s_nop 4
    s_cbranch_vccz .noresc_183
    s_call_b64 s[94:95], .Lresc
.noresc_183:
    v_fma_f32 v8, v8, s75, -v3
    v_fma_f32 v9, v9, s75, -v3
    v_fma_f32 v10, v10, s75, -v3
    v_fma_f32 v11, v11, s75, -v3
    v_fma_f32 v12, v12, s75, -v3
    v_fma_f32 v13, v13, s75, -v3
    v_fma_f32 v14, v14, s75, -v3
    v_fma_f32 v15, v15, s75, -v3
    v_exp_f32 v8, v8
    v_exp_f32 v9, v9
    v_exp_f32 v10, v10
    v_exp_f32 v11, v11
    v_exp_f32 v12, v12
    v_exp_f32 v13, v13
    v_exp_f32 v14, v14
    v_exp_f32 v15, v15
    v_cvt_pk_bf16_f32 v32, v8, v9
    v_cvt_pk_bf16_f32 v33, v10, v11
    v_cvt_pk_bf16_f32 v34, v12, v13
    v_cvt_pk_bf16_f32 v35, v14, v15
    v_add_f32 v8, v8, v9
    v_add_f32 v10, v10, v11
    v_add_f32 v12, v12, v13
    v_add_f32 v14, v14, v15
    v_add_f32 v8, v8, v10
    v_add_f32 v12, v12, v14
    v_add_f32 v5, v5, v8
    v_add_f32 v5, v5, v12
    s_waitcnt vmcnt(9)
    v_perm_b32 v36, v68, v64, s76
    v_perm_b32 v37, v76, v72, s76
    v_perm_b32 v38, v84, v80, s76
    v_perm_b32 v39, v92, v88, s76
    v_perm_b32 v40, v68, v64, s77
    v_perm_b32 v41, v76, v72, s77
    v_perm_b32 v42, v84, v80, s77
    v_perm_b32 v43, v92, v88, s77
    v_mfma_f32_16x16x32_bf16 a[192:195], v[36:39], v[32:35], a[192:195]
    v_perm_b32 v44, v69, v65, s76
    v_perm_b32 v45, v77, v73, s76
    v_perm_b32 v46, v85, v81, s76
    v_perm_b32 v47, v93, v89, s76
    v_mfma_f32_16x16x32_bf16 a[196:199], v[40:43], v[32:35], a[196:199]
    v_perm_b32 v48, v69, v65, s77
    v_perm_b32 v49, v77, v73, s77
    v_perm_b32 v50, v85, v81, s77
    v_perm_b32 v51, v93, v89, s77
    v_mfma_f32_16x16x32_bf16 a[200:203], v[44:47], v[32:35], a[200:203]
    v_perm_b32 v36, v70, v66, s76
    v_perm_b32 v37, v78, v74, s76
    v_perm_b32 v38, v86, v82, s76
    v_perm_b32 v39, v94, v90, s76
    v_mfma_f32_16x16x32_bf16 a[204:207], v[48:51], v[32:35], a[204:207]
    v_perm_b32 v40, v70, v66, s77
    v_perm_b32 v41, v78, v74, s77
    v_perm_b32 v42, v86, v82, s77
    v_perm_b32 v43, v94, v90, s77
    v_mfma_f32_16x16x32_bf16 a[208:211], v[36:39], v[32:35], a[208:211]
    v_perm_b32 v44, v71, v67, s76
    v_perm_b32 v45, v79, v75, s76
    v_perm_b32 v46, v87, v83, s76
    v_perm_b32 v47, v95, v91, s76
    v_mfma_f32_16x16x32_bf16 a[212:215], v[40:43], v[32:35], a[212:215]
    v_perm_b32 v48, v71, v67, s77
    v_perm_b32 v49, v79, v75, s77
    v_perm_b32 v50, v87, v83, s77
    v_perm_b32 v51, v95, v91, s77
    v_mfma_f32_16x16x32_bf16 a[216:219], v[44:47], v[32:35], a[216:219]
    s_nop 0
    v_mfma_f32_16x16x32_bf16 a[220:223], v[48:51], v[32:35], a[220:223]
    buffer_load_dwordx4 v[64:67], v2, s[32:35], s79 offen offset:0 nt
    buffer_load_dwordx4 v[68:71], v2, s[32:35], s79 offen offset:256 nt
    buffer_load_dwordx4 v[72:75], v2, s[32:35], s79 offen offset:2048 nt
    buffer_load_dwordx4 v[76:79], v2, s[32:35], s79 offen offset:2304 nt
    buffer_load_dwordx4 v[80:83], v2, s[32:35], s80 offen offset:0 nt
    buffer_load_dwordx4 v[84:87], v2, s[32:35], s80 offen offset:256 nt
    buffer_load_dwordx4 v[88:91], v2, s[32:35], s80 offen offset:2048 nt
    buffer_load_dwordx4 v[92:95], v2, s[32:35], s80 offen offset:2304 nt
    s_branch .attn_176
.tail_175:
    s_cmp_eq_u32 s66, 0
    s_cselect_b32 s83, s74, s71
    s_cselect_b32 s84, s68, s67
    s_cmp_ge_u32 s83, s84
    s_cbranch_scc1 .tail3_184
    s_xor_b32 s66, s66, 1
    s_lshl_b32 s83, s66, 4
    s_lshl_b32 s83, 1, s83
    v_mov_b32 v61, s83
    s_mov_b64 exec, 1
    buffer_atomic_add v61, off, s[36:39], s82 sc0 sc1
    s_mov_b64 exec, -1
    v_add_f32_dpp v8, v17, v16 quad_perm:[1,0,3,2] row_mask:0xf bank_mask:0xf
    v_add_f32_dpp v9, v19, v18 quad_perm:[1,0,3,2] row_mask:0xf bank_mask:0xf
    v_add_f32_dpp v10, v21, v20 quad_perm:[1,0,3,2] row_mask:0xf bank_mask:0xf
    v_add_f32_dpp v11, v23, v22 quad_perm:[1,0,3,2] row_mask:0xf bank_mask:0xf
    v_add_f32_dpp v12, v25, v24 quad_perm:[1,0,3,2] row_mask:0xf bank_mask:0xf
    v_add_f32_dpp v13, v27, v26 quad_perm:[1,0,3,2] row_mask:0xf bank_mask:0xf
    v_add_f32_dpp v14, v29, v28 quad_perm:[1,0,3,2] row_mask:0xf bank_mask:0xf
    v_add_f32_dpp v15, v31, v30 quad_perm:[1,0,3,2] row_mask:0xf bank_mask:0xf
    v_max3_f32 v7, v8, v9, v10
    v_max3_f32 v7, v7, v11, v12
    v_max3_f32 v7, v7, v13, v14
    v_max_f32 v7, v7, v15
    v_cmp_gt_f32 vcc, v7, v4
    s_nop 4
    s_cbranch_vccz .noresc_185
    s_call_b64 s[94:95], .Lresc
.noresc_185:
    v_fma_f32 v8, v8, s75, -v3
    v_fma_f32 v9, v9, s75, -v3
    v_fma_f32 v10, v10, s75, -v3
    v_fma_f32 v11, v11, s75, -v3
    v_fma_f32 v12, v12, s75, -v3
    v_fma_f32 v13, v13, s75, -v3
    v_fma_f32 v14, v14, s75, -v3
    v_fma_f32 v15, v15, s75, -v3
    v_exp_f32 v8, v8
    v_exp_f32 v9, v9
    v_exp_f32 v10, v10
    v_exp_f32 v11, v11
    v_exp_f32 v12, v12
    v_exp_f32 v13, v13
    v_exp_f32 v14, v14
    v_exp_f32 v15, v15
    v_cvt_pk_bf16_f32 v32, v8, v9
    v_cvt_pk_bf16_f32 v33, v10, v11
    v_cvt_pk_bf16_f32 v34, v12, v13
    v_cvt_pk_bf16_f32 v35, v14, v15
    v_add_f32 v8, v8, v9
    v_add_f32 v10, v10, v11
    v_add_f32 v12, v12, v13
    v_add_f32 v14, v14, v15
    v_add_f32 v8, v8, v10
    v_add_f32 v12, v12, v14
    v_add_f32 v5, v5, v8
    v_add_f32 v5, v5, v12
    s_waitcnt vmcnt(0)
    v_perm_b32 v36, v68, v64, s76
    v_perm_b32 v37, v76, v72, s76
    v_perm_b32 v38, v84, v80, s76
    v_perm_b32 v39, v92, v88, s76
    v_perm_b32 v40, v68, v64, s77
    v_perm_b32 v41, v76, v72, s77
    v_perm_b32 v42, v84, v80, s77
    v_perm_b32 v43, v92, v88, s77
    v_mfma_f32_16x16x32_bf16 a[192:195], v[36:39], v[32:35], a[192:195]
    v_perm_b32 v44, v69, v65, s76
    v_perm_b32 v45, v77, v73, s76
    v_perm_b32 v46, v85, v81, s76
    v_perm_b32 v47, v93, v89, s76
    v_mfma_f32_16x16x32_bf16 a[196:199], v[40:43], v[32:35], a[196:199]
    v_perm_b32 v48, v69, v65, s77
    v_perm_b32 v49, v77, v73, s77
    v_perm_b32 v50, v85, v81, s77
    v_perm_b32 v51, v93, v89, s77
    v_mfma_f32_16x16x32_bf16 a[200:203], v[44:47], v[32:35], a[200:203]
    v_perm_b32 v36, v70, v66, s76
    v_perm_b32 v37, v78, v74, s76
    v_perm_b32 v38, v86, v82, s76
    v_perm_b32 v39, v94, v90, s76
    v_mfma_f32_16x16x32_bf16 a[204:207], v[48:51], v[32:35], a[204:207]
    v_perm_b32 v40, v70, v66, s77
    v_perm_b32 v41, v78, v74, s77
    v_perm_b32 v42, v86, v82, s77
    v_perm_b32 v43, v94, v90, s77
    v_mfma_f32_16x16x32_bf16 a[208:211], v[36:39], v[32:35], a[208:211]
    v_perm_b32 v44, v71, v67, s76
    v_perm_b32 v45, v79, v75, s76
    v_perm_b32 v46, v87, v83, s76
    v_perm_b32 v47, v95, v91, s76
    v_mfma_f32_16x16x32_bf16 a[212:215], v[40:43], v[32:35], a[212:215]
    v_perm_b32 v48, v71, v67, s77
    v_perm_b32 v49, v79, v75, s77
    v_perm_b32 v50, v87, v83, s77
    v_perm_b32 v51, v95, v91, s77
    v_mfma_f32_16x16x32_bf16 a[216:219], v[44:47], v[32:35], a[216:219]
    s_nop 0
    v_mfma_f32_16x16x32_bf16 a[220:223], v[48:51], v[32:35], a[220:223]
    s_nop 7
    s_branch .b0skip_177
.tail3_184:
    v_add_f32_dpp v8, v17, v16 quad_perm:[1,0,3,2] row_mask:0xf bank_mask:0xf
    v_add_f32_dpp v9, v19, v18 quad_perm:[1,0,3,2] row_mask:0xf bank_mask:0xf
    v_add_f32_dpp v10, v21, v20 quad_perm:[1,0,3,2] row_mask:0xf bank_mask:0xf
    v_add_f32_dpp v11, v23, v22 quad_perm:[1,0,3,2] row_mask:0xf bank_mask:0xf
    v_add_f32_dpp v12, v25, v24 quad_perm:[1,0,3,2] row_mask:0xf bank_mask:0xf
    v_add_f32_dpp v13, v27, v26 quad_perm:[1,0,3,2] row_mask:0xf bank_mask:0xf
    v_add_f32_dpp v14, v29, v28 quad_perm:[1,0,3,2] row_mask:0xf bank_mask:0xf
    v_add_f32_dpp v15, v31, v30 quad_perm:[1,0,3,2] row_mask:0xf bank_mask:0xf
    v_max3_f32 v7, v8, v9, v10
    v_max3_f32 v7, v7, v11, v12
    v_max3_f32 v7, v7, v13, v14
    v_max_f32 v7, v7, v15
    v_cmp_gt_f32 vcc, v7, v4
    s_nop 4
    s_cbranch_vccz .noresc_186
    s_call_b64 s[94:95], .Lresc
.noresc_186:
    v_fma_f32 v8, v8, s75, -v3
    v_fma_f32 v9, v9, s75, -v3
    v_fma_f32 v10, v10, s75, -v3
    v_fma_f32 v11, v11, s75, -v3
    v_fma_f32 v12, v12, s75, -v3
    v_fma_f32 v13, v13, s75, -v3
    v_fma_f32 v14, v14, s75, -v3
    v_fma_f32 v15, v15, s75, -v3
    v_exp_f32 v8, v8
    v_exp_f32 v9, v9
    v_exp_f32 v10, v10
    v_exp_f32 v11, v11
    v_exp_f32 v12, v12
    v_exp_f32 v13, v13
    v_exp_f32 v14, v14
    v_exp_f32 v15, v15
    v_cvt_pk_bf16_f32 v32, v8, v9
    v_cvt_pk_bf16_f32 v33, v10, v11
    v_cvt_pk_bf16_f32 v34, v12, v13
    v_cvt_pk_bf16_f32 v35, v14, v15
    v_add_f32 v8, v8, v9
    v_add_f32 v10, v10, v11
    v_add_f32 v12, v12, v13
    v_add_f32 v14, v14, v15
    v_add_f32 v8, v8, v10
    v_add_f32 v12, v12, v14
    v_add_f32 v5, v5, v8
    v_add_f32 v5, v5, v12
    s_waitcnt vmcnt(0)
    v_perm_b32 v36, v68, v64, s76
    v_perm_b32 v37, v76, v72, s76
    v_perm_b32 v38, v84, v80, s76
    v_perm_b32 v39, v92, v88, s76
    v_perm_b32 v40, v68, v64, s77
    v_perm_b32 v41, v76, v72, s77
    v_perm_b32 v42, v84, v80, s77
    v_perm_b32 v43, v92, v88, s77
    v_mfma_f32_16x16x32_bf16 a[192:195], v[36:39], v[32:35], a[192:195]
    v_perm_b32 v44, v69, v65, s76
    v_perm_b32 v45, v77, v73, s76
    v_perm_b32 v46, v85, v81, s76
    v_perm_b32 v47, v93, v89, s76
    v_mfma_f32_16x16x32_bf16 a[196:199], v[40:43], v[32:35], a[196:199]
    v_perm_b32 v48, v69, v65, s77
    v_perm_b32 v49, v77, v73, s77
    v_perm_b32 v50, v85, v81, s77
    v_perm_b32 v51, v93, v89, s77
    v_mfma_f32_16x16x32_bf16 a[200:203], v[44:47], v[32:35], a[200:203]
    v_perm_b32 v36, v70, v66, s76
    v_perm_b32 v37, v78, v74, s76
    v_perm_b32 v38, v86, v82, s76
    v_perm_b32 v39, v94, v90, s76
    v_mfma_f32_16x16x32_bf16 a[204:207], v[48:51], v[32:35], a[204:207]
    v_perm_b32 v40, v70, v66, s77
    v_perm_b32 v41, v78, v74, s77
    v_perm_b32 v42, v86, v82, s77
    v_perm_b32 v43, v94, v90, s77
    v_mfma_f32_16x16x32_bf16 a[208:211], v[36:39], v[32:35], a[208:211]
    v_perm_b32 v44, v71, v67, s76
    v_perm_b32 v45, v79, v75, s76
    v_perm_b32 v46, v87, v83, s76
    v_perm_b32 v47, v95, v91, s76
    v_mfma_f32_16x16x32_bf16 a[212:215], v[40:43], v[32:35], a[212:215]
    v_perm_b32 v48, v71, v67, s77
    v_perm_b32 v49, v79, v75, s77
    v_perm_b32 v50, v87, v83, s77
    v_perm_b32 v51, v95, v91, s77
    v_mfma_f32_16x16x32_bf16 a[216:219], v[44:47], v[32:35], a[216:219]
    s_nop 0
    v_mfma_f32_16x16x32_bf16 a[220:223], v[48:51], v[32:35], a[220:223]
    s_nop 7
.tail2_178:
.p2j_67:
    s_mov_b32 s89, 917504
    s_call_b64 s[86:87], .Lchain
.Lend:
    s_endpgm
.Lchain:
    v_mov_b32 v52, v5
    s_nop 1
    v_permlane16_swap_b32 v5, v52
    v_add_f32 v5, v5, v52
    v_mov_b32 v52, v5
    s_nop 1
    v_permlane32_swap_b32 v5, v52
    v_add_f32 v5, v5, v52
    v_lshrrev_b32 v52, 1, v62
    v_lshlrev_b32 v52, 9, v52
    v_lshl_add_u32 v52, v63, 4, v52
    s_lshl_b32 s83, s3, 10
    s_add_u32 s83, s83, 154432
    v_add_u32 v52, s83, v52
    s_mov_b32 exec_lo, 0x50005
    s_mov_b32 exec_hi, 0x50005
    ds_write_b128 v52, a[192:195] offset:0
    ds_write_b128 v52, a[196:199] offset:64
    ds_write_b128 v52, a[200:203] offset:128
    ds_write_b128 v52, a[204:207] offset:192
    ds_write_b128 v52, a[208:211] offset:256
    ds_write_b128 v52, a[212:215] offset:320
    ds_write_b128 v52, a[216:219] offset:384
    ds_write_b128 v52, a[220:223] offset:448
    v_lshrrev_b32 v53, 1, v62
    v_lshlrev_b32 v53, 2, v53
    s_lshl_b32 s83, s3, 4
    s_add_u32 s83, s83, 158528
    v_add_u32 v53, s83, v53
    s_mov_b32 exec_lo, 0x5
    s_mov_b32 exec_hi, 0x0
    ds_write_b32 v53, v6
    ds_write_b32 v53, v5 offset:8
    s_mov_b64 exec, -1
    s_and_b32 s83, s3, 1
    s_lshl_b32 s83, s83, 6
    v_add_u32 v52, s83, v0
    v_and_b32 v53, 7, v52
    v_lshrrev_b32 v54, 3, v52
    v_lshlrev_b32 v53, 6, v53
    v_lshl_add_u32 v53, v54, 2, v53
    s_lshr_b32 s83, s3, 1
    s_lshl_b32 s84, s83, 9
    s_add_u32 s84, s84, 154432
    v_add_u32 v53, s84, v53
    s_lshl_b32 s84, s83, 2
    s_add_u32 s84, s84, 158528
    v_mov_b32 v54, s84
    s_lshl_b32 s4, s2, 10
    s_lshl_b32 s5, s3, 8
    s_add_u32 s4, s4, s5
    s_add_u32 s4, s4, s89
    s_mul_i32 s5, s72, 18
    s_add_u32 s5, s5, s83
    s_lshl_b32 s5, s5, 4
    s_add_u32 s5, s5, s73
    s_lshl_b32 s5, s5, 3
    s_add_u32 s5, s5, s89
    s_add_u32 s5, s5, 262144
    s_bitcmp0_b32 s3, 0
    s_cselect_b32 s12, 0x1ff, 0
    s_mov_b32 s13, 0
    v_lshlrev_b32 v52, 2, v0
    v_lshlrev_b32 v55, 8, v0
    s_waitcnt lgkmcnt(0)
    s_barrier
    ds_read_b32 v8, v53 offset:0
    ds_read_b32 v9, v53 offset:1024
    ds_read_b32 v10, v53 offset:2048
    ds_read_b32 v11, v53 offset:3072
    ds_read_b32 v16, v54 offset:0
    ds_read_b32 v20, v54 offset:8
    ds_read_b32 v17, v54 offset:16
    ds_read_b32 v21, v54 offset:24
    ds_read_b32 v18, v54 offset:32
    ds_read_b32 v22, v54 offset:40
    ds_read_b32 v19, v54 offset:48
    ds_read_b32 v23, v54 offset:56
    s_waitcnt lgkmcnt(0)
    v_max3_f32 v56, v16, v17, v18
    v_max_f32 v56, v56, v19
    v_sub_f32 v16, v16, v56
    v_sub_f32 v17, v17, v56
    v_sub_f32 v18, v18, v56
    v_sub_f32 v19, v19, v56
    v_mul_f32 v16, s75, v16
    v_mul_f32 v17, s75, v17
    v_mul_f32 v18, s75, v18
    v_mul_f32 v19, s75, v19
    v_exp_f32 v16, v16
    v_exp_f32 v17, v17
    v_exp_f32 v18, v18
    v_exp_f32 v19, v19
    v_mul_f32 v32, v8, v16
    v_mul_f32 v57, v20, v16
    v_fmac_f32 v32, v9, v17
    v_fmac_f32 v57, v21, v17
    v_fmac_f32 v32, v10, v18
    v_fmac_f32 v57, v22, v18
    v_fmac_f32 v32, v11, v19
    v_fmac_f32 v57, v23, v19
    s_nop 0
    v_mov_b32_dpp v33, v32 quad_perm:[1,1,1,1] row_mask:0xf bank_mask:0xf
    v_mov_b32_dpp v34, v32 quad_perm:[2,2,2,2] row_mask:0xf bank_mask:0xf
    v_mov_b32_dpp v35, v32 quad_perm:[3,3,3,3] row_mask:0xf bank_mask:0xf
    s_mov_b32 exec_lo, 0x11111111
    s_mov_b32 exec_hi, 0x11111111
    buffer_store_dwordx4 v[32:35], v52, s[36:39], s4 offen sc1
    s_mov_b64 exec, s[12:13]
    buffer_store_dwordx2 v[56:57], v55, s[36:39], s5 offen sc1
    s_lshl_b32 s6, s73, 2
    s_add_u32 s6, s6, s3
    s_lshl_b32 s6, s6, 2
    s_lshl_b32 s83, s72, 15
    s_add_u32 s6, s6, s83
    s_cmp_eq_u32 s89, 0
    s_cselect_b32 s83, 0, 512
    s_add_u32 s6, s6, s83
    s_add_u32 s6, s6, 1838080
    v_writelane_b32 v8, s20, 0
    s_nop 0
    v_writelane_b32 v8, s21, 1
    s_mov_b64 exec, 3
    buffer_store_dword v8, v55, s[36:39], s6 offen sc1
    s_mov_b64 exec, -1
    s_cmp_ge_u32 s60, 144
    s_cbranch_scc1 .skB_187
    v_bfe_u32 v53, v62, 3, 1
    v_and_b32 v52, 1, v63
    v_lshl_or_b32 v53, v52, 1, v53
    v_xor_b32 v53, s3, v53
    v_lshlrev_b32 v53, 5, v53
    v_and_b32 v52, 3, v62
    v_lshl_add_u32 v53, v52, 3, v53
    v_lshrrev_b32 v52, 2, v62
    v_lshl_add_u32 v52, v63, 3, v52
    v_lshl_add_u32 v52, v52, 7, v53
    ds_read_b64_tr_b16 a[192:193], v52 offset:0
    ds_read_b64_tr_b16 a[194:195], v52 offset:512
    ds_read_b64_tr_b16 a[196:197], v52 offset:4096
    ds_read_b64_tr_b16 a[198:199], v52 offset:4608
    ds_read_b64_tr_b16 a[200:201], v52 offset:8192
    ds_read_b64_tr_b16 a[202:203], v52 offset:8704
    ds_read_b64_tr_b16 a[204:205], v52 offset:12288
    ds_read_b64_tr_b16 a[206:207], v52 offset:12800
    ds_read_b64_tr_b16 a[208:209], v52 offset:16384
    ds_read_b64_tr_b16 a[210:211], v52 offset:16896
    ds_read_b64_tr_b16 a[212:213], v52 offset:20480
    ds_read_b64_tr_b16 a[214:215], v52 offset:20992
    ds_read_b64_tr_b16 a[216:217], v52 offset:24576
    ds_read_b64_tr_b16 a[218:219], v52 offset:25088
    ds_read_b64_tr_b16 a[220:221], v52 offset:28672
    ds_read_b64_tr_b16 a[222:223], v52 offset:29184
    v_lshlrev_b32 v53, 12, v63
    v_lshl_add_u32 v53, v62, 4, v53
    v_lshlrev_b32 v54, 5, v63
    s_lshl_b32 s4, s61, 14
    s_lshl_b32 s83, s3, 8
    s_add_u32 s4, s4, s83
    s_add_u32 s4, s4, s89
    s_lshl_b32 s5, s60, 1
    s_lshr_b32 s83, s3, 1
    s_add_u32 s5, s5, s83
    s_lshl_b32 s5, s5, 7
    s_add_u32 s5, s5, s89
    s_add_u32 s5, s5, 262144
    s_lshl_b32 s6, s62, 4
    s_add_u32 s6, s6, s61
    s_lshl_b32 s6, s6, 8
    s_lshl_b32 s83, s3, 6
    s_add_u32 s6, s6, s83
    s_add_u32 s6, s6, s89
    s_add_u32 s6, s6, 299008
    v_mul_u32_u24 v55, 36864, v62
    v_lshl_add_u32 v55, v63, 4, v55
    v_lshlrev_b32 v56, 3, v62
    s_lshl_b32 s83, s3, 7
    s_add_u32 s83, s83, 148736
    v_add_u32 v56, s83, v56
    v_lshlrev_b32 v57, 4, v63
    v_add_u32 v57, 148736, v57
    s_mov_b32 s88, 200000
    s_nop 0
.gB_188:
    buffer_load_dwordx4 v[8:11], v53, s[36:39], s4 offen offset:0 sc1
    buffer_load_dwordx4 v[12:15], v53, s[36:39], s4 offen offset:1024 sc1
    buffer_load_dwordx4 v[16:19], v53, s[36:39], s4 offen offset:2048 sc1
    buffer_load_dwordx4 v[20:23], v53, s[36:39], s4 offen offset:3072 sc1
    buffer_load_dwordx4 v[24:27], v54, s[36:39], s5 offen offset:0 sc1
    buffer_load_dwordx4 v[28:31], v54, s[36:39], s5 offen offset:16 sc1
    s_waitcnt vmcnt(0)
    v_pk_add_f32 v[32:33], v[8:9], v[10:11]
    v_pk_add_f32 v[34:35], v[12:13], v[14:15]
    v_pk_add_f32 v[32:33], v[32:33], v[16:17]
    v_pk_add_f32 v[34:35], v[34:35], v[18:19]
    v_pk_add_f32 v[32:33], v[32:33], v[20:21]
    v_pk_add_f32 v[34:35], v[34:35], v[22:23]
    v_pk_add_f32 v[32:33], v[32:33], v[24:25]
    v_pk_add_f32 v[34:35], v[34:35], v[26:27]
    v_pk_add_f32 v[32:33], v[32:33], v[28:29]
    v_pk_add_f32 v[34:35], v[34:35], v[30:31]
    v_pk_add_f32 v[32:33], v[32:33], v[34:35]
    v_add_f32 v32, v32, v33
    v_cmp_u_f32 vcc, v32, v32
    s_nop 4
    s_cbranch_vccz .gBd_189
    s_mov_b64 exec, vcc
    s_sub_u32 s88, s88, 1
    s_cmp_lg_u32 s88, 0
    s_cbranch_scc1 .gB_188
.gBd_189:
    s_mov_b64 exec, -1
    v_max3_f32 v32, v24, v26, v28
    v_max_f32 v32, v32, v30
    v_mov_b32 v33, v32
    s_nop 1
    v_permlane16_swap_b32 v32, v33
    v_max_f32 v32, v32, v33
    v_mov_b32 v33, v32
    s_nop 1
    v_permlane32_swap_b32 v32, v33
    v_max_f32 v32, v32, v33
    v_sub_f32 v34, v24, v32
    v_sub_f32 v35, v26, v32
    v_sub_f32 v36, v28, v32
    v_sub_f32 v37, v30, v32
    v_mul_f32 v34, s75, v34
    v_mul_f32 v35, s75, v35
    v_mul_f32 v36, s75, v36
    v_mul_f32 v37, s75, v37
    v_exp_f32 v34, v34
    v_exp_f32 v35, v35
    v_exp_f32 v36, v36
    v_exp_f32 v37, v37
    v_mul_f32 v44, v34, v25
    v_mul_f32 v40, v34, v8
    v_mul_f32 v41, v34, v9
    v_mul_f32 v42, v34, v10
    v_mul_f32 v43, v34, v11
    v_fmac_f32 v44, v35, v27
    v_fmac_f32 v40, v35, v12
    v_fmac_f32 v41, v35, v13
    v_fmac_f32 v42, v35, v14
    v_fmac_f32 v43, v35, v15
    v_fmac_f32 v44, v36, v29
    v_fmac_f32 v40, v36, v16
    v_fmac_f32 v41, v36, v17
    v_fmac_f32 v42, v36, v18
    v_fmac_f32 v43, v36, v19
    v_fmac_f32 v44, v37, v31
    v_fmac_f32 v40, v37, v20
    v_fmac_f32 v41, v37, v21
    v_fmac_f32 v42, v37, v22
    v_fmac_f32 v43, v37, v23
    v_mov_b32 v46, v40
    v_mov_b32 v47, v41
    v_mov_b32 v48, v42
    v_mov_b32 v49, v43
    v_mov_b32 v50, v44
    v_permlane16_swap_b32 v40, v46
    v_permlane16_swap_b32 v41, v47
    v_permlane16_swap_b32 v42, v48
    v_permlane16_swap_b32 v43, v49
    v_permlane16_swap_b32 v44, v50
    v_add_f32 v40, v40, v46
    v_add_f32 v41, v41, v47
    v_add_f32 v42, v42, v48
    v_add_f32 v43, v43, v49
    v_add_f32 v44, v44, v50
    v_mov_b32 v46, v40
    v_mov_b32 v47, v41
    v_mov_b32 v48, v42
    v_mov_b32 v49, v43
    v_mov_b32 v50, v44
    v_permlane32_swap_b32 v40, v46
    v_permlane32_swap_b32 v41, v47
    v_permlane32_swap_b32 v42, v48
    v_permlane32_swap_b32 v43, v49
    v_permlane32_swap_b32 v44, v50
    v_add_f32 v40, v40, v46
    v_add_f32 v41, v41, v47
    v_add_f32 v42, v42, v48
    v_add_f32 v43, v43, v49
    v_add_f32 v44, v44, v50
    v_rcp_f32 v44, v44
    s_nop 0
    v_mul_f32 v40, v40, v44
    v_mul_f32 v41, v41, v44
    v_mul_f32 v42, v42, v44
    v_mul_f32 v43, v43, v44
    v_cvt_pk_bf16_f32 v46, v40, v41
    v_cvt_pk_bf16_f32 v47, v42, v43
    s_mov_b64 exec, 0xffff
    ds_write_b64 v56, v[46:47]
    s_mov_b64 exec, -1
    s_waitcnt lgkmcnt(0)
    s_barrier
    ds_read_b128 v[8:11], v57 offset:0
    ds_read_b128 v[12:15], v57 offset:64
    ds_read_b128 v[16:19], v57 offset:128
    ds_read_b128 v[20:23], v57 offset:192
    ds_read_b128 v[24:27], v57 offset:256
    ds_read_b128 v[28:31], v57 offset:320
    ds_read_b128 v[32:35], v57 offset:384
    ds_read_b128 v[36:39], v57 offset:448
    s_waitcnt lgkmcnt(7)
    v_mfma_f32_16x16x32_bf16 v[40:43], a[192:195], v[8:11], 0
    s_waitcnt lgkmcnt(6)
    v_mfma_f32_16x16x32_bf16 v[40:43], a[196:199], v[12:15], v[40:43]
    s_waitcnt lgkmcnt(5)
    v_mfma_f32_16x16x32_bf16 v[40:43], a[200:203], v[16:19], v[40:43]
    s_waitcnt lgkmcnt(4)
    v_mfma_f32_16x16x32_bf16 v[40:43], a[204:207], v[20:23], v[40:43]
    s_waitcnt lgkmcnt(3)
    v_mfma_f32_16x16x32_bf16 v[40:43], a[208:211], v[24:27], v[40:43]
    s_waitcnt lgkmcnt(2)
    v_mfma_f32_16x16x32_bf16 v[40:43], a[212:215], v[28:31], v[40:43]
    s_waitcnt lgkmcnt(1)
    v_mfma_f32_16x16x32_bf16 v[40:43], a[216:219], v[32:35], v[40:43]
    s_waitcnt lgkmcnt(0)
    v_mfma_f32_16x16x32_bf16 v[40:43], a[220:223], v[36:39], v[40:43]
    s_mov_b32 exec_lo, 0xff00ff
    s_mov_b32 exec_hi, 0xff00ff
    s_nop 5
    buffer_store_dwordx4 v[40:43], v55, s[36:39], s6 offen sc1
    s_mov_b64 exec, -1
    s_nop 0
.skB_187:
    s_cmp_lg_u32 s89, 0
    s_cbranch_scc1 .npb_190
    s_cmp_ge_u32 s60, 72
    s_cbranch_scc1 .npb_190
    s_waitcnt vmcnt(0)
    s_lshl_b32 s4, s3, 14
    s_lshl_b32 s5, s73, 9
    s_add_u32 s4, s4, s5
    s_add_u32 s4, s4, 0x8e0000
    s_add_u32 s5, s4, 0x100000
    s_mov_b64 exec, 1
    s_cmp_ge_u32 s3, 2
    s_cbranch_scc1 .pbv_191
    buffer_load_dword v8, off, s[28:31], s5 nt
    s_add_u32 s5, s4, 0x2000
    s_movk_i32 s12, 0x7fff
    s_movk_i32 s13, 0x7fff
    s_waitcnt vmcnt(0)
    s_memtime s[6:7]
    s_waitcnt lgkmcnt(0)
    buffer_load_dword v8, off, s[28:31], s4 offset:0 nt
    s_waitcnt vmcnt(0)
    s_memtime s[8:9]
    s_waitcnt lgkmcnt(0)
    s_sub_u32 s6, s8, s6
    s_min_u32 s12, s12, s6
    s_memtime s[6:7]
    s_waitcnt lgkmcnt(0)
    buffer_load_dword v8, off, s[28:31], s5 offset:0 nt
    s_waitcnt vmcnt(0)
    s_memtime s[8:9]
    s_waitcnt lgkmcnt(0)
    s_sub_u32 s6, s8, s6
    s_min_u32 s13, s13, s6
    s_memtime s[6:7]
    s_waitcnt lgkmcnt(0)
    buffer_load_dword v8, off, s[28:31], s4 offset:128 nt
    s_waitcnt vmcnt(0)
    s_memtime s[8:9]
    s_waitcnt lgkmcnt(0)
    s_sub_u32 s6, s8, s6
    s_min_u32 s12, s12, s6
    s_memtime s[6:7]
    s_waitcnt lgkmcnt(0)
    buffer_load_dword v8, off, s[28:31], s5 offset:128 nt
    s_waitcnt vmcnt(0)
    s_memtime s[8:9]
    s_waitcnt lgkmcnt(0)
    s_sub_u32 s6, s8, s6
    s_min_u32 s13, s13, s6
    s_memtime s[6:7]
    s_waitcnt lgkmcnt(0)
    buffer_load_dword v8, off, s[28:31], s4 offset:256 nt
    s_waitcnt vmcnt(0)
    s_memtime s[8:9]
    s_waitcnt lgkmcnt(0)
    s_sub_u32 s6, s8, s6
    s_min_u32 s12, s12, s6
    s_memtime s[6:7]
    s_waitcnt lgkmcnt(0)
    buffer_load_dword v8, off, s[28:31], s5 offset:256 nt
    s_waitcnt vmcnt(0)
    s_memtime s[8:9]
    s_waitcnt lgkmcnt(0)
    s_sub_u32 s6, s8, s6
    s_min_u32 s13, s13, s6
    s_branch .pbj_192
.pbv_191:
    buffer_load_dword v8, off, s[32:35], s5 nt
    s_add_u32 s5, s4, 0x2000
    s_movk_i32 s12, 0x7fff
    s_movk_i32 s13, 0x7fff
    s_waitcnt vmcnt(0)
    s_memtime s[6:7]
    s_waitcnt lgkmcnt(0)
    buffer_load_dword v8, off, s[32:35], s4 offset:0 nt
    s_waitcnt vmcnt(0)
    s_memtime s[8:9]
    s_waitcnt lgkmcnt(0)
    s_sub_u32 s6, s8, s6
    s_min_u32 s12, s12, s6
    s_memtime s[6:7]
    s_waitcnt lgkmcnt(0)
    buffer_load_dword v8, off, s[32:35], s5 offset:0 nt
    s_waitcnt vmcnt(0)
    s_memtime s[8:9]
    s_waitcnt lgkmcnt(0)
    s_sub_u32 s6, s8, s6
    s_min_u32 s13, s13, s6
    s_memtime s[6:7]
    s_waitcnt lgkmcnt(0)
    buffer_load_dword v8, off, s[32:35], s4 offset:128 nt
    s_waitcnt vmcnt(0)
    s_memtime s[8:9]
    s_waitcnt lgkmcnt(0)
    s_sub_u32 s6, s8, s6
    s_min_u32 s12, s12, s6
    s_memtime s[6:7]
    s_waitcnt lgkmcnt(0)
    buffer_load_dword v8, off, s[32:35], s5 offset:128 nt
    s_waitcnt vmcnt(0)
    s_memtime s[8:9]
    s_waitcnt lgkmcnt(0)
    s_sub_u32 s6, s8, s6
    s_min_u32 s13, s13, s6
    s_memtime s[6:7]
    s_waitcnt lgkmcnt(0)
    buffer_load_dword v8, off, s[32:35], s4 offset:256 nt
    s_waitcnt vmcnt(0)
    s_memtime s[8:9]
    s_waitcnt lgkmcnt(0)
    s_sub_u32 s6, s8, s6
    s_min_u32 s12, s12, s6
    s_memtime s[6:7]
    s_waitcnt lgkmcnt(0)
    buffer_load_dword v8, off, s[32:35], s5 offset:256 nt
    s_waitcnt vmcnt(0)
    s_memtime s[8:9]
    s_waitcnt lgkmcnt(0)
    s_sub_u32 s6, s8, s6
    s_min_u32 s13, s13, s6
.pbj_192:
    s_mov_b64 exec, -1
    s_sub_i32 s12, s13, s12
    s_max_i32 s12, s12, -300
    s_min_i32 s12, s12, 300
    s_lshl_b32 s5, s3, 2
    s_add_u32 s5, s5, 158528
    v_mov_b32 v8, s5
    v_mov_b32 v9, s12
    ds_write_b32 v8, v9
    v_mov_b32 v8, 158528
    s_waitcnt lgkmcnt(0)
    s_barrier
    ds_read_b128 v[8:11], v8
    s_waitcnt lgkmcnt(0)
    v_add_u32 v8, v8, v9
    v_add_u32 v10, v10, v11
    v_readfirstlane_b32 s12, v8
    v_readfirstlane_b32 s13, v10
    s_cmp_lg_u32 s3, 0
    s_nop 3
    s_cbranch_scc1 .pbn_193
    s_abs_i32 s4, s12
    s_abs_i32 s5, s13
    s_min_u32 s4, s4, s5
    s_cmp_lt_u32 s4, 120
    s_cbranch_scc1 .pbn_193
    s_xor_b32 s4, s12, s13
    s_cmp_lt_i32 s4, 0
    s_cselect_b32 s4, 0x10000, 1
    v_mov_b32 v8, s4
    s_mov_b64 exec, 1
    buffer_atomic_add v8, off, s[48:51], 0 offset:64 sc1
    s_mov_b64 exec, -1
.pbn_193:
    s_cmp_lt_i32 s12, 0
    s_cselect_b32 s81, 1, 0
.npb_190:
    s_cmp_lt_u32 s60, 144
    s_cbranch_scc1 .skC_194
    s_cmp_ge_u32 s60, 216
    s_cbranch_scc1 .skC_194
    s_cmp_lg_u32 s89, 0
    s_cbranch_scc1 .lwd_196
    s_lshr_b32 s83, s74, 3
    v_bfe_u32 v10, v0, 1, 2
    v_bfe_u32 v58, v0, 4, 1
    v_xor_b32 v10, v10, v58
    v_lshlrev_b32 v10, 5, v10
    v_and_b32 v58, 1, v0
    v_lshl_add_u32 v10, v58, 4, v10
    v_lshrrev_b32 v58, 3, v0
    v_mul_u32_u24 v58, s83, v58
    v_add_u32 v58, v58, v10
    v_xor_b32 v59, 64, v58
    s_mov_b32 s22, 8
    s_nop 0
.lw_195:
    s_cmp_lg_u32 s68, 0
    s_cbranch_scc1 .wgo_197
    s_mov_b64 s[52:53], s[56:57]
    s_mov_b32 s54, s58
    s_mov_b32 s66, s69
    s_mov_b32 s67, s70
    s_mov_b32 s68, s71
.wgo_197:
    s_mov_b32 m0, s67
    s_nop 0
    buffer_load_dwordx4 v58, s[52:55], s66 offen nt lds
    s_add_u32 s66, s66, s74
    s_add_u32 m0, s67, 1024
    s_nop 0
    buffer_load_dwordx4 v59, s[52:55], s66 offen nt lds
    s_add_u32 s66, s66, s74
    s_add_u32 s67, s67, 2048
    s_sub_u32 s68, s68, 1
    s_sub_u32 s22, s22, 1
    s_cmp_lg_u32 s22, 0
    s_cbranch_scc1 .lw_195
    s_waitcnt vmcnt(0)
    s_barrier
.lwd_196:
    v_bfe_u32 v1, v62, 3, 1
    v_and_b32 v5, 1, v63
    v_lshl_or_b32 v1, v5, 1, v1
    v_xor_b32 v1, s3, v1
    v_lshlrev_b32 v1, 5, v1
    v_and_b32 v5, 3, v62
    v_lshl_add_u32 v1, v5, 3, v1
    v_lshrrev_b32 v5, 2, v62
    v_lshl_add_u32 v5, v63, 3, v5
    v_lshl_add_u32 v5, v5, 7, v1
    v_add_u32 v6, 0x10000, v5
    v_add_u32 v7, 0x20000, v5
    ds_read_b64_tr_b16 a[192:193], v5 offset:0
    ds_read_b64_tr_b16 a[194:195], v5 offset:512
    ds_read_b64_tr_b16 a[196:197], v6 offset:8192
    ds_read_b64_tr_b16 a[198:199], v6 offset:8704
    ds_read_b64_tr_b16 a[200:201], v5 offset:4096
    ds_read_b64_tr_b16 a[202:203], v5 offset:4608
    ds_read_b64_tr_b16 a[204:205], v6 offset:12288
    ds_read_b64_tr_b16 a[206:207], v6 offset:12800
    ds_read_b64_tr_b16 a[208:209], v5 offset:8192
    ds_read_b64_tr_b16 a[210:211], v5 offset:8704
    ds_read_b64_tr_b16 a[212:213], v6 offset:16384
    ds_read_b64_tr_b16 a[214:215], v6 offset:16896
    ds_read_b64_tr_b16 a[216:217], v5 offset:12288
    ds_read_b64_tr_b16 a[218:219], v5 offset:12800
    ds_read_b64_tr_b16 a[220:221], v6 offset:20480
    ds_read_b64_tr_b16 a[222:223], v6 offset:20992
    ds_read_b64_tr_b16 a[224:225], v5 offset:16384
    ds_read_b64_tr_b16 a[226:227], v5 offset:16896
    ds_read_b64_tr_b16 a[228:229], v6 offset:24576
    ds_read_b64_tr_b16 a[230:231], v6 offset:25088
    v_lshlrev_b32 v58, 4, v0
    v_min_u32 v59, 2, v63
    v_lshlrev_b32 v59, 7, v59
    v_lshl_add_u32 v59, v62, 3, v59
    s_cmp_eq_u32 s3, 3
    s_nop 0
    s_cbranch_scc1 .c3_198
    s_and_b32 s4, s63, 7
    s_mul_i32 s4, s4, 36864
    s_mul_i32 s83, s3, 12288
    s_add_u32 s4, s4, s83
    s_add_u32 s4, s4, s89
    s_add_u32 s4, s4, 299008
    s_add_u32 s5, s4, 4096
    s_add_u32 s6, s4, 8192
    s_cmp_eq_u32 s89, 0
    s_cselect_b32 s8, s40, s36
    s_cselect_b32 s9, s41, s37
    s_cselect_b32 s10, s42, s38
    s_mov_b32 s11, 0x00020000
    s_and_b32 s83, s63, 15
    s_mul_i32 s83, s83, 1280
    s_add_u32 s84, s83, 844800
    s_cmp_eq_u32 s89, 0
    s_cselect_b32 s18, 0, s84
    s_mul_i32 s84, s3, 384
    s_add_u32 s18, s18, s84
    s_add_u32 s7, s83, s89
    s_add_u32 s7, s7, 593920
    s_add_u32 s7, s7, s84
    s_cmp_lt_u32 s63, 16
    s_cselect_b32 s7, s7, -1
    s_mov_b32 s88, 200000
.gX_200:
    buffer_load_dwordx4 v[8:11], v58, s[36:39], s4 offen offset:0 sc1
    buffer_load_dwordx4 v[12:15], v58, s[36:39], s4 offen offset:1024 sc1
    buffer_load_dwordx4 v[16:19], v58, s[36:39], s4 offen offset:2048 sc1
    buffer_load_dwordx4 v[20:23], v58, s[36:39], s4 offen offset:3072 sc1
    buffer_load_dwordx4 v[24:27], v58, s[36:39], s5 offen offset:0 sc1
    buffer_load_dwordx4 v[28:31], v58, s[36:39], s5 offen offset:1024 sc1
    buffer_load_dwordx4 v[32:35], v58, s[36:39], s5 offen offset:2048 sc1
    buffer_load_dwordx4 v[36:39], v58, s[36:39], s5 offen offset:3072 sc1
    buffer_load_dwordx4 v[40:43], v58, s[36:39], s6 offen offset:0 sc1
    buffer_load_dwordx4 v[44:47], v58, s[36:39], s6 offen offset:1024 sc1
    buffer_load_dwordx4 v[48:51], v58, s[36:39], s6 offen offset:2048 sc1
    buffer_load_dwordx4 v[52:55], v58, s[36:39], s6 offen offset:3072 sc1
    buffer_load_dwordx2 v[56:57], v59, s[8:11], s18 offen sc1
    s_waitcnt vmcnt(0)
    v_pk_add_f32 v[8:9], v[8:9], v[12:13]
    v_pk_add_f32 v[10:11], v[10:11], v[14:15]
    v_pk_add_f32 v[24:25], v[24:25], v[28:29]
    v_pk_add_f32 v[26:27], v[26:27], v[30:31]
    v_pk_add_f32 v[40:41], v[40:41], v[44:45]
    v_pk_add_f32 v[42:43], v[42:43], v[46:47]
    v_pk_add_f32 v[8:9], v[8:9], v[16:17]
    v_pk_add_f32 v[10:11], v[10:11], v[18:19]
    v_pk_add_f32 v[24:25], v[24:25], v[32:33]
    v_pk_add_f32 v[26:27], v[26:27], v[34:35]
    v_pk_add_f32 v[40:41], v[40:41], v[48:49]
    v_pk_add_f32 v[42:43], v[42:43], v[50:51]
    v_pk_add_f32 v[8:9], v[8:9], v[20:21]
    v_pk_add_f32 v[10:11], v[10:11], v[22:23]
    v_pk_add_f32 v[24:25], v[24:25], v[36:37]
    v_pk_add_f32 v[26:27], v[26:27], v[38:39]
    v_pk_add_f32 v[40:41], v[40:41], v[52:53]
    v_pk_add_f32 v[42:43], v[42:43], v[54:55]
    v_pk_add_f32 v[2:3], v[8:9], v[10:11]
    v_pk_add_f32 v[4:5], v[24:25], v[26:27]
    v_pk_add_f32 v[2:3], v[2:3], v[40:41]
    v_pk_add_f32 v[4:5], v[4:5], v[42:43]
    v_pk_add_f32 v[2:3], v[2:3], v[56:57]
    v_pk_add_f32 v[2:3], v[2:3], v[4:5]
    v_add_f32 v60, v2, v3
    v_cmp_u_f32 vcc, v60, v60
    s_nop 4
    s_cbranch_vccz .gXd_201
    s_mov_b64 exec, vcc
    s_sub_u32 s88, s88, 1
    s_cmp_lg_u32 s88, 0
    s_cbranch_scc1 .gX_200
.gXd_201:
    s_mov_b64 exec, -1
    v_mov_b32 v12, v40
    v_mov_b32 v13, v41
    v_mov_b32 v14, v42
    v_mov_b32 v15, v43
    v_permlane16_swap_b32 v8, v24
    v_permlane16_swap_b32 v9, v25
    v_permlane16_swap_b32 v10, v26
    v_permlane16_swap_b32 v11, v27
    v_permlane16_swap_b32 v40, v12
    v_permlane16_swap_b32 v41, v13
    v_permlane16_swap_b32 v42, v14
    v_permlane16_swap_b32 v43, v15
    v_pk_add_f32 v[8:9], v[8:9], v[24:25]
    v_pk_add_f32 v[10:11], v[10:11], v[26:27]
    v_pk_add_f32 v[40:41], v[40:41], v[12:13]
    v_pk_add_f32 v[42:43], v[42:43], v[14:15]
    s_nop 0
    v_permlane32_swap_b32 v8, v40
    v_permlane32_swap_b32 v9, v41
    v_permlane32_swap_b32 v10, v42
    v_permlane32_swap_b32 v11, v43
    v_pk_add_f32 v[8:9], v[8:9], v[40:41]
    v_pk_add_f32 v[10:11], v[10:11], v[42:43]
    v_cvt_pk_bf16_f32 v12, v8, v9
    v_cvt_pk_bf16_f32 v13, v10, v11
    v_lshlrev_b32 v8, 16, v12
    v_and_b32 v9, s100, v12
    v_lshlrev_b32 v10, 16, v13
    v_and_b32 v11, s100, v13
    v_lshlrev_b32 v16, 16, v56
    v_and_b32 v17, s100, v56
    v_lshlrev_b32 v18, 16, v57
    v_and_b32 v19, s100, v57
    v_pk_add_f32 v[16:17], v[16:17], v[8:9]
    v_pk_add_f32 v[18:19], v[18:19], v[10:11]
    v_cvt_pk_bf16_f32 v12, v16, v17
    v_cvt_pk_bf16_f32 v13, v18, v19
    s_cmp_eq_u32 s7, -1
    s_nop 0
    s_cbranch_scc1 .nopub_202
    s_mov_b32 exec_lo, 0xffffffff
    s_mov_b32 exec_hi, 0xffff
    buffer_store_dwordx2 v[12:13], v59, s[36:39], s7 offen sc1
    s_mov_b64 exec, -1
.nopub_202:
    v_lshlrev_b32 v16, 16, v12
    v_and_b32 v17, s100, v12
    v_lshlrev_b32 v18, 16, v13
    v_and_b32 v19, s100, v13
    v_add_f32 v20, v16, v17
    v_mul_f32 v21, v16, v16
    v_add_f32 v20, v20, v18
    v_fmac_f32 v21, v17, v17
    v_add_f32 v20, v20, v19
    v_fmac_f32 v21, v18, v18
    v_fmac_f32 v21, v19, v19
    v_cmp_gt_u32 vcc, 48, v0
    s_nop 1
    v_cndmask_b32 v20, 0, v20, vcc
    v_cndmask_b32 v21, 0, v21, vcc
    s_nop 0
    v_add_f32_dpp v20, v20, v20 quad_perm:[1,0,3,2] row_mask:0xf bank_mask:0xf
    v_add_f32_dpp v21, v21, v21 quad_perm:[1,0,3,2] row_mask:0xf bank_mask:0xf
    s_nop 0
    v_add_f32_dpp v20, v20, v20 quad_perm:[2,3,0,1] row_mask:0xf bank_mask:0xf
    v_add_f32_dpp v21, v21, v21 quad_perm:[2,3,0,1] row_mask:0xf bank_mask:0xf
    s_nop 0
    v_add_f32_dpp v20, v20, v20 row_half_mirror row_mask:0xf bank_mask:0xf
    v_add_f32_dpp v21, v21, v21 row_half_mirror row_mask:0xf bank_mask:0xf
    s_nop 0
    v_add_f32_dpp v20, v20, v20 row_mirror row_mask:0xf bank_mask:0xf
    v_add_f32_dpp v21, v21, v21 row_mirror row_mask:0xf bank_mask:0xf
    v_mov_b32 v22, v20
    v_mov_b32 v23, v21
    s_nop 0
    v_permlane16_swap_b32 v20, v22
    v_permlane16_swap_b32 v21, v23
    v_add_f32 v20, v20, v22
    v_add_f32 v21, v21, v23
    v_mov_b32 v22, v20
    v_mov_b32 v23, v21
    s_nop 0
    v_permlane32_swap_b32 v20, v22
    v_permlane32_swap_b32 v21, v23
    v_add_f32 v20, v20, v22
    v_add_f32 v21, v21, v23
    s_lshl_b32 s83, s3, 3
    s_add_u32 s83, s83, 154368
    v_mov_b32 v22, s83
    v_mov_b32 v23, 154368
    s_mov_b64 exec, 1
    ds_write_b64 v22, v[20:21]
    s_mov_b64 exec, -1
    s_mul_i32 s83, s3, 384
    s_add_u32 s83, s83, 147456
    v_add_u32 v59, s83, v59
    s_waitcnt lgkmcnt(0)
    s_barrier
    ds_read_b128 v[24:27], v23
    ds_read_b64 v[28:29], v23 offset:16
    s_waitcnt lgkmcnt(0)
    v_pk_add_f32 v[24:25], v[24:25], v[26:27]
    v_pk_add_f32 v[24:25], v[24:25], v[28:29]
    v_mul_f32 v24, 0x3ae38e39, v24
    v_mul_f32 v25, 0x3ae38e39, v25
    v_fma_f32 v25, -v24, v24, v25
    v_max_f32 v25, 0, v25
    v_cvt_pk_bf16_f32 v25, v25, v25
    v_lshlrev_b32 v25, 16, v25
    v_add_f32 v25, 0x3727c5ac, v25
    v_cvt_pk_bf16_f32 v25, v25, v25
    v_lshlrev_b32 v25, 16, v25
    v_sqrt_f32 v25, v25
    s_nop 0
    v_cvt_pk_bf16_f32 v25, v25, v25
    v_lshlrev_b32 v25, 16, v25
    v_rcp_f32 v25, v25
    v_cvt_pk_bf16_f32 v24, v24, v24
    v_lshlrev_b32 v24, 16, v24
    v_sub_f32 v16, v16, v24
    v_sub_f32 v17, v17, v24
    v_sub_f32 v18, v18, v24
    v_sub_f32 v19, v19, v24
    v_cvt_pk_bf16_f32 v12, v16, v17
    v_cvt_pk_bf16_f32 v13, v18, v19
    v_lshlrev_b32 v16, 16, v12
    v_and_b32 v17, s100, v12
    v_lshlrev_b32 v18, 16, v13
    v_and_b32 v19, s100, v13
    v_mul_f32 v16, v16, v25
    v_mul_f32 v17, v17, v25
    v_mul_f32 v18, v18, v25
    v_mul_f32 v19, v19, v25
    v_cvt_pk_bf16_f32 v12, v16, v17
    v_cvt_pk_bf16_f32 v13, v18, v19
    s_mov_b32 exec_lo, 0xffffffff
    s_mov_b32 exec_hi, 0xffff
    ds_write_b64 v59, v[12:13]
    s_mov_b64 exec, -1
    s_waitcnt lgkmcnt(0)
    s_barrier
    s_branch .cj_199
.c3_198:
    s_barrier
    s_barrier
.cj_199:
    v_bfe_u32 v28, v62, 3, 1
    v_and_b32 v24, 1, v63
    v_lshl_or_b32 v28, v24, 1, v28
    v_xor_b32 v28, s3, v28
    v_lshlrev_b32 v28, 5, v28
    v_and_b32 v24, 3, v62
    v_lshl_add_u32 v28, v24, 3, v28
    v_lshrrev_b32 v24, 2, v62
    v_lshl_add_u32 v24, v63, 3, v24
    v_lshl_add_u32 v24, v24, 7, v28
    v_add_u32 v25, 0x10000, v24
    v_add_u32 v26, 0x20000, v24
    v_lshlrev_b32 v27, 4, v63
    v_add_u32 v27, 147456, v27
    s_lshl_b32 s4, s63, 7
    s_lshl_b32 s83, s3, 5
    s_add_u32 s4, s4, s83
    s_add_u32 s4, s4, s89
    s_add_u32 s4, s4, 614400
    v_mul_u32_u24 v28, 9216, v62
    v_lshl_add_u32 v28, v63, 3, v28
    s_mov_b32 s12, 0x22222222
    s_mov_b32 s13, 0x22222222
    s_mov_b32 s14, 0x44444444
    s_mov_b32 s15, 0x44444444
    s_mov_b32 s16, 0x88888888
    s_mov_b32 s17, 0x88888888
    s_waitcnt lgkmcnt(0)
    ds_read_b128 v[2:5], v27 offset:0
    ds_read_b128 v[16:19], v27 offset:64
    ds_read_b128 v[20:23], v27 offset:128
    ds_read_b128 v[56:59], v27 offset:192
    s_waitcnt lgkmcnt(3)
    v_mfma_f32_16x16x32_bf16 v[8:11], a[192:195], v[2:5], 0
    ds_read_b64_tr_b16 a[192:193], v24 offset:20480
    ds_read_b64_tr_b16 a[194:195], v24 offset:20992
    v_mfma_f32_16x16x32_bf16 v[12:15], a[196:199], v[2:5], 0
    ds_read_b64_tr_b16 a[196:197], v25 offset:28672
    ds_read_b64_tr_b16 a[198:199], v25 offset:29184
    ds_read_b128 v[2:5], v27 offset:256
    s_waitcnt lgkmcnt(7)
    v_mfma_f32_16x16x32_bf16 v[8:11], a[200:203], v[16:19], v[8:11]
    ds_read_b64_tr_b16 a[200:201], v24 offset:24576
    ds_read_b64_tr_b16 a[202:203], v24 offset:25088
    v_mfma_f32_16x16x32_bf16 v[12:15], a[204:207], v[16:19], v[12:15]
    ds_read_b64_tr_b16 a[204:205], v25 offset:32768
    ds_read_b64_tr_b16 a[206:207], v25 offset:33280
    ds_read_b128 v[16:19], v27 offset:320
    s_waitcnt lgkmcnt(11)
    v_mfma_f32_16x16x32_bf16 v[8:11], a[208:211], v[20:23], v[8:11]
    ds_read_b64_tr_b16 a[208:209], v24 offset:28672
    ds_read_b64_tr_b16 a[210:211], v24 offset:29184
    v_mfma_f32_16x16x32_bf16 v[12:15], a[212:215], v[20:23], v[12:15]
    ds_read_b64_tr_b16 a[212:213], v25 offset:36864
    ds_read_b64_tr_b16 a[214:215], v25 offset:37376
    ds_read_b128 v[20:23], v27 offset:384
    s_waitcnt lgkmcnt(15)
    v_mfma_f32_16x16x32_bf16 v[8:11], a[216:219], v[56:59], v[8:11]
    ds_read_b64_tr_b16 a[216:217], v24 offset:32768
    ds_read_b64_tr_b16 a[218:219], v24 offset:33280
    v_mfma_f32_16x16x32_bf16 v[12:15], a[220:223], v[56:59], v[12:15]
    ds_read_b64_tr_b16 a[220:221], v25 offset:40960
    ds_read_b64_tr_b16 a[222:223], v25 offset:41472
    ds_read_b128 v[56:59], v27 offset:448
    s_waitcnt lgkmcnt(15)
    v_mfma_f32_16x16x32_bf16 v[8:11], a[224:227], v[2:5], v[8:11]
    ds_read_b64_tr_b16 a[224:225], v24 offset:36864
    ds_read_b64_tr_b16 a[226:227], v24 offset:37376
    v_mfma_f32_16x16x32_bf16 v[12:15], a[228:231], v[2:5], v[12:15]
    ds_read_b64_tr_b16 a[228:229], v25 offset:45056
    ds_read_b64_tr_b16 a[230:231], v25 offset:45568
    ds_read_b128 v[2:5], v27 offset:512
    s_waitcnt lgkmcnt(15)
    v_mfma_f32_16x16x32_bf16 v[8:11], a[192:195], v[16:19], v[8:11]
    ds_read_b64_tr_b16 a[192:193], v24 offset:40960
    ds_read_b64_tr_b16 a[194:195], v24 offset:41472
    v_mfma_f32_16x16x32_bf16 v[12:15], a[196:199], v[16:19], v[12:15]
    ds_read_b64_tr_b16 a[196:197], v25 offset:49152
    ds_read_b64_tr_b16 a[198:199], v25 offset:49664
    ds_read_b128 v[16:19], v27 offset:576
    s_waitcnt lgkmcnt(15)
    v_mfma_f32_16x16x32_bf16 v[8:11], a[200:203], v[20:23], v[8:11]
    ds_read_b64_tr_b16 a[200:201], v24 offset:45056
    ds_read_b64_tr_b16 a[202:203], v24 offset:45568
    v_mfma_f32_16x16x32_bf16 v[12:15], a[204:207], v[20:23], v[12:15]
    ds_read_b64_tr_b16 a[204:205], v25 offset:53248
    ds_read_b64_tr_b16 a[206:207], v25 offset:53760
    ds_read_b128 v[20:23], v27 offset:640
    s_waitcnt lgkmcnt(15)
    v_mfma_f32_16x16x32_bf16 v[8:11], a[208:211], v[56:59], v[8:11]
    ds_read_b64_tr_b16 a[208:209], v24 offset:49152
    ds_read_b64_tr_b16 a[210:211], v24 offset:49664
    v_mfma_f32_16x16x32_bf16 v[12:15], a[212:215], v[56:59], v[12:15]
    ds_read_b64_tr_b16 a[212:213], v25 offset:57344
    ds_read_b64_tr_b16 a[214:215], v25 offset:57856
    ds_read_b128 v[56:59], v27 offset:704
    s_waitcnt lgkmcnt(15)
    v_mfma_f32_16x16x32_bf16 v[8:11], a[216:219], v[2:5], v[8:11]
    ds_read_b64_tr_b16 a[216:217], v24 offset:53248
    ds_read_b64_tr_b16 a[218:219], v24 offset:53760
    v_mfma_f32_16x16x32_bf16 v[12:15], a[220:223], v[2:5], v[12:15]
    ds_read_b64_tr_b16 a[220:221], v25 offset:61440
    ds_read_b64_tr_b16 a[222:223], v25 offset:61952
    ds_read_b128 v[2:5], v27 offset:768
    s_waitcnt lgkmcnt(15)
    v_mfma_f32_16x16x32_bf16 v[8:11], a[224:227], v[16:19], v[8:11]
    ds_read_b64_tr_b16 a[224:225], v24 offset:57344
    ds_read_b64_tr_b16 a[226:227], v24 offset:57856
    v_mfma_f32_16x16x32_bf16 v[12:15], a[228:231], v[16:19], v[12:15]
    ds_read_b64_tr_b16 a[228:229], v26 offset:0
    ds_read_b64_tr_b16 a[230:231], v26 offset:512
    ds_read_b128 v[16:19], v27 offset:832
    s_waitcnt lgkmcnt(15)
    v_mfma_f32_16x16x32_bf16 v[8:11], a[192:195], v[20:23], v[8:11]
    ds_read_b64_tr_b16 a[192:193], v24 offset:61440
    ds_read_b64_tr_b16 a[194:195], v24 offset:61952
    v_mfma_f32_16x16x32_bf16 v[12:15], a[196:199], v[20:23], v[12:15]
    ds_read_b64_tr_b16 a[196:197], v26 offset:4096
    ds_read_b64_tr_b16 a[198:199], v26 offset:4608
    ds_read_b128 v[20:23], v27 offset:896
    s_waitcnt lgkmcnt(15)
    v_mfma_f32_16x16x32_bf16 v[8:11], a[200:203], v[56:59], v[8:11]
    ds_read_b64_tr_b16 a[200:201], v25 offset:0
    ds_read_b64_tr_b16 a[202:203], v25 offset:512
    v_mfma_f32_16x16x32_bf16 v[12:15], a[204:207], v[56:59], v[12:15]
    ds_read_b64_tr_b16 a[204:205], v26 offset:8192
    ds_read_b64_tr_b16 a[206:207], v26 offset:8704
    ds_read_b128 v[56:59], v27 offset:960
    s_waitcnt lgkmcnt(15)
    v_mfma_f32_16x16x32_bf16 v[8:11], a[208:211], v[2:5], v[8:11]
    ds_read_b64_tr_b16 a[208:209], v25 offset:4096
    ds_read_b64_tr_b16 a[210:211], v25 offset:4608
    v_mfma_f32_16x16x32_bf16 v[12:15], a[212:215], v[2:5], v[12:15]
    ds_read_b64_tr_b16 a[212:213], v26 offset:12288
    ds_read_b64_tr_b16 a[214:215], v26 offset:12800
    ds_read_b128 v[2:5], v27 offset:1024
    s_waitcnt lgkmcnt(15)
    v_mfma_f32_16x16x32_bf16 v[8:11], a[216:219], v[16:19], v[8:11]
    v_mfma_f32_16x16x32_bf16 v[12:15], a[220:223], v[16:19], v[12:15]
    ds_read_b128 v[16:19], v27 offset:1088
    s_waitcnt lgkmcnt(11)
    v_mfma_f32_16x16x32_bf16 v[8:11], a[224:227], v[20:23], v[8:11]
    v_mfma_f32_16x16x32_bf16 v[12:15], a[228:231], v[20:23], v[12:15]
    s_waitcnt lgkmcnt(6)
    v_mfma_f32_16x16x32_bf16 v[8:11], a[192:195], v[56:59], v[8:11]
    v_mfma_f32_16x16x32_bf16 v[12:15], a[196:199], v[56:59], v[12:15]
    s_waitcnt lgkmcnt(1)
    v_mfma_f32_16x16x32_bf16 v[8:11], a[200:203], v[2:5], v[8:11]
    v_mfma_f32_16x16x32_bf16 v[12:15], a[204:207], v[2:5], v[12:15]
    s_waitcnt lgkmcnt(0)
    v_mfma_f32_16x16x32_bf16 v[8:11], a[208:211], v[16:19], v[8:11]
    v_mfma_f32_16x16x32_bf16 v[12:15], a[212:215], v[16:19], v[12:15]
    s_nop 6
    v_cndmask_b32 v8, v8, v9, s[12:13]
    v_cndmask_b32 v8, v8, v10, s[14:15]
    v_cndmask_b32 v8, v8, v11, s[16:17]
    v_cndmask_b32 v12, v12, v13, s[12:13]
    v_cndmask_b32 v12, v12, v14, s[14:15]
    v_cndmask_b32 v12, v12, v15, s[16:17]
    v_cvt_pk_bf16_f32 v8, v8, v8
    v_lshlrev_b32 v8, 16, v8
    v_cvt_pk_bf16_f32 v12, v12, v12
    v_lshlrev_b32 v12, 16, v12
    v_mul_f32 v16, v8, v8
    v_mul_f32 v16, 0xbdd2d3e8, v16
    v_add_f32 v16, 0xc0135761, v16
    v_mul_f32 v16, v16, v8
    v_exp_f32 v16, v16
    s_nop 0
    v_add_f32 v16, 1.0, v16
    v_rcp_f32 v16, v16
    s_nop 0
    v_mul_f32 v16, v16, v8
    v_cvt_pk_bf16_f32 v16, v16, v16
    v_lshlrev_b32 v16, 16, v16
    v_mul_f32 v16, v16, v12
    s_nop 1
    v_mov_b32_dpp v20, v16 quad_perm:[0,0,0,0] row_mask:0xf bank_mask:0xf
    v_mov_b32_dpp v21, v16 quad_perm:[1,1,1,1] row_mask:0xf bank_mask:0xf
    v_mov_b32_dpp v22, v16 quad_perm:[2,2,2,2] row_mask:0xf bank_mask:0xf
    v_mov_b32_dpp v23, v16 quad_perm:[3,3,3,3] row_mask:0xf bank_mask:0xf
    v_cvt_pk_bf16_f32 v18, v20, v21
    v_cvt_pk_bf16_f32 v19, v22, v23
    s_mov_b32 exec_lo, 0x1ff01ff
    s_mov_b32 exec_hi, 0x1ff01ff
    buffer_store_dwordx2 v[18:19], v28, s[36:39], s4 offen sc1
    s_mov_b64 exec, -1
.skC_194:
    s_cmp_lt_u32 s60, 72
    s_cbranch_scc1 .skD_203
    s_cmp_ge_u32 s60, 144
    s_cbranch_scc1 .skD_203
    s_cmp_lg_u32 s89, 0
    s_cbranch_scc1 .lwd_205
    s_lshr_b32 s83, s74, 3
    v_bfe_u32 v10, v0, 1, 2
    v_bfe_u32 v58, v0, 4, 1
    v_xor_b32 v10, v10, v58
    v_lshlrev_b32 v10, 5, v10
    v_and_b32 v58, 1, v0
    v_lshl_add_u32 v10, v58, 4, v10
    v_lshrrev_b32 v58, 3, v0
    v_mul_u32_u24 v58, s83, v58
    v_add_u32 v58, v58, v10
    v_xor_b32 v59, 64, v58
    s_mov_b32 s22, 5
    s_nop 0
.lw_204:
    s_cmp_lg_u32 s68, 0
    s_cbranch_scc1 .wgo_206
    s_mov_b64 s[52:53], s[56:57]
    s_mov_b32 s54, s58
    s_mov_b32 s66, s69
    s_mov_b32 s67, s70
    s_mov_b32 s68, s71
.wgo_206:
    s_mov_b32 m0, s67
    s_nop 0
    buffer_load_dwordx4 v58, s[52:55], s66 offen nt lds
    s_add_u32 s66, s66, s74
    s_add_u32 m0, s67, 1024
    s_nop 0
    buffer_load_dwordx4 v59, s[52:55], s66 offen nt lds
    s_add_u32 s66, s66, s74
    s_add_u32 s67, s67, 2048
    s_sub_u32 s68, s68, 1
    s_sub_u32 s22, s22, 1
    s_cmp_lg_u32 s22, 0
    s_cbranch_scc1 .lw_204
    s_waitcnt vmcnt(0)
    s_barrier
.lwd_205:
    v_bfe_u32 v28, v62, 3, 1
    v_and_b32 v24, 1, v63
    v_lshl_or_b32 v28, v24, 1, v28
    v_xor_b32 v28, s3, v28
    v_lshlrev_b32 v28, 5, v28
    v_and_b32 v24, 3, v62
    v_lshl_add_u32 v28, v24, 3, v28
    v_lshrrev_b32 v24, 2, v62
    v_lshl_add_u32 v24, v63, 3, v24
    v_lshl_add_u32 v24, v24, 7, v28
    v_add_u32 v25, 0x10000, v24
    ds_read_b64_tr_b16 a[192:193], v24 offset:32768
    ds_read_b64_tr_b16 a[194:195], v24 offset:33280
    ds_read_b64_tr_b16 a[196:197], v24 offset:36864
    ds_read_b64_tr_b16 a[198:199], v24 offset:37376
    ds_read_b64_tr_b16 a[200:201], v24 offset:40960
    ds_read_b64_tr_b16 a[202:203], v24 offset:41472
    ds_read_b64_tr_b16 a[204:205], v24 offset:45056
    ds_read_b64_tr_b16 a[206:207], v24 offset:45568
    ds_read_b64_tr_b16 a[208:209], v24 offset:49152
    ds_read_b64_tr_b16 a[210:211], v24 offset:49664
    ds_read_b64_tr_b16 a[212:213], v24 offset:53248
    ds_read_b64_tr_b16 a[214:215], v24 offset:53760
    ds_read_b64_tr_b16 a[216:217], v24 offset:57344
    ds_read_b64_tr_b16 a[218:219], v24 offset:57856
    ds_read_b64_tr_b16 a[220:221], v24 offset:61440
    ds_read_b64_tr_b16 a[222:223], v24 offset:61952
    ds_read_b64_tr_b16 a[224:225], v25 offset:0
    ds_read_b64_tr_b16 a[226:227], v25 offset:512
    ds_read_b64_tr_b16 a[228:229], v25 offset:4096
    ds_read_b64_tr_b16 a[230:231], v25 offset:4608
    s_mul_i32 s4, s65, 9216
    s_mul_i32 s83, s64, 1152
    s_add_u32 s4, s4, s83
    s_add_u32 s4, s4, s89
    s_add_u32 s4, s4, 614400
    v_lshlrev_b32 v28, 4, v0
    v_min_u32 v29, 7, v0
    v_lshlrev_b32 v29, 4, v29
    s_mul_i32 s83, s3, 1280
    s_add_u32 s83, s83, 149248
    v_add_u32 v30, s83, v28
    v_add_u32 v31, s83, v29
    v_lshlrev_b32 v27, 4, v63
    v_add_u32 v27, s83, v27
    s_lshl_b32 s5, s65, 3
    s_add_u32 s5, s5, s64
    s_lshl_b32 s5, s5, 8
    s_lshl_b32 s83, s3, 6
    s_add_u32 s5, s5, s83
    s_add_u32 s5, s5, s89
    s_add_u32 s5, s5, 697344
    v_mul_u32_u24 v32, 18432, v62
    v_lshl_add_u32 v32, v63, 4, v32
    s_mov_b32 s88, 200000
    buffer_load_dwordx4 v[36:39], v28, s[36:39], s4 offen sc1
    buffer_load_dwordx4 v[40:43], v29, s[36:39], s4 offen offset:1024 sc1
.mp_207:
    s_waitcnt vmcnt(0)
    v_max3_u32 v33, v36, v37, v38
    v_max3_u32 v34, v39, v40, v41
    v_max3_u32 v33, v33, v42, v43
    v_max_u32 v33, v33, v34
    v_cmp_eq_u32 vcc, -1, v33
    s_nop 4
    s_cbranch_vccz .mpk_209
    s_mov_b64 exec, vcc
    buffer_load_dwordx4 v[36:39], v28, s[36:39], s4 offen sc1
    buffer_load_dwordx4 v[40:43], v29, s[36:39], s4 offen offset:1024 sc1
    s_mov_b64 exec, -1
    s_sub_u32 s88, s88, 1
    s_cmp_lg_u32 s88, 0
    s_cbranch_scc1 .mp_207
.mpk_209:
    ds_write_b128 v30, v[36:39]
    ds_write_b128 v31, v[40:43] offset:1024
.mpj_208:
    s_waitcnt lgkmcnt(0)
    ds_read_b128 v[2:5], v27 offset:0
    ds_read_b128 v[16:19], v27 offset:64
    ds_read_b128 v[20:23], v27 offset:128
    ds_read_b128 v[56:59], v27 offset:192
    s_waitcnt lgkmcnt(3)
    v_mfma_f32_16x16x32_bf16 v[8:11], a[192:195], v[2:5], 0
    ds_read_b64_tr_b16 a[192:193], v25 offset:8192
    ds_read_b64_tr_b16 a[194:195], v25 offset:8704
    ds_read_b128 v[2:5], v27 offset:256
    s_waitcnt lgkmcnt(5)
    v_mfma_f32_16x16x32_bf16 v[8:11], a[196:199], v[16:19], v[8:11]
    ds_read_b64_tr_b16 a[196:197], v25 offset:12288
    ds_read_b64_tr_b16 a[198:199], v25 offset:12800
    ds_read_b128 v[16:19], v27 offset:320
    s_waitcnt lgkmcnt(7)
    v_mfma_f32_16x16x32_bf16 v[8:11], a[200:203], v[20:23], v[8:11]
    ds_read_b64_tr_b16 a[200:201], v25 offset:16384
    ds_read_b64_tr_b16 a[202:203], v25 offset:16896
    ds_read_b128 v[20:23], v27 offset:384
    s_waitcnt lgkmcnt(9)
    v_mfma_f32_16x16x32_bf16 v[8:11], a[204:207], v[56:59], v[8:11]
    ds_read_b64_tr_b16 a[204:205], v25 offset:20480
    ds_read_b64_tr_b16 a[206:207], v25 offset:20992
    ds_read_b128 v[56:59], v27 offset:448
    s_waitcnt lgkmcnt(9)
    v_mfma_f32_16x16x32_bf16 v[8:11], a[208:211], v[2:5], v[8:11]
    ds_read_b64_tr_b16 a[208:209], v25 offset:24576
    ds_read_b64_tr_b16 a[210:211], v25 offset:25088
    ds_read_b128 v[2:5], v27 offset:512
    s_waitcnt lgkmcnt(9)
    v_mfma_f32_16x16x32_bf16 v[8:11], a[212:215], v[16:19], v[8:11]
    ds_read_b64_tr_b16 a[212:213], v25 offset:28672
    ds_read_b64_tr_b16 a[214:215], v25 offset:29184
    ds_read_b128 v[16:19], v27 offset:576
    s_waitcnt lgkmcnt(9)
    v_mfma_f32_16x16x32_bf16 v[8:11], a[216:219], v[20:23], v[8:11]
    ds_read_b64_tr_b16 a[216:217], v25 offset:32768
    ds_read_b64_tr_b16 a[218:219], v25 offset:33280
    ds_read_b128 v[20:23], v27 offset:640
    s_waitcnt lgkmcnt(9)
    v_mfma_f32_16x16x32_bf16 v[8:11], a[220:223], v[56:59], v[8:11]
    ds_read_b64_tr_b16 a[220:221], v25 offset:36864
    ds_read_b64_tr_b16 a[222:223], v25 offset:37376
    ds_read_b128 v[56:59], v27 offset:704
    s_waitcnt lgkmcnt(9)
    v_mfma_f32_16x16x32_bf16 v[8:11], a[224:227], v[2:5], v[8:11]
    ds_read_b128 v[2:5], v27 offset:768
    s_waitcnt lgkmcnt(7)
    v_mfma_f32_16x16x32_bf16 v[8:11], a[228:231], v[16:19], v[8:11]
    ds_read_b128 v[16:19], v27 offset:832
    s_waitcnt lgkmcnt(5)
    v_mfma_f32_16x16x32_bf16 v[8:11], a[192:195], v[20:23], v[8:11]
    ds_read_b128 v[20:23], v27 offset:896
    s_waitcnt lgkmcnt(3)
    v_mfma_f32_16x16x32_bf16 v[8:11], a[196:199], v[56:59], v[8:11]
    ds_read_b128 v[56:59], v27 offset:960
    s_waitcnt lgkmcnt(3)
    v_mfma_f32_16x16x32_bf16 v[8:11], a[200:203], v[2:5], v[8:11]
    ds_read_b128 v[2:5], v27 offset:1024
    s_waitcnt lgkmcnt(3)
    v_mfma_f32_16x16x32_bf16 v[8:11], a[204:207], v[16:19], v[8:11]
    ds_read_b128 v[16:19], v27 offset:1088
    s_waitcnt lgkmcnt(3)
    v_mfma_f32_16x16x32_bf16 v[8:11], a[208:211], v[20:23], v[8:11]
    s_waitcnt lgkmcnt(2)
    v_mfma_f32_16x16x32_bf16 v[8:11], a[212:215], v[56:59], v[8:11]
    s_waitcnt lgkmcnt(1)
    v_mfma_f32_16x16x32_bf16 v[8:11], a[216:219], v[2:5], v[8:11]
    s_waitcnt lgkmcnt(0)
    v_mfma_f32_16x16x32_bf16 v[8:11], a[220:223], v[16:19], v[8:11]
    s_mov_b32 exec_lo, 0xff00ff
    s_mov_b32 exec_hi, 0xff00ff
    s_nop 5
    buffer_store_dwordx4 v[8:11], v32, s[36:39], s5 offen sc1
    s_mov_b64 exec, -1
    s_nop 0
.skD_203:
    s_cmp_eq_u32 s89, 0
    s_cselect_b32 s83, 64, 1
    s_cmp_ge_u32 s60, s83
    s_cbranch_scc1 .skE_210
    s_cmp_lg_u32 s89, 0
    s_cbranch_scc1 .np_212
    v_bfe_u32 v1, v62, 3, 1
    v_and_b32 v5, 1, v63
    v_lshl_or_b32 v1, v5, 1, v1
    v_xor_b32 v1, s3, v1
    v_lshlrev_b32 v1, 5, v1
    v_and_b32 v5, 3, v62
    v_lshl_add_u32 v1, v5, 3, v1
    v_lshrrev_b32 v5, 2, v62
    v_lshl_add_u32 v5, v63, 3, v5
    v_lshl_add_u32 v5, v5, 7, v1
    v_add_u32 v6, 0x10000, v5
    ds_read_b64_tr_b16 a[192:193], v5 offset:32768
    ds_read_b64_tr_b16 a[194:195], v5 offset:33280
    ds_read_b64_tr_b16 a[196:197], v5 offset:36864
    ds_read_b64_tr_b16 a[198:199], v5 offset:37376
    ds_read_b64_tr_b16 a[200:201], v5 offset:40960
    ds_read_b64_tr_b16 a[202:203], v5 offset:41472
    ds_read_b64_tr_b16 a[204:205], v5 offset:45056
    ds_read_b64_tr_b16 a[206:207], v5 offset:45568
    ds_read_b64_tr_b16 a[208:209], v5 offset:49152
    ds_read_b64_tr_b16 a[210:211], v5 offset:49664
    ds_read_b64_tr_b16 a[212:213], v5 offset:53248
    ds_read_b64_tr_b16 a[214:215], v5 offset:53760
    ds_read_b64_tr_b16 a[216:217], v5 offset:57344
    ds_read_b64_tr_b16 a[218:219], v5 offset:57856
    ds_read_b64_tr_b16 a[220:221], v5 offset:61440
    ds_read_b64_tr_b16 a[222:223], v5 offset:61952
    ds_read_b64_tr_b16 a[224:225], v6 offset:0
    ds_read_b64_tr_b16 a[226:227], v6 offset:512
    ds_read_b64_tr_b16 a[228:229], v6 offset:4096
    ds_read_b64_tr_b16 a[230:231], v6 offset:4608
.np_212:
    v_lshlrev_b32 v58, 4, v0
    v_min_u32 v59, 2, v63
    v_lshlrev_b32 v59, 7, v59
    v_lshl_add_u32 v59, v62, 3, v59
    s_cmp_eq_u32 s3, 3
    s_nop 0
    s_cbranch_scc1 .e3_213
    s_mul_i32 s4, s62, 9216
    s_lshl_b32 s83, s60, 7
    s_add_u32 s4, s4, s83
    s_add_u32 s4, s4, s89
    s_add_u32 s4, s4, 614400
    s_mov_b32 s88, 200000
    s_mov_b64 exec, 1
.pw_215:
    buffer_load_dword v60, off, s[36:39], s4 sc1
    s_waitcnt vmcnt(0)
    v_cmp_eq_u32 vcc, -1, v60
    s_nop 4
    s_cbranch_vccz .pwd_216
    s_sub_u32 s88, s88, 1
    s_cmp_lg_u32 s88, 0
    s_cbranch_scc1 .pw_215
.pwd_216:
    s_mov_b64 exec, -1
    s_and_b32 s4, s60, 7
    s_mul_i32 s4, s4, 18432
    s_mul_i32 s83, s3, 6144
    s_add_u32 s4, s4, s83
    s_add_u32 s4, s4, s89
    s_add_u32 s4, s4, 697344
    s_add_u32 s5, s4, 4096
    s_add_u32 s6, s4, 8192
    s_and_b32 s83, s60, 15
    s_mul_i32 s83, s83, 1280
    s_mul_i32 s84, s3, 384
    s_add_u32 s83, s83, s84
    s_add_u32 s18, s83, s89
    s_add_u32 s18, s18, 593920
    s_add_u32 s7, s83, 844800
    s_cmp_lt_u32 s60, 16
    s_cselect_b32 s7, s7, -1
    s_mov_b32 s88, 200000
.gX_217:
    buffer_load_dwordx4 v[8:11], v58, s[36:39], s4 offen offset:0 sc1
    buffer_load_dwordx4 v[12:15], v58, s[36:39], s4 offen offset:1024 sc1
    buffer_load_dwordx4 v[16:19], v58, s[36:39], s4 offen offset:2048 sc1
    buffer_load_dwordx4 v[20:23], v58, s[36:39], s4 offen offset:3072 sc1
    buffer_load_dwordx4 v[24:27], v58, s[36:39], s5 offen offset:0 sc1
    buffer_load_dwordx4 v[28:31], v58, s[36:39], s5 offen offset:1024 sc1
    buffer_load_dwordx2 v[56:57], v59, s[36:39], s18 offen sc1
    s_waitcnt vmcnt(0)
    v_pk_add_f32 v[8:9], v[8:9], v[12:13]
    v_pk_add_f32 v[10:11], v[10:11], v[14:15]
    v_pk_add_f32 v[16:17], v[16:17], v[20:21]
    v_pk_add_f32 v[18:19], v[18:19], v[22:23]
    v_pk_add_f32 v[24:25], v[24:25], v[28:29]
    v_pk_add_f32 v[26:27], v[26:27], v[30:31]
    v_pk_add_f32 v[2:3], v[8:9], v[10:11]
    v_pk_add_f32 v[4:5], v[16:17], v[18:19]
    v_pk_add_f32 v[2:3], v[2:3], v[24:25]
    v_pk_add_f32 v[4:5], v[4:5], v[26:27]
    v_pk_add_f32 v[2:3], v[2:3], v[56:57]
    v_pk_add_f32 v[2:3], v[2:3], v[4:5]
    v_add_f32 v60, v2, v3
    v_cmp_u_f32 vcc, v60, v60
    s_nop 4
    s_cbranch_vccz .gXd_218
    s_mov_b64 exec, vcc
    s_sub_u32 s88, s88, 1
    s_cmp_lg_u32 s88, 0
    s_cbranch_scc1 .gX_217
.gXd_218:
    s_mov_b64 exec, -1
    s_cmp_lg_u32 s89, 0
    s_cbranch_scc1 .fin_211
    v_mov_b32 v12, v24
    v_mov_b32 v13, v25
    v_mov_b32 v14, v26
    v_mov_b32 v15, v27
    v_permlane16_swap_b32 v8, v16
    v_permlane16_swap_b32 v9, v17
    v_permlane16_swap_b32 v10, v18
    v_permlane16_swap_b32 v11, v19
    v_permlane16_swap_b32 v24, v12
    v_permlane16_swap_b32 v25, v13
    v_permlane16_swap_b32 v26, v14
    v_permlane16_swap_b32 v27, v15
    v_pk_add_f32 v[8:9], v[8:9], v[16:17]
    v_pk_add_f32 v[10:11], v[10:11], v[18:19]
    v_pk_add_f32 v[24:25], v[24:25], v[12:13]
    v_pk_add_f32 v[26:27], v[26:27], v[14:15]
    s_nop 0
    v_permlane32_swap_b32 v8, v24
    v_permlane32_swap_b32 v9, v25
    v_permlane32_swap_b32 v10, v26
    v_permlane32_swap_b32 v11, v27
    v_pk_add_f32 v[8:9], v[8:9], v[24:25]
    v_pk_add_f32 v[10:11], v[10:11], v[26:27]
    v_cvt_pk_bf16_f32 v12, v8, v9
    v_cvt_pk_bf16_f32 v13, v10, v11
    v_lshlrev_b32 v8, 16, v12
    v_and_b32 v9, s100, v12
    v_lshlrev_b32 v10, 16, v13
    v_and_b32 v11, s100, v13
    v_lshlrev_b32 v16, 16, v56
    v_and_b32 v17, s100, v56
    v_lshlrev_b32 v18, 16, v57
    v_and_b32 v19, s100, v57
    v_pk_add_f32 v[16:17], v[16:17], v[8:9]
    v_pk_add_f32 v[18:19], v[18:19], v[10:11]
    v_cvt_pk_bf16_f32 v12, v16, v17
    v_cvt_pk_bf16_f32 v13, v18, v19
    s_cmp_eq_u32 s7, -1
    s_nop 0
    s_cbranch_scc1 .nopub_219
    s_mov_b32 exec_lo, 0xffffffff
    s_mov_b32 exec_hi, 0xffff
    buffer_store_dwordx2 v[12:13], v59, s[36:39], s7 offen sc1
    s_mov_b64 exec, -1
.nopub_219:
    v_lshlrev_b32 v16, 16, v12
    v_and_b32 v17, s100, v12
    v_lshlrev_b32 v18, 16, v13
    v_and_b32 v19, s100, v13
    v_add_f32 v20, v16, v17
    v_mul_f32 v21, v16, v16
    v_add_f32 v20, v20, v18
    v_fmac_f32 v21, v17, v17
    v_add_f32 v20, v20, v19
    v_fmac_f32 v21, v18, v18
    v_fmac_f32 v21, v19, v19
    v_cmp_gt_u32 vcc, 48, v0
    s_nop 1
    v_cndmask_b32 v20, 0, v20, vcc
    v_cndmask_b32 v21, 0, v21, vcc
    s_nop 0
    v_add_f32_dpp v20, v20, v20 quad_perm:[1,0,3,2] row_mask:0xf bank_mask:0xf
    v_add_f32_dpp v21, v21, v21 quad_perm:[1,0,3,2] row_mask:0xf bank_mask:0xf
    s_nop 0
    v_add_f32_dpp v20, v20, v20 quad_perm:[2,3,0,1] row_mask:0xf bank_mask:0xf
    v_add_f32_dpp v21, v21, v21 quad_perm:[2,3,0,1] row_mask:0xf bank_mask:0xf
    s_nop 0
    v_add_f32_dpp v20, v20, v20 row_half_mirror row_mask:0xf bank_mask:0xf
    v_add_f32_dpp v21, v21, v21 row_half_mirror row_mask:0xf bank_mask:0xf
    s_nop 0
    v_add_f32_dpp v20, v20, v20 row_mirror row_mask:0xf bank_mask:0xf
    v_add_f32_dpp v21, v21, v21 row_mirror row_mask:0xf bank_mask:0xf
    v_mov_b32 v22, v20
    v_mov_b32 v23, v21
    s_nop 0
    v_permlane16_swap_b32 v20, v22
    v_permlane16_swap_b32 v21, v23
    v_add_f32 v20, v20, v22
    v_add_f32 v21, v21, v23
    v_mov_b32 v22, v20
    v_mov_b32 v23, v21
    s_nop 0
    v_permlane32_swap_b32 v20, v22
    v_permlane32_swap_b32 v21, v23
    v_add_f32 v20, v20, v22
    v_add_f32 v21, v21, v23
    s_lshl_b32 s83, s3, 3
    s_add_u32 s83, s83, 154368
    v_mov_b32 v22, s83
    v_mov_b32 v23, 154368
    s_mov_b64 exec, 1
    ds_write_b64 v22, v[20:21]
    s_mov_b64 exec, -1
    s_mul_i32 s83, s3, 384
    s_add_u32 s83, s83, 147456
    v_add_u32 v59, s83, v59
    s_waitcnt lgkmcnt(0)
    s_barrier
    ds_read_b128 v[24:27], v23
    ds_read_b64 v[28:29], v23 offset:16
    s_waitcnt lgkmcnt(0)
    v_pk_add_f32 v[24:25], v[24:25], v[26:27]
    v_pk_add_f32 v[24:25], v[24:25], v[28:29]
    v_mul_f32 v24, 0x3ae38e39, v24
    v_mul_f32 v25, 0x3ae38e39, v25
    v_fma_f32 v25, -v24, v24, v25
    v_max_f32 v25, 0, v25
    v_cvt_pk_bf16_f32 v25, v25, v25
    v_lshlrev_b32 v25, 16, v25
    v_add_f32 v25, 0x3727c5ac, v25
    v_cvt_pk_bf16_f32 v25, v25, v25
    v_lshlrev_b32 v25, 16, v25
    v_sqrt_f32 v25, v25
    s_nop 0
    v_cvt_pk_bf16_f32 v25, v25, v25
    v_lshlrev_b32 v25, 16, v25
    v_rcp_f32 v25, v25
    v_cvt_pk_bf16_f32 v24, v24, v24
    v_lshlrev_b32 v24, 16, v24
    v_sub_f32 v16, v16, v24
    v_sub_f32 v17, v17, v24
    v_sub_f32 v18, v18, v24
    v_sub_f32 v19, v19, v24
    v_cvt_pk_bf16_f32 v12, v16, v17
    v_cvt_pk_bf16_f32 v13, v18, v19
    v_lshlrev_b32 v16, 16, v12
    v_and_b32 v17, s100, v12
    v_lshlrev_b32 v18, 16, v13
    v_and_b32 v19, s100, v13
    v_mul_f32 v16, v16, v25
    v_mul_f32 v17, v17, v25
    v_mul_f32 v18, v18, v25
    v_mul_f32 v19, v19, v25
    v_cvt_pk_bf16_f32 v12, v16, v17
    v_cvt_pk_bf16_f32 v13, v18, v19
    s_mov_b32 exec_lo, 0xffffffff
    s_mov_b32 exec_hi, 0xffff
    ds_write_b64 v59, v[12:13]
    s_mov_b64 exec, -1
    s_waitcnt lgkmcnt(0)
    s_barrier
    s_branch .ej_214
.e3_213:
    s_cmp_lg_u32 s89, 0
    s_cbranch_scc1 .skE_210
    s_and_b32 s83, s60, 3
    s_cmp_lg_u32 s83, 0
    s_cbranch_scc1 .mds_220
    s_mov_b32 s88, 4
    s_mov_b64 exec, 1
.mdl_221:
    buffer_load_dword v8, off, s[48:51], 0 offset:64 sc1
    s_waitcnt vmcnt(0)
    v_readfirstlane_b32 s83, v8
    s_nop 0
    s_and_b32 s84, s83, 0xffff
    s_lshr_b32 s83, s83, 16
    s_add_u32 s85, s83, s84
    s_cmp_ge_u32 s85, 32
    s_cbranch_scc1 .mdd_222
    s_sub_u32 s88, s88, 1
    s_cmp_lg_u32 s88, 0
    s_cbranch_scc1 .mdl_221
.mdd_222:
    s_cmp_gt_u32 s83, s84
    s_cselect_b32 s83, 1, 0
    v_mov_b32 v8, s83
    s_lshr_b32 s84, s60, 2
    s_lshl_b32 s84, s84, 15
    s_add_u32 s84, s84, 1840128
    buffer_store_dword v8, off, s[36:39], s84 sc1
    s_mov_b64 exec, -1
.mds_220:
    s_barrier
    s_barrier
.ej_214:
    v_bfe_u32 v28, v62, 3, 1
    v_and_b32 v24, 1, v63
    v_lshl_or_b32 v28, v24, 1, v28
    v_xor_b32 v28, s3, v28
    v_lshlrev_b32 v28, 5, v28
    v_and_b32 v24, 3, v62
    v_lshl_add_u32 v28, v24, 3, v28
    v_lshrrev_b32 v24, 2, v62
    v_lshl_add_u32 v24, v63, 3, v24
    v_lshl_add_u32 v24, v24, 7, v28
    v_add_u32 v25, 0x10000, v24
    v_lshlrev_b32 v27, 4, v63
    v_add_u32 v27, 147456, v27
    s_lshr_b32 s4, s60, 2
    s_lshl_b32 s4, s4, 15
    s_and_b32 s83, s60, 3
    s_lshl_b32 s83, s83, 7
    s_add_u32 s4, s4, s83
    s_lshl_b32 s83, s3, 5
    s_add_u32 s4, s4, s83
    s_add_u32 s4, s4, 1835520
    v_lshlrev_b32 v28, 11, v62
    v_lshl_add_u32 v28, v63, 3, v28
    s_waitcnt lgkmcnt(0)
    ds_read_b128 v[2:5], v27 offset:0
    ds_read_b128 v[16:19], v27 offset:64
    ds_read_b128 v[20:23], v27 offset:128
    ds_read_b128 v[56:59], v27 offset:192
    s_waitcnt lgkmcnt(3)
    v_mfma_f32_16x16x32_bf16 v[8:11], a[192:195], v[2:5], 0
    ds_read_b64_tr_b16 a[192:193], v25 offset:8192
    ds_read_b64_tr_b16 a[194:195], v25 offset:8704
    ds_read_b128 v[2:5], v27 offset:256
    s_waitcnt lgkmcnt(5)
    v_mfma_f32_16x16x32_bf16 v[8:11], a[196:199], v[16:19], v[8:11]
    ds_read_b64_tr_b16 a[196:197], v25 offset:12288
    ds_read_b64_tr_b16 a[198:199], v25 offset:12800
    ds_read_b128 v[16:19], v27 offset:320
    s_waitcnt lgkmcnt(7)
    v_mfma_f32_16x16x32_bf16 v[8:11], a[200:203], v[20:23], v[8:11]
    ds_read_b64_tr_b16 a[200:201], v25 offset:16384
    ds_read_b64_tr_b16 a[202:203], v25 offset:16896
    ds_read_b128 v[20:23], v27 offset:384
    s_waitcnt lgkmcnt(9)
    v_mfma_f32_16x16x32_bf16 v[8:11], a[204:207], v[56:59], v[8:11]
    ds_read_b64_tr_b16 a[204:205], v25 offset:20480
    ds_read_b64_tr_b16 a[206:207], v25 offset:20992
    ds_read_b128 v[56:59], v27 offset:448
    s_waitcnt lgkmcnt(9)
    v_mfma_f32_16x16x32_bf16 v[8:11], a[208:211], v[2:5], v[8:11]
    ds_read_b64_tr_b16 a[208:209], v25 offset:24576
    ds_read_b64_tr_b16 a[210:211], v25 offset:25088
    ds_read_b128 v[2:5], v27 offset:512
    s_waitcnt lgkmcnt(9)
    v_mfma_f32_16x16x32_bf16 v[8:11], a[212:215], v[16:19], v[8:11]
    ds_read_b64_tr_b16 a[212:213], v25 offset:28672
    ds_read_b64_tr_b16 a[214:215], v25 offset:29184
    ds_read_b128 v[16:19], v27 offset:576
    s_waitcnt lgkmcnt(9)
    v_mfma_f32_16x16x32_bf16 v[8:11], a[216:219], v[20:23], v[8:11]
    ds_read_b64_tr_b16 a[216:217], v25 offset:32768
    ds_read_b64_tr_b16 a[218:219], v25 offset:33280
    ds_read_b128 v[20:23], v27 offset:640
    s_waitcnt lgkmcnt(9)
    v_mfma_f32_16x16x32_bf16 v[8:11], a[220:223], v[56:59], v[8:11]
    ds_read_b64_tr_b16 a[220:221], v25 offset:36864
    ds_read_b64_tr_b16 a[222:223], v25 offset:37376
    ds_read_b128 v[56:59], v27 offset:704
    s_waitcnt lgkmcnt(9)
    v_mfma_f32_16x16x32_bf16 v[8:11], a[224:227], v[2:5], v[8:11]
    ds_read_b128 v[2:5], v27 offset:768
    s_waitcnt lgkmcnt(7)
    v_mfma_f32_16x16x32_bf16 v[8:11], a[228:231], v[16:19], v[8:11]
    ds_read_b128 v[16:19], v27 offset:832
    s_waitcnt lgkmcnt(5)
    v_mfma_f32_16x16x32_bf16 v[8:11], a[192:195], v[20:23], v[8:11]
    ds_read_b128 v[20:23], v27 offset:896
    s_waitcnt lgkmcnt(3)
    v_mfma_f32_16x16x32_bf16 v[8:11], a[196:199], v[56:59], v[8:11]
    ds_read_b128 v[56:59], v27 offset:960
    s_waitcnt lgkmcnt(3)
    v_mfma_f32_16x16x32_bf16 v[8:11], a[200:203], v[2:5], v[8:11]
    ds_read_b128 v[2:5], v27 offset:1024
    s_waitcnt lgkmcnt(3)
    v_mfma_f32_16x16x32_bf16 v[8:11], a[204:207], v[16:19], v[8:11]
    ds_read_b128 v[16:19], v27 offset:1088
    s_waitcnt lgkmcnt(3)
    v_mfma_f32_16x16x32_bf16 v[8:11], a[208:211], v[20:23], v[8:11]
    s_waitcnt lgkmcnt(2)
    v_mfma_f32_16x16x32_bf16 v[8:11], a[212:215], v[56:59], v[8:11]
    s_waitcnt lgkmcnt(1)
    v_mfma_f32_16x16x32_bf16 v[8:11], a[216:219], v[2:5], v[8:11]
    s_waitcnt lgkmcnt(0)
    v_mfma_f32_16x16x32_bf16 v[8:11], a[220:223], v[16:19], v[8:11]
    s_nop 7
    v_cvt_pk_bf16_f32 v18, v8, v9
    v_cvt_pk_bf16_f32 v19, v10, v11
    buffer_store_dwordx2 v[18:19], v28, s[36:39], s4 offen sc1
    s_nop 0
    s_branch .skE_210
.fin_211:
    v_mov_b32 v12, v24
    v_mov_b32 v13, v25
    v_mov_b32 v14, v26
    v_mov_b32 v15, v27
    v_permlane16_swap_b32 v8, v16
    v_permlane16_swap_b32 v9, v17
    v_permlane16_swap_b32 v10, v18
    v_permlane16_swap_b32 v11, v19
    v_permlane16_swap_b32 v24, v12
    v_permlane16_swap_b32 v25, v13
    v_permlane16_swap_b32 v26, v14
    v_permlane16_swap_b32 v27, v15
    v_pk_add_f32 v[8:9], v[8:9], v[16:17]
    v_pk_add_f32 v[10:11], v[10:11], v[18:19]
    v_pk_add_f32 v[24:25], v[24:25], v[12:13]
    v_pk_add_f32 v[26:27], v[26:27], v[14:15]
    s_nop 0
    v_permlane32_swap_b32 v8, v24
    v_permlane32_swap_b32 v9, v25
    v_permlane32_swap_b32 v10, v26
    v_permlane32_swap_b32 v11, v27
    v_pk_add_f32 v[8:9], v[8:9], v[24:25]
    v_pk_add_f32 v[10:11], v[10:11], v[26:27]
    v_cvt_pk_bf16_f32 v12, v8, v9
    v_cvt_pk_bf16_f32 v13, v10, v11
    v_lshlrev_b32 v8, 16, v12
    v_and_b32 v9, s100, v12
    v_lshlrev_b32 v10, 16, v13
    v_and_b32 v11, s100, v13
    v_lshlrev_b32 v16, 16, v56
    v_and_b32 v17, s100, v56
    v_lshlrev_b32 v18, 16, v57
    v_and_b32 v19, s100, v57
    v_pk_add_f32 v[16:17], v[16:17], v[8:9]
    v_pk_add_f32 v[18:19], v[18:19], v[10:11]
    v_cvt_pk_bf16_f32 v12, v16, v17
    v_cvt_pk_bf16_f32 v13, v18, v19
    s_mov_b32 exec_lo, 0xffffffff
    s_mov_b32 exec_hi, 0xffff
    s_mul_i32 s83, s3, 384
    buffer_store_dwordx2 v[12:13], v59, s[44:47], s83 offen
    s_mov_b64 exec, -1
.skE_210:
    s_setpc_b64 s[86:87]
.Lresc:
    v_max_f32 v7, v7, v6
    v_mov_b32 v52, v7
    s_nop 1
    v_permlane16_swap_b32 v7, v52
    v_max_f32 v7, v7, v52
    v_mov_b32 v52, v7
    s_nop 1
    v_permlane32_swap_b32 v7, v52
    v_max_f32 v7, v7, v52
    v_sub_f32 v52, v6, v7
    v_mul_f32 v52, s75, v52
    v_exp_f32 v52, v52
    v_mov_b32 v6, v7
    v_and_b32 v53, 1, v0
    v_mul_u32_u24 v53, 0xff, v53
    v_lshlrev_b32 v53, 23, v53
    v_fma_f32 v3, v6, s75, v53
    v_add_f32 v4, 0x427af233, v6
    v_add_f32 v4, v4, v53
    v_mul_f32 v5, v5, v52
    v_accvgpr_read_b32 v16, a192
    v_mul_f32 v16, v16, v52
    v_accvgpr_write_b32 a192, v16
    v_accvgpr_read_b32 v17, a193
    v_mul_f32 v17, v17, v52
    v_accvgpr_write_b32 a193, v17
    v_accvgpr_read_b32 v18, a194
    v_mul_f32 v18, v18, v52
    v_accvgpr_write_b32 a194, v18
    v_accvgpr_read_b32 v19, a195
    v_mul_f32 v19, v19, v52
    v_accvgpr_write_b32 a195, v19
    v_accvgpr_read_b32 v16, a196
    v_mul_f32 v16, v16, v52
    v_accvgpr_write_b32 a196, v16
    v_accvgpr_read_b32 v17, a197
    v_mul_f32 v17, v17, v52
    v_accvgpr_write_b32 a197, v17
    v_accvgpr_read_b32 v18, a198
    v_mul_f32 v18, v18, v52
    v_accvgpr_write_b32 a198, v18
    v_accvgpr_read_b32 v19, a199
    v_mul_f32 v19, v19, v52
    v_accvgpr_write_b32 a199, v19
    v_accvgpr_read_b32 v16, a200
    v_mul_f32 v16, v16, v52
    v_accvgpr_write_b32 a200, v16
    v_accvgpr_read_b32 v17, a201
    v_mul_f32 v17, v17, v52
    v_accvgpr_write_b32 a201, v17
    v_accvgpr_read_b32 v18, a202
    v_mul_f32 v18, v18, v52
    v_accvgpr_write_b32 a202, v18
    v_accvgpr_read_b32 v19, a203
    v_mul_f32 v19, v19, v52
    v_accvgpr_write_b32 a203, v19
    v_accvgpr_read_b32 v16, a204
    v_mul_f32 v16, v16, v52
    v_accvgpr_write_b32 a204, v16
    v_accvgpr_read_b32 v17, a205
    v_mul_f32 v17, v17, v52
    v_accvgpr_write_b32 a205, v17
    v_accvgpr_read_b32 v18, a206
    v_mul_f32 v18, v18, v52
    v_accvgpr_write_b32 a206, v18
    v_accvgpr_read_b32 v19, a207
    v_mul_f32 v19, v19, v52
    v_accvgpr_write_b32 a207, v19
    v_accvgpr_read_b32 v16, a208
    v_mul_f32 v16, v16, v52
    v_accvgpr_write_b32 a208, v16
    v_accvgpr_read_b32 v17, a209
    v_mul_f32 v17, v17, v52
    v_accvgpr_write_b32 a209, v17
    v_accvgpr_read_b32 v18, a210
    v_mul_f32 v18, v18, v52
    v_accvgpr_write_b32 a210, v18
    v_accvgpr_read_b32 v19, a211
    v_mul_f32 v19, v19, v52
    v_accvgpr_write_b32 a211, v19
    v_accvgpr_read_b32 v16, a212
    v_mul_f32 v16, v16, v52
    v_accvgpr_write_b32 a212, v16
    v_accvgpr_read_b32 v17, a213
    v_mul_f32 v17, v17, v52
    v_accvgpr_write_b32 a213, v17
    v_accvgpr_read_b32 v18, a214
    v_mul_f32 v18, v18, v52
    v_accvgpr_write_b32 a214, v18
    v_accvgpr_read_b32 v19, a215
    v_mul_f32 v19, v19, v52
    v_accvgpr_write_b32 a215, v19
    v_accvgpr_read_b32 v16, a216
    v_mul_f32 v16, v16, v52
    v_accvgpr_write_b32 a216, v16
    v_accvgpr_read_b32 v17, a217
    v_mul_f32 v17, v17, v52
    v_accvgpr_write_b32 a217, v17
    v_accvgpr_read_b32 v18, a218
    v_mul_f32 v18, v18, v52
    v_accvgpr_write_b32 a218, v18
    v_accvgpr_read_b32 v19, a219
    v_mul_f32 v19, v19, v52
    v_accvgpr_write_b32 a219, v19
    v_accvgpr_read_b32 v16, a220
    v_mul_f32 v16, v16, v52
    v_accvgpr_write_b32 a220, v16
    v_accvgpr_read_b32 v17, a221
    v_mul_f32 v17, v17, v52
    v_accvgpr_write_b32 a221, v17
    v_accvgpr_read_b32 v18, a222
    v_mul_f32 v18, v18, v52
    v_accvgpr_write_b32 a222, v18
    v_accvgpr_read_b32 v19, a223
    v_mul_f32 v19, v19, v52
    v_accvgpr_write_b32 a223, v19
    s_nop 1
    s_setpc_b64 s[94:95]
.Lcode_end:
.section .rodata,"a"
.p2align 6
.amdhsa_kernel interleave_layers__gqa_block_cached__glu_gated_geglu__decode_kernel
  .amdhsa_next_free_vgpr 512
  .amdhsa_next_free_sgpr 102
  .amdhsa_accum_offset 256
  .amdhsa_group_segment_fixed_size 0
  .amdhsa_kernarg_size 96
  .amdhsa_user_sgpr_count 2
  .amdhsa_user_sgpr_kernarg_segment_ptr 1
  .amdhsa_system_sgpr_workgroup_id_x 1
.end_amdhsa_kernel
```
